```python
import torch

def _softmax(x, axis=-1):
    return torch.softmax(x, dim=axis)
def _gelu(x):
    return torch.nn.functional.gelu(x, approximate="tanh")
def _silu(x):
    return torch.nn.functional.silu(x)
def _sigmoid(x):
    return torch.sigmoid(x)
def _layernorm(x, axis=-1, eps=1e-5):
    m = x.mean(dim=axis, keepdim=True)
    v = x.var(dim=axis, keepdim=True, unbiased=False)
    return (x - m) / torch.sqrt(v + eps)
def _scatter_add(tgt, idx, src, axis=0):
    return tgt.clone().index_add_(axis, idx, src)
def _segment_sum(src, seg, n):
    out = torch.zeros((n,) + src.shape[1:], dtype=src.dtype)
    return out.index_add_(0, seg, src)
def _pad(x, pw):
    flat = tuple(v for pair in reversed(pw) for v in pair)
    return torch.nn.functional.pad(x, flat)

kernel_name = 'parallel_sum__grouped_kv_mqa__glu_gated_swiglu__prompt'

def setup_inputs():

    _w = (lambda a: (lambda t: t.to(torch.bfloat16) if t.is_floating_point() else t)(torch.as_tensor(a)))
    def _A_setup():
        B, S, D, H = 1, 2048, 512, 32
        Dh = D // H
        return {
            "x": _w((lambda *s: torch.randn(*s, dtype=torch.bfloat16) * 0.05)(B, S, D)),
            "wq": _w((lambda *s: torch.randn(*s, dtype=torch.bfloat16) * 0.05)(D, H * Dh)),
            "wk": _w((lambda *s: torch.randn(*s, dtype=torch.bfloat16) * 0.05)(D, Dh)),
            "wv": _w((lambda *s: torch.randn(*s, dtype=torch.bfloat16) * 0.05)(D, Dh)),
            "wo": _w((lambda *s: torch.randn(*s, dtype=torch.bfloat16) * 0.05)(H * Dh, D)),
        }
    _A_in = _A_setup()

    def _B_setup():
        B, S, D, F = 1, 2048, 512, 1792
        return {
            "x": _w((lambda *s: torch.randn(*s, dtype=torch.bfloat16) * 0.05)(B, S, D)),
            "w1": _w((lambda *s: torch.randn(*s, dtype=torch.bfloat16) * 0.4)(D, F) * (2.0 / D) ** 0.5),
            "w3": _w((lambda *s: torch.randn(*s, dtype=torch.bfloat16) * 0.4)(D, F) * (2.0 / D) ** 0.5),
            "w2": _w((lambda *s: torch.randn(*s, dtype=torch.bfloat16) * 0.4)(F, D) * (2.0 / F) ** 0.5),
        }
    _B_in = _B_setup()

    return {
        "A_x": _A_in["x"],
        "A_wq": _A_in["wq"],
        "A_wk": _A_in["wk"],
        "A_wv": _A_in["wv"],
        "A_wo": _A_in["wo"],
        "B_x": _B_in["x"],
        "B_w1": _B_in["w1"],
        "B_w3": _B_in["w3"],
        "B_w2": _B_in["w2"],
    }

def reference(A_x, A_wq, A_wk, A_wv, A_wo, B_x, B_w1, B_w3, B_w2):
    def _A_ref(x, wq, wk, wv, wo):
        B, S, D = x.shape
        H = 32
        Dh = D // H
        q = (lambda x, *d: x.permute(*d))((x @ wq).reshape(B, S, H, Dh), 0, 2, 1, 3)
        k = x @ wk
        v = x @ wv
        scores = torch.einsum("bhqd,bkd->bhqk", q, k) * (Dh ** -0.5)
        p = _softmax(scores, axis=-1)
        o = torch.einsum("bhqk,bkd->bhqd", p, v)
        return (lambda x, *d: x.permute(*d))(o, 0, 2, 1, 3).reshape(B, S, H * Dh) @ wo

    def _B_ref(x, w1, w3, w2):
        gate = torch.einsum("bsd,df->bsf", x, w1)
        up = torch.einsum("bsd,df->bsf", x, w3)
        h = _silu(gate) * up
        out = torch.einsum("bsf,fd->bsd", h, w2)
        return out

    x = A_x
    xn = _layernorm(x, axis=-1)
    return x + _A_ref(xn, A_wq, A_wk, A_wv, A_wo) + _B_ref(xn, B_w1, B_w3, B_w2)
```

```asm
; @launch grid=(256,1,1) block=(512,1,1) lds=163840
    .amdgcn_target "amdgcn-amd-amdhsa--gfx950"
    .text
    .globl parallel_sum__grouped_kv_mqa__glu_gated_swiglu__prompt_kernel
    .p2align 8
    .type parallel_sum__grouped_kv_mqa__glu_gated_swiglu__prompt_kernel,@function
parallel_sum__grouped_kv_mqa__glu_gated_swiglu__prompt_kernel:
    s_cmp_ge_u32 s2, 256
    s_cbranch_scc1 L_end
    s_load_dwordx16 s[4:19], s[0:1], 0
    s_load_dwordx8 s[20:27], s[0:1], 64
    v_lshrrev_b32 v1, 6, v0
    v_and_b32 v0, 63, v0
    v_readfirstlane_b32 s56, v1
    s_and_b32 s60, s2, 1
    s_lshl_b32 s60, s60, 3
    s_or_b32 s60, s60, s56
    s_cmp_ge_u32 s60, 12
    s_cbranch_scc1 L_G_o
    s_nop 1
    s_cmp_ge_u32 s56, 4
    s_cbranch_scc1 L_G
    s_cmp_lg_u32 s56, 0
    s_cbranch_scc1 L_A_notkv
    s_and_b32 s60, s2, 7
    s_lshr_b32 s61, s2, 3
    s_lshr_b32 s62, s60, 1
    s_lshl_b32 s62, s62, 2
    s_lshr_b32 s63, s61, 3
    s_or_b32 s58, s62, s63
    s_and_b32 s62, s60, 1
    s_lshl_b32 s62, s62, 3
    s_and_b32 s63, s61, 7
    s_or_b32 s59, s62, s63
    s_and_b32 s57, s56, 3
    s_lshl_b32 s80, s58, 4
    s_or_b32 s80, s80, s59
    s_mov_b32 s70, 100000
    s_mov_b32 s84, 0
    s_mov_b32 s85, -1
    s_mov_b32 s88, 0xffff
    s_mov_b32 s89, 0xffff
    s_add_u32 s90, s59, 0
    s_and_b32 s90, s90, 3
    s_add_u32 s91, s59, 1
    s_and_b32 s91, s91, 3
    s_add_u32 s92, s59, 2
    s_and_b32 s92, s92, 3
    s_add_u32 s93, s59, 3
    s_and_b32 s93, s93, 3
    s_waitcnt lgkmcnt(0)
    s_mov_b32 s28, s4
    s_and_b32 s29, s5, 0xffff
    s_mov_b32 s30, 0x200000
    s_mov_b32 s31, 0x20000
    s_mov_b32 s32, s26
    s_and_b32 s33, s27, 0xffff
    s_mov_b32 s34, 0xb00000
    s_mov_b32 s35, 0x20000
    s_lshr_b32 s61, s59, 1
    s_lshl_b32 s61, s61, 4
    s_lshl_b32 s64, s58, 7
    s_add_u32 s64, s64, s61
    s_lshl_b32 s65, s64, 10
    v_and_b32 v4, 15, v0
    v_lshrrev_b32 v5, 4, v0
    v_lshlrev_b32 v6, 10, v4
    v_lshl_add_u32 v6, v5, 4, v6
    buffer_load_dwordx4 v[128:131], v6, s[28:31], s65 offen offset:0
    buffer_load_dwordx4 v[132:135], v6, s[28:31], s65 offen offset:64
    buffer_load_dwordx4 v[136:139], v6, s[28:31], s65 offen offset:128
    buffer_load_dwordx4 v[140:143], v6, s[28:31], s65 offen offset:192
    buffer_load_dwordx4 v[144:147], v6, s[28:31], s65 offen offset:256
    buffer_load_dwordx4 v[148:151], v6, s[28:31], s65 offen offset:320
    buffer_load_dwordx4 v[152:155], v6, s[28:31], s65 offen offset:384
    buffer_load_dwordx4 v[156:159], v6, s[28:31], s65 offen offset:448
    buffer_load_dwordx4 v[160:163], v6, s[28:31], s65 offen offset:512
    buffer_load_dwordx4 v[164:167], v6, s[28:31], s65 offen offset:576
    buffer_load_dwordx4 v[168:171], v6, s[28:31], s65 offen offset:640
    buffer_load_dwordx4 v[172:175], v6, s[28:31], s65 offen offset:704
    buffer_load_dwordx4 v[176:179], v6, s[28:31], s65 offen offset:768
    buffer_load_dwordx4 v[180:183], v6, s[28:31], s65 offen offset:832
    buffer_load_dwordx4 v[184:187], v6, s[28:31], s65 offen offset:896
    buffer_load_dwordx4 v[188:191], v6, s[28:31], s65 offen offset:960
    s_and_b32 s60, s59, 1
    s_cmp_eq_u32 s60, 0
    s_cselect_b32 s62, s8, s10
    s_cselect_b32 s63, s9, s11
    s_mov_b32 s40, s62
    s_and_b32 s41, s63, 0xffff
    s_mov_b32 s42, 0x4000
    s_mov_b32 s43, 0x20000
    v_lshlrev_b32 v7, 4, v0
    v_mov_b32 v8, 167936
    buffer_load_dword v9, v8, s[32:35], 0 offen sc1
    s_mov_b32 m0, 147456
    s_mov_b32 s66, 0
    buffer_load_dwordx4 v7, s[40:43], s66 offen offset:0 lds
    buffer_load_dwordx4 v7, s[40:43], s66 offen offset:1024 lds
    buffer_load_dwordx4 v7, s[40:43], s66 offen offset:2048 lds
    buffer_load_dwordx4 v7, s[40:43], s66 offen offset:3072 lds
    s_mov_b32 m0, 151552
    s_mov_b32 s66, 4096
    buffer_load_dwordx4 v7, s[40:43], s66 offen offset:0 lds
    buffer_load_dwordx4 v7, s[40:43], s66 offen offset:1024 lds
    buffer_load_dwordx4 v7, s[40:43], s66 offen offset:2048 lds
    buffer_load_dwordx4 v7, s[40:43], s66 offen offset:3072 lds
    s_mov_b32 m0, 155648
    s_mov_b32 s66, 8192
    buffer_load_dwordx4 v7, s[40:43], s66 offen offset:0 lds
    buffer_load_dwordx4 v7, s[40:43], s66 offen offset:1024 lds
    buffer_load_dwordx4 v7, s[40:43], s66 offen offset:2048 lds
    buffer_load_dwordx4 v7, s[40:43], s66 offen offset:3072 lds
    s_mov_b32 m0, 159744
    s_mov_b32 s66, 12288
    buffer_load_dwordx4 v7, s[40:43], s66 offen offset:0 lds
    buffer_load_dwordx4 v7, s[40:43], s66 offen offset:1024 lds
    buffer_load_dwordx4 v7, s[40:43], s66 offen offset:2048 lds
    buffer_load_dwordx4 v7, s[40:43], s66 offen offset:3072 lds
    s_mov_b32 s36, s6
    s_and_b32 s37, s7, 0xffff
    s_mov_b32 s38, 0x80000
    s_mov_b32 s39, 0x20000
    v_lshrrev_b32 v2, 2, v0
    v_lshlrev_b32 v2, 10, v2
    v_and_b32 v3, 3, v0
    v_lshl_add_u32 v2, v3, 4, v2
    s_lshl_b32 s67, s59, 6
    v_add_u32 v2, s67, v2
    v_bfe_u32 v10, v0, 2, 2
    v_lshlrev_b32 v10, 5, v10
    v_lshl_add_u32 v10, v5, 8, v10
    v_and_b32 v11, 3, v0
    v_lshl_add_u32 v10, v11, 3, v10
    v_add_u32 v10, 147456, v10
    v_mov_b32 v12, 0x3f803f80
    v_mov_b32 v16, 0
    v_mov_b32 v13, 0x3f803f80
    v_mov_b32 v17, 0
    v_mov_b32 v14, 0x3f803f80
    v_mov_b32 v18, 0
    v_mov_b32 v15, 0x3f803f80
    v_mov_b32 v19, 0
    s_waitcnt vmcnt(16)
    v_readfirstlane_b32 s66, v9
    v_dot2c_f32_bf16 v16, v12, v128
    v_dot2c_f32_bf16 v18, v128, v128
    v_dot2c_f32_bf16 v17, v12, v129
    v_dot2c_f32_bf16 v19, v129, v129
    v_dot2c_f32_bf16 v16, v12, v130
    v_dot2c_f32_bf16 v18, v130, v130
    v_dot2c_f32_bf16 v17, v12, v131
    v_dot2c_f32_bf16 v19, v131, v131
    v_dot2c_f32_bf16 v16, v12, v132
    v_dot2c_f32_bf16 v18, v132, v132
    v_dot2c_f32_bf16 v17, v12, v133
    v_dot2c_f32_bf16 v19, v133, v133
    v_dot2c_f32_bf16 v16, v12, v134
    v_dot2c_f32_bf16 v18, v134, v134
    v_dot2c_f32_bf16 v17, v12, v135
    v_dot2c_f32_bf16 v19, v135, v135
    v_dot2c_f32_bf16 v16, v12, v136
    v_dot2c_f32_bf16 v18, v136, v136
    v_dot2c_f32_bf16 v17, v12, v137
    v_dot2c_f32_bf16 v19, v137, v137
    v_dot2c_f32_bf16 v16, v12, v138
    v_dot2c_f32_bf16 v18, v138, v138
    v_dot2c_f32_bf16 v17, v12, v139
    v_dot2c_f32_bf16 v19, v139, v139
    v_dot2c_f32_bf16 v16, v12, v140
    v_dot2c_f32_bf16 v18, v140, v140
    v_dot2c_f32_bf16 v17, v12, v141
    v_dot2c_f32_bf16 v19, v141, v141
    v_dot2c_f32_bf16 v16, v12, v142
    v_dot2c_f32_bf16 v18, v142, v142
    v_dot2c_f32_bf16 v17, v12, v143
    v_dot2c_f32_bf16 v19, v143, v143
    v_dot2c_f32_bf16 v16, v12, v144
    v_dot2c_f32_bf16 v18, v144, v144
    v_dot2c_f32_bf16 v17, v12, v145
    v_dot2c_f32_bf16 v19, v145, v145
    v_dot2c_f32_bf16 v16, v12, v146
    v_dot2c_f32_bf16 v18, v146, v146
    v_dot2c_f32_bf16 v17, v12, v147
    v_dot2c_f32_bf16 v19, v147, v147
    v_dot2c_f32_bf16 v16, v12, v148
    v_dot2c_f32_bf16 v18, v148, v148
    v_dot2c_f32_bf16 v17, v12, v149
    v_dot2c_f32_bf16 v19, v149, v149
    v_dot2c_f32_bf16 v16, v12, v150
    v_dot2c_f32_bf16 v18, v150, v150
    v_dot2c_f32_bf16 v17, v12, v151
    v_dot2c_f32_bf16 v19, v151, v151
    v_dot2c_f32_bf16 v16, v12, v152
    v_dot2c_f32_bf16 v18, v152, v152
    v_dot2c_f32_bf16 v17, v12, v153
    v_dot2c_f32_bf16 v19, v153, v153
    v_dot2c_f32_bf16 v16, v12, v154
    v_dot2c_f32_bf16 v18, v154, v154
    v_dot2c_f32_bf16 v17, v12, v155
    v_dot2c_f32_bf16 v19, v155, v155
    v_dot2c_f32_bf16 v16, v12, v156
    v_dot2c_f32_bf16 v18, v156, v156
    v_dot2c_f32_bf16 v17, v12, v157
    v_dot2c_f32_bf16 v19, v157, v157
    v_dot2c_f32_bf16 v16, v12, v158
    v_dot2c_f32_bf16 v18, v158, v158
    v_dot2c_f32_bf16 v17, v12, v159
    v_dot2c_f32_bf16 v19, v159, v159
    v_dot2c_f32_bf16 v16, v12, v160
    v_dot2c_f32_bf16 v18, v160, v160
    v_dot2c_f32_bf16 v17, v12, v161
    v_dot2c_f32_bf16 v19, v161, v161
    v_dot2c_f32_bf16 v16, v12, v162
    v_dot2c_f32_bf16 v18, v162, v162
    v_dot2c_f32_bf16 v17, v12, v163
    v_dot2c_f32_bf16 v19, v163, v163
    v_dot2c_f32_bf16 v16, v12, v164
    v_dot2c_f32_bf16 v18, v164, v164
    v_dot2c_f32_bf16 v17, v12, v165
    v_dot2c_f32_bf16 v19, v165, v165
    v_dot2c_f32_bf16 v16, v12, v166
    v_dot2c_f32_bf16 v18, v166, v166
    v_dot2c_f32_bf16 v17, v12, v167
    v_dot2c_f32_bf16 v19, v167, v167
    v_dot2c_f32_bf16 v16, v12, v168
    v_dot2c_f32_bf16 v18, v168, v168
    v_dot2c_f32_bf16 v17, v12, v169
    v_dot2c_f32_bf16 v19, v169, v169
    v_dot2c_f32_bf16 v16, v12, v170
    v_dot2c_f32_bf16 v18, v170, v170
    v_dot2c_f32_bf16 v17, v12, v171
    v_dot2c_f32_bf16 v19, v171, v171
    v_dot2c_f32_bf16 v16, v12, v172
    v_dot2c_f32_bf16 v18, v172, v172
    v_dot2c_f32_bf16 v17, v12, v173
    v_dot2c_f32_bf16 v19, v173, v173
    v_dot2c_f32_bf16 v16, v12, v174
    v_dot2c_f32_bf16 v18, v174, v174
    v_dot2c_f32_bf16 v17, v12, v175
    v_dot2c_f32_bf16 v19, v175, v175
    v_dot2c_f32_bf16 v16, v12, v176
    v_dot2c_f32_bf16 v18, v176, v176
    v_dot2c_f32_bf16 v17, v12, v177
    v_dot2c_f32_bf16 v19, v177, v177
    v_dot2c_f32_bf16 v16, v12, v178
    v_dot2c_f32_bf16 v18, v178, v178
    v_dot2c_f32_bf16 v17, v12, v179
    v_dot2c_f32_bf16 v19, v179, v179
    v_dot2c_f32_bf16 v16, v12, v180
    v_dot2c_f32_bf16 v18, v180, v180
    v_dot2c_f32_bf16 v17, v12, v181
    v_dot2c_f32_bf16 v19, v181, v181
    v_dot2c_f32_bf16 v16, v12, v182
    v_dot2c_f32_bf16 v18, v182, v182
    v_dot2c_f32_bf16 v17, v12, v183
    v_dot2c_f32_bf16 v19, v183, v183
    v_dot2c_f32_bf16 v16, v12, v184
    v_dot2c_f32_bf16 v18, v184, v184
    v_dot2c_f32_bf16 v17, v12, v185
    v_dot2c_f32_bf16 v19, v185, v185
    v_dot2c_f32_bf16 v16, v12, v186
    v_dot2c_f32_bf16 v18, v186, v186
    v_dot2c_f32_bf16 v17, v12, v187
    v_dot2c_f32_bf16 v19, v187, v187
    v_dot2c_f32_bf16 v16, v12, v188
    v_dot2c_f32_bf16 v18, v188, v188
    v_dot2c_f32_bf16 v17, v12, v189
    v_dot2c_f32_bf16 v19, v189, v189
    v_dot2c_f32_bf16 v16, v12, v190
    v_dot2c_f32_bf16 v18, v190, v190
    v_dot2c_f32_bf16 v17, v12, v191
    v_dot2c_f32_bf16 v19, v191, v191
    s_waitcnt vmcnt(0)
    ds_read_b64_tr_b16 v[192:193], v10 offset:0
    ds_read_b64_tr_b16 v[194:195], v10 offset:128
    ds_read_b64_tr_b16 v[196:197], v10 offset:1024
    ds_read_b64_tr_b16 v[198:199], v10 offset:1152
    ds_read_b64_tr_b16 v[200:201], v10 offset:2048
    ds_read_b64_tr_b16 v[202:203], v10 offset:2176
    ds_read_b64_tr_b16 v[204:205], v10 offset:3072
    ds_read_b64_tr_b16 v[206:207], v10 offset:3200
    s_add_u32 s72, s66, 1
    s_not_b32 s73, s66
    v_add_f32 v16, v16, v17
    v_add_f32 v18, v18, v19
    v_mov_b32 v17, v16
    v_mov_b32 v19, v18
    s_nop 0
    v_permlane32_swap_b32 v16, v17
    v_permlane32_swap_b32 v18, v19
    v_add_f32 v16, v16, v17
    v_add_f32 v18, v18, v19
    v_mov_b32 v17, v16
    v_mov_b32 v19, v18
    s_nop 0
    v_permlane16_swap_b32 v16, v17
    v_permlane16_swap_b32 v18, v19
    v_add_f32 v16, v16, v17
    v_add_f32 v18, v18, v19
    v_mul_f32 v16, 0xbb000000, v16
    v_mul_f32 v18, 0x3b000000, v18
    v_fma_f32 v18, -v16, v16, v18
    v_max_f32 v18, 0, v18
    v_add_f32 v18, 0x3727c5ac, v18
    v_rsq_f32 v18, v18
    ds_read_b64_tr_b16 v[208:209], v10 offset:4096
    ds_read_b64_tr_b16 v[210:211], v10 offset:4224
    ds_read_b64_tr_b16 v[212:213], v10 offset:5120
    ds_read_b64_tr_b16 v[214:215], v10 offset:5248
    ds_read_b64_tr_b16 v[216:217], v10 offset:6144
    ds_read_b64_tr_b16 v[218:219], v10 offset:6272
    ds_read_b64_tr_b16 v[220:221], v10 offset:7168
    ds_read_b64_tr_b16 v[222:223], v10 offset:7296
    ds_read_b64_tr_b16 v[224:225], v10 offset:8192
    ds_read_b64_tr_b16 v[226:227], v10 offset:8320
    ds_read_b64_tr_b16 v[228:229], v10 offset:9216
    ds_read_b64_tr_b16 v[230:231], v10 offset:9344
    ds_read_b64_tr_b16 v[232:233], v10 offset:10240
    ds_read_b64_tr_b16 v[234:235], v10 offset:10368
    ds_read_b64_tr_b16 v[236:237], v10 offset:11264
    ds_read_b64_tr_b16 v[238:239], v10 offset:11392
    ds_read_b64_tr_b16 v[240:241], v10 offset:12288
    ds_read_b64_tr_b16 v[242:243], v10 offset:12416
    ds_read_b64_tr_b16 v[244:245], v10 offset:13312
    ds_read_b64_tr_b16 v[246:247], v10 offset:13440
    ds_read_b64_tr_b16 v[248:249], v10 offset:14336
    ds_read_b64_tr_b16 v[250:251], v10 offset:14464
    ds_read_b64_tr_b16 v[252:253], v10 offset:15360
    ds_read_b64_tr_b16 v[254:255], v10 offset:15488
    s_waitcnt lgkmcnt(15)
    v_mfma_f32_16x16x32_bf16 v[24:27], v[192:195], v[128:131], 0
    v_mfma_f32_16x16x32_bf16 v[28:31], v[192:195], v[12:15], 0
    v_mfma_f32_16x16x32_bf16 v[24:27], v[196:199], v[132:135], v[24:27]
    v_mfma_f32_16x16x32_bf16 v[28:31], v[196:199], v[12:15], v[28:31]
    v_mfma_f32_16x16x32_bf16 v[24:27], v[200:203], v[136:139], v[24:27]
    v_mfma_f32_16x16x32_bf16 v[28:31], v[200:203], v[12:15], v[28:31]
    v_mfma_f32_16x16x32_bf16 v[24:27], v[204:207], v[140:143], v[24:27]
    v_mfma_f32_16x16x32_bf16 v[28:31], v[204:207], v[12:15], v[28:31]
    v_mfma_f32_16x16x32_bf16 v[24:27], v[208:211], v[144:147], v[24:27]
    v_mfma_f32_16x16x32_bf16 v[28:31], v[208:211], v[12:15], v[28:31]
    v_mfma_f32_16x16x32_bf16 v[24:27], v[212:215], v[148:151], v[24:27]
    v_mfma_f32_16x16x32_bf16 v[28:31], v[212:215], v[12:15], v[28:31]
    v_mfma_f32_16x16x32_bf16 v[24:27], v[216:219], v[152:155], v[24:27]
    v_mfma_f32_16x16x32_bf16 v[28:31], v[216:219], v[12:15], v[28:31]
    v_mfma_f32_16x16x32_bf16 v[24:27], v[220:223], v[156:159], v[24:27]
    v_mfma_f32_16x16x32_bf16 v[28:31], v[220:223], v[12:15], v[28:31]
    s_waitcnt lgkmcnt(14)
    v_mfma_f32_16x16x32_bf16 v[24:27], v[224:227], v[160:163], v[24:27]
    v_mfma_f32_16x16x32_bf16 v[28:31], v[224:227], v[12:15], v[28:31]
    s_waitcnt lgkmcnt(12)
    v_mfma_f32_16x16x32_bf16 v[24:27], v[228:231], v[164:167], v[24:27]
    v_mfma_f32_16x16x32_bf16 v[28:31], v[228:231], v[12:15], v[28:31]
    s_waitcnt lgkmcnt(10)
    v_mfma_f32_16x16x32_bf16 v[24:27], v[232:235], v[168:171], v[24:27]
    v_mfma_f32_16x16x32_bf16 v[28:31], v[232:235], v[12:15], v[28:31]
    s_waitcnt lgkmcnt(8)
    v_mfma_f32_16x16x32_bf16 v[24:27], v[236:239], v[172:175], v[24:27]
    v_mfma_f32_16x16x32_bf16 v[28:31], v[236:239], v[12:15], v[28:31]
    s_waitcnt lgkmcnt(6)
    v_mfma_f32_16x16x32_bf16 v[24:27], v[240:243], v[176:179], v[24:27]
    v_mfma_f32_16x16x32_bf16 v[28:31], v[240:243], v[12:15], v[28:31]
    s_waitcnt lgkmcnt(4)
    v_mfma_f32_16x16x32_bf16 v[24:27], v[244:247], v[180:183], v[24:27]
    v_mfma_f32_16x16x32_bf16 v[28:31], v[244:247], v[12:15], v[28:31]
    s_waitcnt lgkmcnt(2)
    v_mfma_f32_16x16x32_bf16 v[24:27], v[248:251], v[184:187], v[24:27]
    v_mfma_f32_16x16x32_bf16 v[28:31], v[248:251], v[12:15], v[28:31]
    s_waitcnt lgkmcnt(0)
    v_mfma_f32_16x16x32_bf16 v[24:27], v[252:255], v[188:191], v[24:27]
    v_mfma_f32_16x16x32_bf16 v[28:31], v[252:255], v[12:15], v[28:31]
    s_lshl_b32 s61, s80, 3
    v_mov_b32 v20, s61
    v_lshlrev_b32 v33, 3, v0
    s_and_b32 s60, s59, 1
    s_cmp_eq_u32 s60, 1
    s_cbranch_scc1 L_A_vaddr
    s_lshr_b32 s60, s64, 5
    s_lshl_b32 s60, s60, 10
    s_and_b32 s61, s64, 16
    s_lshl_b32 s61, s61, 4
    s_add_u32 s60, s60, s61
    v_and_b32 v21, 1, v5
    v_lshlrev_b32 v21, 9, v21
    v_lshl_add_u32 v21, v4, 4, v21
    v_lshrrev_b32 v32, 1, v5
    v_lshl_add_u32 v21, v32, 3, v21
    s_branch L_A_kvfin
L_A_vaddr:
    v_bfe_u32 v21, v4, 2, 1
    v_lshlrev_b32 v21, 8, v21
    v_lshl_add_u32 v21, v5, 6, v21
    v_lshrrev_b32 v32, 3, v4
    v_lshl_add_u32 v21, v32, 3, v21
    v_and_b32 v32, 3, v4
    v_lshl_add_u32 v21, v32, 1, v21
    v_add_u32 v21, 147456, v21
    v_add_u32 v32, 147456, v33
    s_lshr_b32 s60, s64, 4
    s_lshl_b32 s60, s60, 9
    s_add_u32 s60, s60, 65536
L_A_kvfin:
    v_fmac_f32 v24, v16, v28
    v_fmac_f32 v25, v16, v29
    v_fmac_f32 v26, v16, v30
    v_fmac_f32 v27, v16, v31
    v_mul_f32 v24, v18, v24
    v_mul_f32 v25, v18, v25
    v_mul_f32 v26, v18, v26
    v_mul_f32 v27, v18, v27
    v_cvt_pk_bf16_f32 v22, v24, v25
    v_cvt_pk_bf16_f32 v23, v26, v27
    s_and_b32 s61, s59, 1
    s_cmp_eq_u32 s61, 0
    s_cbranch_scc1 L_A_kvst
    ds_write_b16 v21, v22
    ds_write_b16_d16_hi v21, v22 offset:16
    ds_write_b16 v21, v23 offset:32
    ds_write_b16_d16_hi v21, v23 offset:48
    ds_read_b64 v[22:23], v32
    v_mov_b32 v21, v33
    s_waitcnt lgkmcnt(0)
L_A_kvst:
    buffer_store_dwordx2 v[22:23], v21, s[32:35], s60 offen sc1
    s_waitcnt vmcnt(0)
    v_mov_b32 v26, s72
    v_mov_b32 v27, s73
    s_mov_b32 s87, 147456
    s_mov_b64 exec, 1
    buffer_store_dwordx2 v[26:27], v20, s[32:35], s87 offen sc1
    s_mov_b64 exec, -1
    s_lshl_b32 s62, s92, 17
    s_lshl_b32 s63, s93, 17
    s_mov_b32 m0, 147456
    s_add_u32 s60, s62, 0
    buffer_load_dwordx4 v2, s[36:39], s60 offen lds
    s_mov_b32 m0, 148480
    s_add_u32 s60, s62, 16384
    buffer_load_dwordx4 v2, s[36:39], s60 offen lds
    s_mov_b32 m0, 149504
    s_add_u32 s60, s62, 32768
    buffer_load_dwordx4 v2, s[36:39], s60 offen lds
    s_mov_b32 m0, 150528
    s_add_u32 s60, s62, 49152
    buffer_load_dwordx4 v2, s[36:39], s60 offen lds
    s_mov_b32 m0, 151552
    s_add_u32 s60, s62, 65536
    buffer_load_dwordx4 v2, s[36:39], s60 offen lds
    s_mov_b32 m0, 152576
    s_add_u32 s60, s62, 81920
    buffer_load_dwordx4 v2, s[36:39], s60 offen lds
    s_mov_b32 m0, 153600
    s_add_u32 s60, s62, 98304
    buffer_load_dwordx4 v2, s[36:39], s60 offen lds
    s_mov_b32 m0, 154624
    s_add_u32 s60, s62, 114688
    buffer_load_dwordx4 v2, s[36:39], s60 offen lds
    s_mov_b32 m0, 155648
    s_add_u32 s60, s63, 0
    buffer_load_dwordx4 v2, s[36:39], s60 offen lds
    s_mov_b32 m0, 156672
    s_add_u32 s60, s63, 16384
    buffer_load_dwordx4 v2, s[36:39], s60 offen lds
    s_mov_b32 m0, 157696
    s_add_u32 s60, s63, 32768
    buffer_load_dwordx4 v2, s[36:39], s60 offen lds
    s_mov_b32 m0, 158720
    s_add_u32 s60, s63, 49152
    buffer_load_dwordx4 v2, s[36:39], s60 offen lds
    s_mov_b32 m0, 159744
    s_add_u32 s60, s63, 65536
    buffer_load_dwordx4 v2, s[36:39], s60 offen lds
    s_mov_b32 m0, 160768
    s_add_u32 s60, s63, 81920
    buffer_load_dwordx4 v2, s[36:39], s60 offen lds
    s_mov_b32 m0, 161792
    s_add_u32 s60, s63, 98304
    buffer_load_dwordx4 v2, s[36:39], s60 offen lds
    s_mov_b32 m0, 162816
    s_add_u32 s60, s63, 114688
    buffer_load_dwordx4 v2, s[36:39], s60 offen lds
    s_branch L_A_b1
L_A_notkv:
    s_and_b32 s60, s2, 7
    s_lshr_b32 s61, s2, 3
    s_lshr_b32 s62, s60, 1
    s_lshl_b32 s62, s62, 2
    s_lshr_b32 s63, s61, 3
    s_or_b32 s58, s62, s63
    s_and_b32 s62, s60, 1
    s_lshl_b32 s62, s62, 3
    s_and_b32 s63, s61, 7
    s_or_b32 s59, s62, s63
    s_and_b32 s57, s56, 3
    s_lshl_b32 s80, s58, 4
    s_or_b32 s80, s80, s59
    s_mov_b32 s70, 100000
    s_mov_b32 s84, 0
    s_mov_b32 s85, -1
    s_mov_b32 s88, 0xffff
    s_mov_b32 s89, 0xffff
    s_add_u32 s90, s59, 0
    s_and_b32 s90, s90, 3
    s_add_u32 s91, s59, 1
    s_and_b32 s91, s91, 3
    s_add_u32 s92, s59, 2
    s_and_b32 s92, s92, 3
    s_add_u32 s93, s59, 3
    s_and_b32 s93, s93, 3
    s_waitcnt lgkmcnt(0)
    s_mov_b32 s28, s4
    s_and_b32 s29, s5, 0xffff
    s_mov_b32 s30, 0x200000
    s_mov_b32 s31, 0x20000
    s_mov_b32 s32, s26
    s_and_b32 s33, s27, 0xffff
    s_mov_b32 s34, 0xb00000
    s_mov_b32 s35, 0x20000
    s_mov_b32 s36, s6
    s_and_b32 s37, s7, 0xffff
    s_mov_b32 s38, 0x80000
    s_mov_b32 s39, 0x20000
    v_lshrrev_b32 v2, 2, v0
    v_lshlrev_b32 v2, 10, v2
    v_and_b32 v3, 3, v0
    v_lshl_add_u32 v2, v3, 4, v2
    s_lshl_b32 s67, s59, 6
    v_add_u32 v2, s67, v2
    s_cmp_eq_u32 s56, 3
    s_cbranch_scc1 L_A_w3
    s_sub_u32 s61, s56, 1
    s_lshl_b32 s62, s61, 13
    s_add_u32 s62, s62, 131072
    s_cmp_eq_u32 s61, 0
    s_cselect_b32 s61, s90, s91
    s_lshl_b32 s61, s61, 17
    s_add_u32 m0, s62, 0
    s_add_u32 s60, s61, 0
    buffer_load_dwordx4 v2, s[36:39], s60 offen lds
    s_add_u32 m0, s62, 1024
    s_add_u32 s60, s61, 16384
    buffer_load_dwordx4 v2, s[36:39], s60 offen lds
    s_add_u32 m0, s62, 2048
    s_add_u32 s60, s61, 32768
    buffer_load_dwordx4 v2, s[36:39], s60 offen lds
    s_add_u32 m0, s62, 3072
    s_add_u32 s60, s61, 49152
    buffer_load_dwordx4 v2, s[36:39], s60 offen lds
    s_add_u32 m0, s62, 4096
    s_add_u32 s60, s61, 65536
    buffer_load_dwordx4 v2, s[36:39], s60 offen lds
    s_add_u32 m0, s62, 5120
    s_add_u32 s60, s61, 81920
    buffer_load_dwordx4 v2, s[36:39], s60 offen lds
    s_add_u32 m0, s62, 6144
    s_add_u32 s60, s61, 98304
    buffer_load_dwordx4 v2, s[36:39], s60 offen lds
    s_add_u32 m0, s62, 7168
    s_add_u32 s60, s61, 114688
    buffer_load_dwordx4 v2, s[36:39], s60 offen lds
    s_branch L_A_b1
L_A_w3:
L_A_b1:
    s_lshl_b32 s60, s58, 2
    s_add_u32 s60, s60, s56
    s_lshl_b32 s60, s60, 5
    s_lshl_b32 s61, s59, 1
    s_add_u32 s60, s60, s61
    s_lshl_b32 s60, s60, 10
    s_add_u32 s76, s60, 9437184
    v_lshlrev_b32 v108, 4, v0
    v_mov_b32 v60, -1
    v_mov_b32 v61, -1
    v_mov_b32 v62, -1
    v_mov_b32 v63, -1
    buffer_store_dwordx4 v[60:63], v108, s[32:35], s76 offen offset:0 sc1
    buffer_store_dwordx4 v[60:63], v108, s[32:35], s76 offen offset:1024 sc1
    v_mov_b32 v109, 65536
    v_mov_b32 v110, 1
    s_lshl_b32 s60, s56, 9
    v_lshlrev_b32 v111, 3, v0
    v_add_u32 v111, s60, v111
    s_lshl_b32 s60, s56, 14
    s_add_u32 s74, s60, 0
    s_add_u32 s75, s60, 65536
    s_add_u32 s77, s60, 0
    v_and_b32 v113, 15, v0
    v_lshlrev_b32 v113, 4, v113
    v_lshrrev_b32 v114, 5, v0
    v_lshl_add_u32 v113, v114, 8, v113
    v_add_u32 v112, s77, v108
    v_add_u32 v114, s77, v113
    v_add_u32 v118, 8192, v112
    v_mov_b32 v119, v114
    v_add_u32 v117, 8192, v112
    s_lshl_b32 s60, s56, 2
    v_add_u32 v120, s60, v109
    v_lshlrev_b32 v1, 2, v0
    s_add_u32 s60, s77, 2048
    v_add_u32 v1, s60, v1
    s_lshl_b32 s60, s56, 11
    s_add_u32 s61, s60, 2048
    s_and_b32 s61, s61, 0x1fff
    s_add_u32 s61, s61, 118784
    v_add_u32 v122, s61, v108
    s_add_u32 s61, s60, 4096
    s_and_b32 s61, s61, 0x1fff
    s_add_u32 s61, s61, 118784
    v_add_u32 v123, s61, v108
    s_add_u32 s61, s60, 6144
    s_and_b32 s61, s61, 0x1fff
    s_add_u32 s61, s61, 118784
    v_add_u32 v124, s61, v108
    s_add_u32 s61, s60, 8192
    s_and_b32 s61, s61, 0x1fff
    s_add_u32 s61, s61, 118784
    v_add_u32 v125, s61, v108
    v_and_b32 v121, 31, v0
    v_mov_b32 v115, 0x3f803f80
    v_cmp_eq_u32 vcc, 16, v121
    s_nop 1
    v_cndmask_b32 v44, 0, v115, vcc
    v_mov_b32 v45, v44
    v_mov_b32 v46, v44
    v_mov_b32 v47, v44
    v_mov_b32 v48, v44
    v_mov_b32 v49, v44
    v_mov_b32 v50, v44
    v_mov_b32 v51, v44
    v_mov_b32 v52, v44
    v_mov_b32 v53, v44
    v_mov_b32 v54, v44
    v_mov_b32 v55, v44
    v_mov_b32 v56, v44
    v_mov_b32 v57, v44
    v_mov_b32 v58, v44
    v_mov_b32 v59, v44
    v_mov_b32 v100, 0
    v_mov_b32 v101, 0
    v_mov_b32 v102, 0
    v_mov_b32 v103, 0
    v_mov_b32 v104, 0
    v_mov_b32 v105, 0
    v_mov_b32 v106, 0
    v_mov_b32 v107, 0
    v_mov_b32 v90, 0
    v_mov_b32 v91, 0
    s_nop 0
    v_mfma_f32_32x32x16_bf16 v[128:143], v[100:103], v[100:103], 0
    v_mfma_f32_32x32x16_bf16 v[144:159], v[100:103], v[100:103], 0
    v_mfma_f32_32x32x16_bf16 v[160:175], v[100:103], v[100:103], 0
    v_mfma_f32_32x32x16_bf16 v[176:191], v[100:103], v[100:103], 0
    v_mfma_f32_32x32x16_bf16 v[192:207], v[100:103], v[100:103], 0
    v_mfma_f32_32x32x16_bf16 v[208:223], v[100:103], v[100:103], 0
    v_mfma_f32_32x32x16_bf16 v[224:239], v[100:103], v[100:103], 0
    v_mfma_f32_32x32x16_bf16 v[240:255], v[100:103], v[100:103], 0
    s_cmp_eq_u32 s56, 0
    s_cbranch_scc1 L_A_b1go
    s_waitcnt vmcnt(0)
L_A_b1go:
    s_barrier
    s_cmp_gt_u32 s56, 1
    s_cbranch_scc1 L_A_noinit
    s_cmp_eq_u32 s56, 0
    s_cbranch_scc1 L_A_tagw
    v_mov_b32 v6, 0
    v_and_b32 v7, 15, v0
    v_lshlrev_b32 v7, 2, v7
    v_add_u32 v7, 65536, v7
    ds_write_b32 v7, v6
    s_branch L_A_noinit
L_A_tagw:
    v_mov_b32 v6, s72
    v_mov_b32 v7, s73
    v_mov_b32 v8, 65600
    ds_write_b64 v8, v[6:7]
L_A_noinit:
    s_waitcnt vmcnt(0) lgkmcnt(0)
    s_barrier
    v_mov_b32 v6, 65600
    ds_read_b64 v[8:9], v6
    s_waitcnt lgkmcnt(0)
    v_readfirstlane_b32 s72, v8
    v_readfirstlane_b32 s73, v9
    s_nop 0
    s_mov_b32 s87, 147456
L_pf_1:
    buffer_load_dwordx2 v[6:7], v111, s[32:35], s87 offen sc1
    s_waitcnt vmcnt(0)
    v_cmp_eq_u32 vcc, s72, v6
    v_cmp_eq_u32 s[78:79], s73, v7
    s_and_b64 vcc, vcc, s[78:79]
    s_cmp_eq_u64 vcc, -1
    s_cbranch_scc1 L_pfd_2
    s_sub_u32 s70, s70, 1
    s_cbranch_scc1 L_pfd_2_x
    s_sleep 2
    s_branch L_pf_1
L_pfd_2_x:
    s_mov_b32 s70, 0
L_pfd_2:
    buffer_load_dwordx4 v[36:39], v108, s[32:35], s74 offen offset:0 sc1
    s_mov_b64 exec, s[88:89]
    buffer_load_dwordx4 v[44:47], v113, s[32:35], s75 offen offset:0 sc1
    buffer_load_dwordx4 v[48:51], v113, s[32:35], s75 offen offset:512 sc1
    s_mov_b64 exec, -1
    buffer_load_dwordx4 v[40:43], v108, s[32:35], s74 offen offset:1024 sc1
    s_mov_b64 exec, 1
    ds_add_u32 v120, v110 offset:16
    s_mov_b64 exec, -1
    s_add_u32 m0, s77, 0
    s_add_u32 s60, s75, 1024
    buffer_load_dwordx4 v108, s[32:35], s60 offen sc1 lds
    s_add_u32 m0, s77, 8192
    s_add_u32 s60, s74, 2048
    buffer_load_dwordx4 v108, s[32:35], s60 offen sc1 lds
    s_add_u32 m0, s77, 1024
    s_add_u32 s60, s75, 2048
    buffer_load_dwordx4 v108, s[32:35], s60 offen sc1 lds
    s_add_u32 m0, s77, 9216
    s_add_u32 s60, s74, 3072
    buffer_load_dwordx4 v108, s[32:35], s60 offen sc1 lds
    s_add_u32 m0, s77, 2048
    s_add_u32 s60, s75, 3072
    buffer_load_dwordx4 v108, s[32:35], s60 offen sc1 lds
    s_add_u32 m0, s77, 10240
    s_add_u32 s60, s74, 4096
    buffer_load_dwordx4 v108, s[32:35], s60 offen sc1 lds
    s_add_u32 m0, s77, 3072
    s_add_u32 s60, s75, 4096
    buffer_load_dwordx4 v108, s[32:35], s60 offen sc1 lds
    s_add_u32 m0, s77, 11264
    s_add_u32 s60, s74, 5120
    buffer_load_dwordx4 v108, s[32:35], s60 offen sc1 lds
L_pl_3:
    ds_read_b32 v121, v109 offset:4
    s_waitcnt lgkmcnt(0)
    v_cmp_le_u32 vcc, 4, v121
    s_cbranch_vccnz L_pld_4
    s_sub_u32 s70, s70, 1
    s_cbranch_scc1 L_pld_4_x
    s_sleep 1
    s_branch L_pl_3
L_pld_4_x:
    s_mov_b32 s70, 0
L_pld_4:
    ds_read_b128 v[4:7], v122 offset:0
    ds_read_b128 v[8:11], v122 offset:1024
    ds_read_b128 v[12:15], v123 offset:0
    ds_read_b128 v[16:19], v123 offset:1024
    ds_read_b128 v[20:23], v124 offset:0
    ds_read_b128 v[24:27], v124 offset:1024
    ds_read_b128 v[28:31], v125 offset:0
    ds_read_b128 v[32:35], v125 offset:1024
    s_mov_b64 exec, 1
    ds_add_u32 v109, v110 offset:8
    s_mov_b64 exec, -1
    s_setprio 1
    s_mov_b32 s71, 0
    s_waitcnt vmcnt(11) lgkmcnt(8)
    v_mfma_f32_32x32x16_bf16 v[60:75], v[36:39], v[4:7], 0
    s_waitcnt lgkmcnt(0)
    s_nop 15
    .p2align 6
L_A_loop:
    v_exp_f32 v60, v60
    v_cvt_pk_bf16_f32 v107, v90, v91
    v_exp_f32 v61, v61
    v_mfma_f32_32x32x16_bf16 v[240:255], v[52:55], v[100:103], v[240:255]
    v_exp_f32 v62, v62
    v_exp_f32 v63, v63
    v_cvt_pk_bf16_f32 v92, v60, v61
    v_exp_f32 v64, v64
    v_exp_f32 v65, v65
    v_cvt_pk_bf16_f32 v93, v62, v63
    v_exp_f32 v66, v66
    v_mfma_f32_32x32x16_bf16 v[76:91], v[36:39], v[8:11], 0
    v_exp_f32 v67, v67
    v_cvt_pk_bf16_f32 v94, v64, v65
    v_exp_f32 v68, v68
    v_exp_f32 v69, v69
    v_cvt_pk_bf16_f32 v95, v66, v67
    v_exp_f32 v70, v70
    v_exp_f32 v71, v71
    v_cvt_pk_bf16_f32 v96, v68, v69
    v_mfma_f32_32x32x16_bf16 v[240:255], v[56:59], v[104:107], v[240:255]
    v_exp_f32 v72, v72
    v_exp_f32 v73, v73
    v_cvt_pk_bf16_f32 v97, v70, v71
    v_exp_f32 v74, v74
    v_exp_f32 v75, v75
    v_cvt_pk_bf16_f32 v98, v72, v73
    v_exp_f32 v76, v76
    v_cvt_pk_bf16_f32 v99, v74, v75
    v_exp_f32 v77, v77
    s_waitcnt vmcnt(7) lgkmcnt(1)
    s_mov_b64 exec, s[88:89]
    ds_read_b128 v[52:55], v119 offset:0
    ds_read_b128 v[56:59], v119 offset:512
    s_mov_b64 exec, -1
    v_mfma_f32_32x32x16_bf16 v[128:143], v[44:47], v[92:95], v[128:143]
    v_exp_f32 v78, v78
    v_exp_f32 v79, v79
    v_cvt_pk_bf16_f32 v100, v76, v77
    v_exp_f32 v80, v80
    v_exp_f32 v81, v81
    v_cvt_pk_bf16_f32 v101, v78, v79
    v_exp_f32 v82, v82
    v_mfma_f32_32x32x16_bf16 v[60:75], v[36:39], v[12:15], 0
    v_exp_f32 v83, v83
    v_cvt_pk_bf16_f32 v102, v80, v81
    v_exp_f32 v84, v84
    v_exp_f32 v85, v85
    v_cvt_pk_bf16_f32 v103, v82, v83
    v_exp_f32 v86, v86
    v_exp_f32 v87, v87
    v_cvt_pk_bf16_f32 v104, v84, v85
    v_mfma_f32_32x32x16_bf16 v[128:143], v[48:51], v[96:99], v[128:143]
    v_exp_f32 v88, v88
    v_exp_f32 v89, v89
    v_cvt_pk_bf16_f32 v105, v86, v87
    v_exp_f32 v90, v90
    v_exp_f32 v91, v91
    v_cvt_pk_bf16_f32 v106, v88, v89
    v_exp_f32 v60, v60
    v_cvt_pk_bf16_f32 v107, v90, v91
    v_exp_f32 v61, v61
    v_mfma_f32_32x32x16_bf16 v[144:159], v[44:47], v[100:103], v[144:159]
    v_exp_f32 v62, v62
    v_exp_f32 v63, v63
    v_cvt_pk_bf16_f32 v92, v60, v61
    v_exp_f32 v64, v64
    v_exp_f32 v65, v65
    v_cvt_pk_bf16_f32 v93, v62, v63
    v_exp_f32 v66, v66
    v_mfma_f32_32x32x16_bf16 v[76:91], v[36:39], v[16:19], 0
    v_exp_f32 v67, v67
    v_cvt_pk_bf16_f32 v94, v64, v65
    v_exp_f32 v68, v68
    v_exp_f32 v69, v69
    v_cvt_pk_bf16_f32 v95, v66, v67
    v_exp_f32 v70, v70
    v_exp_f32 v71, v71
    v_cvt_pk_bf16_f32 v96, v68, v69
    v_mfma_f32_32x32x16_bf16 v[144:159], v[48:51], v[104:107], v[144:159]
    v_exp_f32 v72, v72
    v_exp_f32 v73, v73
    v_cvt_pk_bf16_f32 v97, v70, v71
    v_exp_f32 v74, v74
    v_exp_f32 v75, v75
    v_cvt_pk_bf16_f32 v98, v72, v73
    v_exp_f32 v76, v76
    v_cvt_pk_bf16_f32 v99, v74, v75
    v_exp_f32 v77, v77
    v_mfma_f32_32x32x16_bf16 v[160:175], v[44:47], v[92:95], v[160:175]
    v_exp_f32 v78, v78
    v_exp_f32 v79, v79
    v_cvt_pk_bf16_f32 v100, v76, v77
    v_exp_f32 v80, v80
    v_exp_f32 v81, v81
    v_cvt_pk_bf16_f32 v101, v78, v79
    v_exp_f32 v82, v82
    v_mfma_f32_32x32x16_bf16 v[60:75], v[36:39], v[20:23], 0
    v_exp_f32 v83, v83
    v_cvt_pk_bf16_f32 v102, v80, v81
    v_exp_f32 v84, v84
    v_exp_f32 v85, v85
    v_cvt_pk_bf16_f32 v103, v82, v83
    v_exp_f32 v86, v86
    v_exp_f32 v87, v87
    v_cvt_pk_bf16_f32 v104, v84, v85
    v_mfma_f32_32x32x16_bf16 v[160:175], v[48:51], v[96:99], v[160:175]
    v_exp_f32 v88, v88
    v_exp_f32 v89, v89
    v_cvt_pk_bf16_f32 v105, v86, v87
    v_exp_f32 v90, v90
    v_exp_f32 v91, v91
    v_cvt_pk_bf16_f32 v106, v88, v89
    v_exp_f32 v60, v60
    v_cvt_pk_bf16_f32 v107, v90, v91
    v_exp_f32 v61, v61
    v_mfma_f32_32x32x16_bf16 v[176:191], v[44:47], v[100:103], v[176:191]
    v_exp_f32 v62, v62
    v_exp_f32 v63, v63
    v_cvt_pk_bf16_f32 v92, v60, v61
    v_exp_f32 v64, v64
    v_exp_f32 v65, v65
    v_cvt_pk_bf16_f32 v93, v62, v63
    v_exp_f32 v66, v66
    v_mfma_f32_32x32x16_bf16 v[76:91], v[36:39], v[24:27], 0
    v_exp_f32 v67, v67
    v_cvt_pk_bf16_f32 v94, v64, v65
    v_exp_f32 v68, v68
    v_exp_f32 v69, v69
    v_cvt_pk_bf16_f32 v95, v66, v67
    v_exp_f32 v70, v70
    v_exp_f32 v71, v71
    v_cvt_pk_bf16_f32 v96, v68, v69
    v_mfma_f32_32x32x16_bf16 v[176:191], v[48:51], v[104:107], v[176:191]
    v_exp_f32 v72, v72
    v_exp_f32 v73, v73
    v_cvt_pk_bf16_f32 v97, v70, v71
    v_exp_f32 v74, v74
    v_exp_f32 v75, v75
    v_cvt_pk_bf16_f32 v98, v72, v73
    v_exp_f32 v76, v76
    v_cvt_pk_bf16_f32 v99, v74, v75
    v_exp_f32 v77, v77
    v_mfma_f32_32x32x16_bf16 v[192:207], v[44:47], v[92:95], v[192:207]
    v_exp_f32 v78, v78
    v_exp_f32 v79, v79
    v_cvt_pk_bf16_f32 v100, v76, v77
    v_exp_f32 v80, v80
    v_exp_f32 v81, v81
    v_cvt_pk_bf16_f32 v101, v78, v79
    v_exp_f32 v82, v82
    v_mfma_f32_32x32x16_bf16 v[60:75], v[36:39], v[28:31], 0
    v_exp_f32 v83, v83
    v_cvt_pk_bf16_f32 v102, v80, v81
    v_exp_f32 v84, v84
    v_exp_f32 v85, v85
    v_cvt_pk_bf16_f32 v103, v82, v83
    v_exp_f32 v86, v86
    v_exp_f32 v87, v87
    v_cvt_pk_bf16_f32 v104, v84, v85
    v_mfma_f32_32x32x16_bf16 v[192:207], v[48:51], v[96:99], v[192:207]
    v_exp_f32 v88, v88
    v_exp_f32 v89, v89
    v_cvt_pk_bf16_f32 v105, v86, v87
    v_exp_f32 v90, v90
    v_exp_f32 v91, v91
    v_cvt_pk_bf16_f32 v106, v88, v89
    v_exp_f32 v60, v60
    v_cvt_pk_bf16_f32 v107, v90, v91
    v_exp_f32 v61, v61
    v_mfma_f32_32x32x16_bf16 v[208:223], v[44:47], v[100:103], v[208:223]
    v_exp_f32 v62, v62
    v_exp_f32 v63, v63
    v_cvt_pk_bf16_f32 v92, v60, v61
    v_exp_f32 v64, v64
    v_exp_f32 v65, v65
    v_cvt_pk_bf16_f32 v93, v62, v63
    v_exp_f32 v66, v66
    v_mfma_f32_32x32x16_bf16 v[76:91], v[36:39], v[32:35], 0
    v_exp_f32 v67, v67
    v_cvt_pk_bf16_f32 v94, v64, v65
    v_exp_f32 v68, v68
    v_exp_f32 v69, v69
    v_cvt_pk_bf16_f32 v95, v66, v67
    v_exp_f32 v70, v70
    v_exp_f32 v71, v71
    v_cvt_pk_bf16_f32 v96, v68, v69
    v_mfma_f32_32x32x16_bf16 v[208:223], v[48:51], v[104:107], v[208:223]
    v_exp_f32 v72, v72
    v_exp_f32 v73, v73
    v_cvt_pk_bf16_f32 v97, v70, v71
    v_exp_f32 v74, v74
    v_exp_f32 v75, v75
    v_cvt_pk_bf16_f32 v98, v72, v73
    v_exp_f32 v76, v76
    v_cvt_pk_bf16_f32 v99, v74, v75
    v_exp_f32 v77, v77
    v_mfma_f32_32x32x16_bf16 v[224:239], v[44:47], v[92:95], v[224:239]
    v_exp_f32 v78, v78
    v_exp_f32 v79, v79
    v_cvt_pk_bf16_f32 v100, v76, v77
    v_exp_f32 v80, v80
    v_exp_f32 v81, v81
    v_cvt_pk_bf16_f32 v101, v78, v79
    v_exp_f32 v82, v82
    s_waitcnt vmcnt(6) lgkmcnt(2)
    ds_read_b128 v[36:39], v118 offset:0
    v_mfma_f32_32x32x16_bf16 v[60:75], v[40:43], v[4:7], 0
    v_exp_f32 v83, v83
    v_cvt_pk_bf16_f32 v102, v80, v81
    v_exp_f32 v84, v84
    v_exp_f32 v85, v85
    v_cvt_pk_bf16_f32 v103, v82, v83
    v_exp_f32 v86, v86
    v_exp_f32 v87, v87
    v_cvt_pk_bf16_f32 v104, v84, v85
    v_mfma_f32_32x32x16_bf16 v[224:239], v[48:51], v[96:99], v[224:239]
    v_exp_f32 v88, v88
    v_exp_f32 v89, v89
    v_cvt_pk_bf16_f32 v105, v86, v87
    v_exp_f32 v90, v90
    v_exp_f32 v91, v91
    v_cvt_pk_bf16_f32 v106, v88, v89
    s_cmp_eq_u32 s71, 14336
    s_cbranch_scc1 L_A_last
    v_exp_f32 v60, v60
    v_cvt_pk_bf16_f32 v107, v90, v91
    v_exp_f32 v61, v61
    v_mfma_f32_32x32x16_bf16 v[240:255], v[44:47], v[100:103], v[240:255]
    v_exp_f32 v62, v62
    v_exp_f32 v63, v63
    v_cvt_pk_bf16_f32 v92, v60, v61
    v_exp_f32 v64, v64
    v_exp_f32 v65, v65
    v_cvt_pk_bf16_f32 v93, v62, v63
    v_exp_f32 v66, v66
    v_mfma_f32_32x32x16_bf16 v[76:91], v[40:43], v[8:11], 0
    v_exp_f32 v67, v67
    v_cvt_pk_bf16_f32 v94, v64, v65
    v_exp_f32 v68, v68
    v_exp_f32 v69, v69
    v_cvt_pk_bf16_f32 v95, v66, v67
    v_exp_f32 v70, v70
    v_exp_f32 v71, v71
    v_cvt_pk_bf16_f32 v96, v68, v69
    v_mfma_f32_32x32x16_bf16 v[240:255], v[48:51], v[104:107], v[240:255]
    v_exp_f32 v72, v72
    v_exp_f32 v73, v73
    v_cvt_pk_bf16_f32 v97, v70, v71
    v_exp_f32 v74, v74
    v_exp_f32 v75, v75
    v_cvt_pk_bf16_f32 v98, v72, v73
    v_exp_f32 v76, v76
    v_cvt_pk_bf16_f32 v99, v74, v75
    v_exp_f32 v77, v77
    s_waitcnt vmcnt(5) lgkmcnt(1)
    s_mov_b64 exec, s[88:89]
    ds_read_b128 v[44:47], v119 offset:1024
    ds_read_b128 v[48:51], v119 offset:1536
    s_mov_b64 exec, -1
    v_mfma_f32_32x32x16_bf16 v[128:143], v[52:55], v[92:95], v[128:143]
    v_exp_f32 v78, v78
    v_exp_f32 v79, v79
    v_cvt_pk_bf16_f32 v100, v76, v77
    v_exp_f32 v80, v80
    v_exp_f32 v81, v81
    v_cvt_pk_bf16_f32 v101, v78, v79
    v_exp_f32 v82, v82
    v_mfma_f32_32x32x16_bf16 v[60:75], v[40:43], v[12:15], 0
    v_exp_f32 v83, v83
    v_cvt_pk_bf16_f32 v102, v80, v81
    v_exp_f32 v84, v84
    v_exp_f32 v85, v85
    v_cvt_pk_bf16_f32 v103, v82, v83
    v_exp_f32 v86, v86
    v_exp_f32 v87, v87
    v_cvt_pk_bf16_f32 v104, v84, v85
    v_mfma_f32_32x32x16_bf16 v[128:143], v[56:59], v[96:99], v[128:143]
    v_exp_f32 v88, v88
    v_exp_f32 v89, v89
    v_cvt_pk_bf16_f32 v105, v86, v87
    v_exp_f32 v90, v90
    v_exp_f32 v91, v91
    v_cvt_pk_bf16_f32 v106, v88, v89
    v_exp_f32 v60, v60
    v_cvt_pk_bf16_f32 v107, v90, v91
    v_exp_f32 v61, v61
    v_mfma_f32_32x32x16_bf16 v[144:159], v[52:55], v[100:103], v[144:159]
    v_exp_f32 v62, v62
    v_exp_f32 v63, v63
    v_cvt_pk_bf16_f32 v92, v60, v61
    v_exp_f32 v64, v64
    v_exp_f32 v65, v65
    v_cvt_pk_bf16_f32 v93, v62, v63
    v_exp_f32 v66, v66
    v_mfma_f32_32x32x16_bf16 v[76:91], v[40:43], v[16:19], 0
    v_exp_f32 v67, v67
    v_cvt_pk_bf16_f32 v94, v64, v65
    v_exp_f32 v68, v68
    v_exp_f32 v69, v69
    v_cvt_pk_bf16_f32 v95, v66, v67
    v_exp_f32 v70, v70
    v_exp_f32 v71, v71
    v_cvt_pk_bf16_f32 v96, v68, v69
    v_mfma_f32_32x32x16_bf16 v[144:159], v[56:59], v[104:107], v[144:159]
    v_exp_f32 v72, v72
    v_exp_f32 v73, v73
    v_cvt_pk_bf16_f32 v97, v70, v71
    v_exp_f32 v74, v74
    v_exp_f32 v75, v75
    v_cvt_pk_bf16_f32 v98, v72, v73
    v_exp_f32 v76, v76
    v_cvt_pk_bf16_f32 v99, v74, v75
    v_exp_f32 v77, v77
    v_mfma_f32_32x32x16_bf16 v[160:175], v[52:55], v[92:95], v[160:175]
    v_exp_f32 v78, v78
    v_exp_f32 v79, v79
    v_cvt_pk_bf16_f32 v100, v76, v77
    v_exp_f32 v80, v80
    v_exp_f32 v81, v81
    v_cvt_pk_bf16_f32 v101, v78, v79
    v_exp_f32 v82, v82
    v_mfma_f32_32x32x16_bf16 v[60:75], v[40:43], v[20:23], 0
    v_exp_f32 v83, v83
    v_cvt_pk_bf16_f32 v102, v80, v81
    v_exp_f32 v84, v84
    v_exp_f32 v85, v85
    v_cvt_pk_bf16_f32 v103, v82, v83
    v_exp_f32 v86, v86
    v_exp_f32 v87, v87
    v_cvt_pk_bf16_f32 v104, v84, v85
    v_mfma_f32_32x32x16_bf16 v[160:175], v[56:59], v[96:99], v[160:175]
    v_exp_f32 v88, v88
    v_exp_f32 v89, v89
    v_cvt_pk_bf16_f32 v105, v86, v87
    v_exp_f32 v90, v90
    v_exp_f32 v91, v91
    v_cvt_pk_bf16_f32 v106, v88, v89
    v_exp_f32 v60, v60
    v_cvt_pk_bf16_f32 v107, v90, v91
    v_exp_f32 v61, v61
    v_mfma_f32_32x32x16_bf16 v[176:191], v[52:55], v[100:103], v[176:191]
    v_exp_f32 v62, v62
    v_exp_f32 v63, v63
    v_cvt_pk_bf16_f32 v92, v60, v61
    v_exp_f32 v64, v64
    v_exp_f32 v65, v65
    v_cvt_pk_bf16_f32 v93, v62, v63
    v_exp_f32 v66, v66
    v_mfma_f32_32x32x16_bf16 v[76:91], v[40:43], v[24:27], 0
    v_exp_f32 v67, v67
    v_cvt_pk_bf16_f32 v94, v64, v65
    v_exp_f32 v68, v68
    v_exp_f32 v69, v69
    v_cvt_pk_bf16_f32 v95, v66, v67
    v_exp_f32 v70, v70
    v_exp_f32 v71, v71
    v_cvt_pk_bf16_f32 v96, v68, v69
    v_mfma_f32_32x32x16_bf16 v[176:191], v[56:59], v[104:107], v[176:191]
    v_exp_f32 v72, v72
    v_exp_f32 v73, v73
    v_cvt_pk_bf16_f32 v97, v70, v71
    v_exp_f32 v74, v74
    v_exp_f32 v75, v75
    v_cvt_pk_bf16_f32 v98, v72, v73
    v_exp_f32 v76, v76
    v_cvt_pk_bf16_f32 v99, v74, v75
    v_exp_f32 v77, v77
    v_mfma_f32_32x32x16_bf16 v[192:207], v[52:55], v[92:95], v[192:207]
    v_exp_f32 v78, v78
    v_exp_f32 v79, v79
    v_cvt_pk_bf16_f32 v100, v76, v77
    v_exp_f32 v80, v80
    v_exp_f32 v81, v81
    v_cvt_pk_bf16_f32 v101, v78, v79
    v_exp_f32 v82, v82
    v_mfma_f32_32x32x16_bf16 v[60:75], v[40:43], v[28:31], 0
    v_exp_f32 v83, v83
    v_cvt_pk_bf16_f32 v102, v80, v81
    v_exp_f32 v84, v84
    v_exp_f32 v85, v85
    v_cvt_pk_bf16_f32 v103, v82, v83
    v_exp_f32 v86, v86
    v_exp_f32 v87, v87
    v_cvt_pk_bf16_f32 v104, v84, v85
    v_mfma_f32_32x32x16_bf16 v[192:207], v[56:59], v[96:99], v[192:207]
    v_exp_f32 v88, v88
    v_exp_f32 v89, v89
    v_cvt_pk_bf16_f32 v105, v86, v87
    v_exp_f32 v90, v90
    v_exp_f32 v91, v91
    v_cvt_pk_bf16_f32 v106, v88, v89
    v_exp_f32 v60, v60
    v_cvt_pk_bf16_f32 v107, v90, v91
    v_exp_f32 v61, v61
    v_mfma_f32_32x32x16_bf16 v[208:223], v[52:55], v[100:103], v[208:223]
    v_exp_f32 v62, v62
    v_exp_f32 v63, v63
    v_cvt_pk_bf16_f32 v92, v60, v61
    v_exp_f32 v64, v64
    v_exp_f32 v65, v65
    v_cvt_pk_bf16_f32 v93, v62, v63
    v_exp_f32 v66, v66
    v_mfma_f32_32x32x16_bf16 v[76:91], v[40:43], v[32:35], 0
    v_exp_f32 v67, v67
    v_cvt_pk_bf16_f32 v94, v64, v65
    v_exp_f32 v68, v68
    v_exp_f32 v69, v69
    v_cvt_pk_bf16_f32 v95, v66, v67
    v_exp_f32 v70, v70
    v_exp_f32 v71, v71
    v_cvt_pk_bf16_f32 v96, v68, v69
    v_mfma_f32_32x32x16_bf16 v[208:223], v[56:59], v[104:107], v[208:223]
    v_exp_f32 v72, v72
    v_exp_f32 v73, v73
    v_cvt_pk_bf16_f32 v97, v70, v71
    v_exp_f32 v74, v74
    v_exp_f32 v75, v75
    v_cvt_pk_bf16_f32 v98, v72, v73
    v_exp_f32 v76, v76
    v_cvt_pk_bf16_f32 v99, v74, v75
    v_exp_f32 v77, v77
    v_mfma_f32_32x32x16_bf16 v[224:239], v[52:55], v[92:95], v[224:239]
    v_exp_f32 v78, v78
    v_exp_f32 v79, v79
    v_cvt_pk_bf16_f32 v100, v76, v77
    v_exp_f32 v80, v80
    v_exp_f32 v81, v81
    v_cvt_pk_bf16_f32 v101, v78, v79
    v_exp_f32 v82, v82
    s_waitcnt vmcnt(4) lgkmcnt(2)
    ds_read_b128 v[40:43], v118 offset:1024
    v_mfma_f32_32x32x16_bf16 v[60:75], v[36:39], v[4:7], 0
    v_exp_f32 v83, v83
    v_cvt_pk_bf16_f32 v102, v80, v81
    v_exp_f32 v84, v84
    v_exp_f32 v85, v85
    v_cvt_pk_bf16_f32 v103, v82, v83
    v_exp_f32 v86, v86
    v_exp_f32 v87, v87
    v_cvt_pk_bf16_f32 v104, v84, v85
    v_mfma_f32_32x32x16_bf16 v[224:239], v[56:59], v[96:99], v[224:239]
    v_exp_f32 v88, v88
    v_exp_f32 v89, v89
    v_cvt_pk_bf16_f32 v105, v86, v87
    v_exp_f32 v90, v90
    v_exp_f32 v91, v91
    v_cvt_pk_bf16_f32 v106, v88, v89
    s_add_u32 s71, s71, 2048
    s_and_b32 s60, s71, 0x1fff
    v_add_u32 v119, s60, v114
    v_add_u32 v118, s60, v117
    s_and_b32 s60, s71, 0xfff
    s_waitcnt vmcnt(0)
    s_cbranch_scc1 L_A_loop
    s_mov_b64 exec, 1
    ds_add_u32 v120, v110 offset:16
    s_mov_b64 exec, -1
    s_lshr_b32 s61, s71, 12
L_pl_5:
    ds_read_b32 v121, v120 offset:32
    s_waitcnt lgkmcnt(0)
    v_cmp_le_u32 vcc, s61, v121
    s_cbranch_vccnz L_pld_6
    s_sub_u32 s70, s70, 1
    s_cbranch_scc1 L_pld_6_x
    s_sleep 1
    s_branch L_pl_5
L_pld_6_x:
    s_mov_b32 s70, 0
L_pld_6:
    s_branch L_A_loop
L_A_last:
    v_exp_f32 v60, v60
    v_cvt_pk_bf16_f32 v107, v90, v91
    v_exp_f32 v61, v61
    v_mfma_f32_32x32x16_bf16 v[240:255], v[44:47], v[100:103], v[240:255]
    v_exp_f32 v62, v62
    v_exp_f32 v63, v63
    v_cvt_pk_bf16_f32 v92, v60, v61
    v_exp_f32 v64, v64
    v_exp_f32 v65, v65
    v_cvt_pk_bf16_f32 v93, v62, v63
    v_exp_f32 v66, v66
    v_mfma_f32_32x32x16_bf16 v[76:91], v[40:43], v[8:11], 0
    v_exp_f32 v67, v67
    v_cvt_pk_bf16_f32 v94, v64, v65
    v_exp_f32 v68, v68
    v_exp_f32 v69, v69
    v_cvt_pk_bf16_f32 v95, v66, v67
    v_exp_f32 v70, v70
    v_exp_f32 v71, v71
    v_cvt_pk_bf16_f32 v96, v68, v69
    v_mfma_f32_32x32x16_bf16 v[240:255], v[48:51], v[104:107], v[240:255]
    v_exp_f32 v72, v72
    v_exp_f32 v73, v73
    v_cvt_pk_bf16_f32 v97, v70, v71
    v_exp_f32 v74, v74
    v_exp_f32 v75, v75
    v_cvt_pk_bf16_f32 v98, v72, v73
    v_exp_f32 v76, v76
    v_cvt_pk_bf16_f32 v99, v74, v75
    v_exp_f32 v77, v77
    s_waitcnt lgkmcnt(0)
    v_mfma_f32_32x32x16_bf16 v[128:143], v[52:55], v[92:95], v[128:143]
    v_exp_f32 v78, v78
    v_exp_f32 v79, v79
    v_cvt_pk_bf16_f32 v100, v76, v77
    v_exp_f32 v80, v80
    v_exp_f32 v81, v81
    v_cvt_pk_bf16_f32 v101, v78, v79
    v_exp_f32 v82, v82
    v_mfma_f32_32x32x16_bf16 v[60:75], v[40:43], v[12:15], 0
    v_exp_f32 v83, v83
    v_cvt_pk_bf16_f32 v102, v80, v81
    v_exp_f32 v84, v84
    v_exp_f32 v85, v85
    v_cvt_pk_bf16_f32 v103, v82, v83
    v_exp_f32 v86, v86
    v_exp_f32 v87, v87
    v_cvt_pk_bf16_f32 v104, v84, v85
    v_mfma_f32_32x32x16_bf16 v[128:143], v[56:59], v[96:99], v[128:143]
    v_exp_f32 v88, v88
    v_exp_f32 v89, v89
    v_cvt_pk_bf16_f32 v105, v86, v87
    v_exp_f32 v90, v90
    v_exp_f32 v91, v91
    v_cvt_pk_bf16_f32 v106, v88, v89
    v_exp_f32 v60, v60
    v_cvt_pk_bf16_f32 v107, v90, v91
    v_exp_f32 v61, v61
    v_mfma_f32_32x32x16_bf16 v[144:159], v[52:55], v[100:103], v[144:159]
    v_exp_f32 v62, v62
    v_exp_f32 v63, v63
    v_cvt_pk_bf16_f32 v92, v60, v61
    ds_write_b128 v112, v[128:131] offset:0
    v_exp_f32 v64, v64
    v_exp_f32 v65, v65
    v_cvt_pk_bf16_f32 v93, v62, v63
    v_exp_f32 v66, v66
    v_mfma_f32_32x32x16_bf16 v[76:91], v[40:43], v[16:19], 0
    v_exp_f32 v67, v67
    v_cvt_pk_bf16_f32 v94, v64, v65
    v_exp_f32 v68, v68
    ds_write_b128 v112, v[132:135] offset:1024
    v_exp_f32 v69, v69
    v_cvt_pk_bf16_f32 v95, v66, v67
    v_exp_f32 v70, v70
    v_exp_f32 v71, v71
    v_cvt_pk_bf16_f32 v96, v68, v69
    v_mfma_f32_32x32x16_bf16 v[144:159], v[56:59], v[104:107], v[144:159]
    v_exp_f32 v72, v72
    v_exp_f32 v73, v73
    v_cvt_pk_bf16_f32 v97, v70, v71
    ds_write_b32 v1, v136 offset:0
    v_exp_f32 v74, v74
    v_exp_f32 v75, v75
    v_cvt_pk_bf16_f32 v98, v72, v73
    v_exp_f32 v76, v76
    v_cvt_pk_bf16_f32 v99, v74, v75
    v_exp_f32 v77, v77
    v_mfma_f32_32x32x16_bf16 v[160:175], v[52:55], v[92:95], v[160:175]
    v_exp_f32 v78, v78
    v_exp_f32 v79, v79
    v_cvt_pk_bf16_f32 v100, v76, v77
    ds_write_b128 v112, v[144:147] offset:2304
    v_exp_f32 v80, v80
    v_exp_f32 v81, v81
    v_cvt_pk_bf16_f32 v101, v78, v79
    v_exp_f32 v82, v82
    v_mfma_f32_32x32x16_bf16 v[60:75], v[40:43], v[20:23], 0
    v_exp_f32 v83, v83
    v_cvt_pk_bf16_f32 v102, v80, v81
    v_exp_f32 v84, v84
    ds_write_b128 v112, v[148:151] offset:3328
    v_exp_f32 v85, v85
    v_cvt_pk_bf16_f32 v103, v82, v83
    v_exp_f32 v86, v86
    v_exp_f32 v87, v87
    v_cvt_pk_bf16_f32 v104, v84, v85
    v_mfma_f32_32x32x16_bf16 v[160:175], v[56:59], v[96:99], v[160:175]
    v_exp_f32 v88, v88
    v_exp_f32 v89, v89
    v_cvt_pk_bf16_f32 v105, v86, v87
    ds_write_b32 v1, v152 offset:2304
    v_exp_f32 v90, v90
    v_exp_f32 v91, v91
    v_cvt_pk_bf16_f32 v106, v88, v89
    v_exp_f32 v60, v60
    v_cvt_pk_bf16_f32 v107, v90, v91
    v_exp_f32 v61, v61
    v_mfma_f32_32x32x16_bf16 v[176:191], v[52:55], v[100:103], v[176:191]
    v_exp_f32 v62, v62
    v_exp_f32 v63, v63
    v_cvt_pk_bf16_f32 v92, v60, v61
    ds_write_b128 v112, v[160:163] offset:4608
    v_exp_f32 v64, v64
    v_exp_f32 v65, v65
    v_cvt_pk_bf16_f32 v93, v62, v63
    v_exp_f32 v66, v66
    v_mfma_f32_32x32x16_bf16 v[76:91], v[40:43], v[24:27], 0
    v_exp_f32 v67, v67
    v_cvt_pk_bf16_f32 v94, v64, v65
    v_exp_f32 v68, v68
    ds_write_b128 v112, v[164:167] offset:5632
    v_exp_f32 v69, v69
    v_cvt_pk_bf16_f32 v95, v66, v67
    v_exp_f32 v70, v70
    v_exp_f32 v71, v71
    v_cvt_pk_bf16_f32 v96, v68, v69
    v_mfma_f32_32x32x16_bf16 v[176:191], v[56:59], v[104:107], v[176:191]
    v_exp_f32 v72, v72
    v_exp_f32 v73, v73
    v_cvt_pk_bf16_f32 v97, v70, v71
    ds_write_b32 v1, v168 offset:4608
    v_exp_f32 v74, v74
    v_exp_f32 v75, v75
    v_cvt_pk_bf16_f32 v98, v72, v73
    v_exp_f32 v76, v76
    v_cvt_pk_bf16_f32 v99, v74, v75
    v_exp_f32 v77, v77
    v_mfma_f32_32x32x16_bf16 v[192:207], v[52:55], v[92:95], v[192:207]
    v_exp_f32 v78, v78
    v_exp_f32 v79, v79
    v_cvt_pk_bf16_f32 v100, v76, v77
    ds_write_b128 v112, v[176:179] offset:6912
    v_exp_f32 v80, v80
    v_exp_f32 v81, v81
    v_cvt_pk_bf16_f32 v101, v78, v79
    v_exp_f32 v82, v82
    v_mfma_f32_32x32x16_bf16 v[60:75], v[40:43], v[28:31], 0
    v_exp_f32 v83, v83
    v_cvt_pk_bf16_f32 v102, v80, v81
    v_exp_f32 v84, v84
    ds_write_b128 v112, v[180:183] offset:7936
    v_exp_f32 v85, v85
    v_cvt_pk_bf16_f32 v103, v82, v83
    v_exp_f32 v86, v86
    v_exp_f32 v87, v87
    v_cvt_pk_bf16_f32 v104, v84, v85
    v_mfma_f32_32x32x16_bf16 v[192:207], v[56:59], v[96:99], v[192:207]
    v_exp_f32 v88, v88
    v_exp_f32 v89, v89
    v_cvt_pk_bf16_f32 v105, v86, v87
    ds_write_b32 v1, v184 offset:6912
    v_exp_f32 v90, v90
    v_exp_f32 v91, v91
    v_cvt_pk_bf16_f32 v106, v88, v89
    v_exp_f32 v60, v60
    v_cvt_pk_bf16_f32 v107, v90, v91
    v_exp_f32 v61, v61
    v_mfma_f32_32x32x16_bf16 v[208:223], v[52:55], v[100:103], v[208:223]
    v_exp_f32 v62, v62
    v_exp_f32 v63, v63
    v_cvt_pk_bf16_f32 v92, v60, v61
    ds_write_b128 v112, v[192:195] offset:9216
    v_exp_f32 v64, v64
    v_exp_f32 v65, v65
    v_cvt_pk_bf16_f32 v93, v62, v63
    v_exp_f32 v66, v66
    v_mfma_f32_32x32x16_bf16 v[76:91], v[40:43], v[32:35], 0
    v_exp_f32 v67, v67
    v_cvt_pk_bf16_f32 v94, v64, v65
    v_exp_f32 v68, v68
    ds_write_b128 v112, v[196:199] offset:10240
    v_exp_f32 v69, v69
    v_cvt_pk_bf16_f32 v95, v66, v67
    v_exp_f32 v70, v70
    v_exp_f32 v71, v71
    v_cvt_pk_bf16_f32 v96, v68, v69
    v_mfma_f32_32x32x16_bf16 v[208:223], v[56:59], v[104:107], v[208:223]
    v_exp_f32 v72, v72
    v_exp_f32 v73, v73
    v_cvt_pk_bf16_f32 v97, v70, v71
    ds_write_b32 v1, v200 offset:9216
    v_exp_f32 v74, v74
    v_exp_f32 v75, v75
    v_cvt_pk_bf16_f32 v98, v72, v73
    v_exp_f32 v76, v76
    v_cvt_pk_bf16_f32 v99, v74, v75
    v_exp_f32 v77, v77
    v_mfma_f32_32x32x16_bf16 v[224:239], v[52:55], v[92:95], v[224:239]
    v_exp_f32 v78, v78
    v_exp_f32 v79, v79
    v_cvt_pk_bf16_f32 v100, v76, v77
    ds_write_b128 v112, v[208:211] offset:11520
    v_exp_f32 v80, v80
    v_exp_f32 v81, v81
    v_cvt_pk_bf16_f32 v101, v78, v79
    v_exp_f32 v82, v82
    v_exp_f32 v83, v83
    v_cvt_pk_bf16_f32 v102, v80, v81
    v_exp_f32 v84, v84
    ds_write_b128 v112, v[212:215] offset:12544
    v_exp_f32 v85, v85
    v_cvt_pk_bf16_f32 v103, v82, v83
    v_exp_f32 v86, v86
    v_exp_f32 v87, v87
    v_cvt_pk_bf16_f32 v104, v84, v85
    v_mfma_f32_32x32x16_bf16 v[224:239], v[56:59], v[96:99], v[224:239]
    v_exp_f32 v88, v88
    v_exp_f32 v89, v89
    v_cvt_pk_bf16_f32 v105, v86, v87
    ds_write_b32 v1, v216 offset:11520
    s_mov_b64 exec, 1
    ds_add_u32 v109, v110 offset:12
    s_mov_b64 exec, -1
    v_exp_f32 v90, v90
    v_exp_f32 v91, v91
    v_cvt_pk_bf16_f32 v106, v88, v89
    v_cvt_pk_bf16_f32 v107, v90, v91
    v_mfma_f32_32x32x16_bf16 v[240:255], v[52:55], v[100:103], v[240:255]
    s_nop 0
    v_mfma_f32_32x32x16_bf16 v[240:255], v[56:59], v[104:107], v[240:255]
L_A_red:
    v_lshlrev_b32 v121, 2, v0
    s_sub_u32 s60, s56, 1
    s_and_b32 s60, s60, 3
    s_mul_i32 s60, s60, 16384
    s_add_u32 s60, s60, 0
    v_add_u32 v114, s60, v108
    s_add_u32 s60, s60, 2048
    v_add_u32 v117, s60, v121
    s_sub_u32 s60, s56, 2
    s_and_b32 s60, s60, 3
    s_mul_i32 s60, s60, 16384
    s_add_u32 s60, s60, 4608
    v_add_u32 v115, s60, v108
    s_add_u32 s60, s60, 2048
    v_add_u32 v118, s60, v121
    s_sub_u32 s60, s56, 3
    s_and_b32 s60, s60, 3
    s_mul_i32 s60, s60, 16384
    s_add_u32 s60, s60, 9216
    v_add_u32 v116, s60, v108
    s_add_u32 s60, s60, 2048
    v_add_u32 v119, s60, v121
    s_lshl_b32 s60, s80, 2
    s_add_u32 s60, s60, s56
    s_lshl_b32 s60, s60, 3
    v_mov_b32 v123, s60
L_pl_7:
    ds_read_b32 v122, v109 offset:12
    s_waitcnt lgkmcnt(0)
    v_cmp_le_u32 vcc, 4, v122
    s_cbranch_vccnz L_pld_8
    s_sub_u32 s70, s70, 1
    s_cbranch_scc1 L_pld_8_x
    s_sleep 1
    s_branch L_pl_7
L_pld_8_x:
    s_mov_b32 s70, 0
L_pld_8:
    ds_read_b128 v[128:131], v114 offset:0
    ds_read_b128 v[132:135], v114 offset:1024
    ds_read_b32 v136, v117 offset:0
    ds_read_b128 v[140:143], v114 offset:2304
    ds_read_b128 v[144:147], v114 offset:3328
    ds_read_b32 v148, v117 offset:2304
    ds_read_b128 v[152:155], v115 offset:0
    ds_read_b128 v[156:159], v115 offset:1024
    ds_read_b32 v160, v118 offset:0
    ds_read_b128 v[164:167], v115 offset:2304
    ds_read_b128 v[168:171], v115 offset:3328
    ds_read_b32 v172, v118 offset:2304
    ds_read_b128 v[176:179], v116 offset:0
    ds_read_b128 v[180:183], v116 offset:1024
    ds_read_b32 v184, v119 offset:0
    ds_read_b128 v[188:191], v116 offset:2304
    ds_read_b128 v[192:195], v116 offset:3328
    ds_read_b32 v196, v119 offset:2304
    s_waitcnt lgkmcnt(12)
    v_pk_add_f32 v[224:225], v[224:225], v[128:129]
    v_pk_add_f32 v[226:227], v[226:227], v[130:131]
    v_pk_add_f32 v[228:229], v[228:229], v[132:133]
    v_pk_add_f32 v[230:231], v[230:231], v[134:135]
    v_add_f32 v232, v232, v136
    v_pk_add_f32 v[240:241], v[240:241], v[140:141]
    v_pk_add_f32 v[242:243], v[242:243], v[142:143]
    v_pk_add_f32 v[244:245], v[244:245], v[144:145]
    v_pk_add_f32 v[246:247], v[246:247], v[146:147]
    v_add_f32 v248, v248, v148
    s_waitcnt lgkmcnt(6)
    v_pk_add_f32 v[224:225], v[224:225], v[152:153]
    v_pk_add_f32 v[226:227], v[226:227], v[154:155]
    v_pk_add_f32 v[228:229], v[228:229], v[156:157]
    v_pk_add_f32 v[230:231], v[230:231], v[158:159]
    v_add_f32 v232, v232, v160
    v_pk_add_f32 v[240:241], v[240:241], v[164:165]
    v_pk_add_f32 v[242:243], v[242:243], v[166:167]
    v_pk_add_f32 v[244:245], v[244:245], v[168:169]
    v_pk_add_f32 v[246:247], v[246:247], v[170:171]
    v_add_f32 v248, v248, v172
    s_waitcnt lgkmcnt(0)
    v_pk_add_f32 v[224:225], v[224:225], v[176:177]
    v_pk_add_f32 v[226:227], v[226:227], v[178:179]
    v_pk_add_f32 v[228:229], v[228:229], v[180:181]
    v_pk_add_f32 v[230:231], v[230:231], v[182:183]
    v_add_f32 v232, v232, v184
    v_pk_add_f32 v[240:241], v[240:241], v[188:189]
    v_pk_add_f32 v[242:243], v[242:243], v[190:191]
    v_pk_add_f32 v[244:245], v[244:245], v[192:193]
    v_pk_add_f32 v[246:247], v[246:247], v[194:195]
    v_add_f32 v248, v248, v196
    v_cmp_le_f32 vcc, 0x2b800000, v232
    s_mov_b32 s60, vcc_lo
    v_cmp_ge_f32 vcc, 0x53800000, v232
    s_and_b32 s60, s60, vcc_lo
    v_cmp_le_f32 vcc, 0x2b800000, v248
    s_and_b32 s60, s60, vcc_lo
    v_cmp_ge_f32 vcc, 0x53800000, v248
    s_and_b32 s60, s60, vcc_lo
    s_cmp_eq_u32 s60, -1
    s_cbranch_scc0 L_A_slow
L_A_fin:
    v_mov_b32 v233, v232
    v_mov_b32 v249, v248
    s_nop 0
    v_permlane32_swap_b32 v232, v233
    v_permlane32_swap_b32 v248, v249
    v_add_f32 v232, v232, v233
    v_add_f32 v248, v248, v249
    v_rcp_f32 v122, v232
    v_rcp_f32 v124, v248
    s_nop 0
    v_pk_mul_f32 v[224:225], v[224:225], v[122:123] op_sel_hi:[1,0]
    v_pk_mul_f32 v[226:227], v[226:227], v[122:123] op_sel_hi:[1,0]
    v_pk_mul_f32 v[228:229], v[228:229], v[122:123] op_sel_hi:[1,0]
    v_pk_mul_f32 v[230:231], v[230:231], v[122:123] op_sel_hi:[1,0]
    v_cvt_pk_bf16_f32 v60, v224, v225
    v_cvt_pk_bf16_f32 v61, v226, v227
    v_cvt_pk_bf16_f32 v62, v228, v229
    v_cvt_pk_bf16_f32 v63, v230, v231
    buffer_store_dwordx4 v[60:63], v108, s[32:35], s76 offen offset:0 sc1
    v_pk_mul_f32 v[240:241], v[240:241], v[124:125] op_sel_hi:[1,0]
    v_pk_mul_f32 v[242:243], v[242:243], v[124:125] op_sel_hi:[1,0]
    v_pk_mul_f32 v[244:245], v[244:245], v[124:125] op_sel_hi:[1,0]
    v_pk_mul_f32 v[246:247], v[246:247], v[124:125] op_sel_hi:[1,0]
    v_cvt_pk_bf16_f32 v64, v240, v241
    v_cvt_pk_bf16_f32 v65, v242, v243
    v_cvt_pk_bf16_f32 v66, v244, v245
    v_cvt_pk_bf16_f32 v67, v246, v247
    buffer_store_dwordx4 v[64:67], v108, s[32:35], s76 offen offset:1024 sc1
    s_mov_b64 exec, 1
    ds_add_u32 v109, v110 offset:48
    s_mov_b64 exec, -1
    s_or_b32 s60, s80, s56
    s_cmp_lg_u32 s60, 0
    s_cbranch_scc1 L_A_noep
    v_mov_b32 v70, s72
    v_mov_b32 v71, 167936
    s_mov_b64 exec, 1
    buffer_store_dword v70, v71, s[32:35], 0 offen sc1
    s_mov_b64 exec, -1
L_A_noep:
    s_endpgm
L_A_slow:
    s_waitcnt vmcnt(0)
    v_mov_b32 v124, 0xff7fffff
    v_mov_b32 v125, 0xff7fffff
    v_mov_b32 v224, 0
    v_mov_b32 v225, 0
    v_mov_b32 v226, 0
    v_mov_b32 v227, 0
    v_mov_b32 v228, 0
    v_mov_b32 v229, 0
    v_mov_b32 v230, 0
    v_mov_b32 v231, 0
    v_mov_b32 v232, 0
    v_mov_b32 v233, 0
    v_mov_b32 v234, 0
    v_mov_b32 v235, 0
    v_mov_b32 v236, 0
    v_mov_b32 v237, 0
    v_mov_b32 v238, 0
    v_mov_b32 v239, 0
    v_mov_b32 v240, 0
    v_mov_b32 v241, 0
    v_mov_b32 v242, 0
    v_mov_b32 v243, 0
    v_mov_b32 v244, 0
    v_mov_b32 v245, 0
    v_mov_b32 v246, 0
    v_mov_b32 v247, 0
    v_mov_b32 v248, 0
    v_mov_b32 v249, 0
    v_mov_b32 v250, 0
    v_mov_b32 v251, 0
    v_mov_b32 v252, 0
    v_mov_b32 v253, 0
    v_mov_b32 v254, 0
    v_mov_b32 v255, 0
    s_mov_b32 s60, 0
    s_mov_b32 s61, 65536
L_A_sloop:
    buffer_load_dwordx4 v[36:39], v108, s[32:35], s60 offen sc1
    s_mov_b64 exec, s[88:89]
    buffer_load_dwordx4 v[44:47], v113, s[32:35], s61 offen sc1
    buffer_load_dwordx4 v[48:51], v113, s[32:35], s61 offen offset:512 sc1
    s_mov_b64 exec, -1
    s_add_u32 s60, s60, 1024
    s_add_u32 s61, s61, 1024
    s_waitcnt vmcnt(0)
    v_mfma_f32_32x32x16_bf16 v[60:75], v[36:39], v[28:31], 0
    v_mfma_f32_32x32x16_bf16 v[76:91], v[36:39], v[32:35], 0
    s_nop 15
    v_max3_f32 v121, v60, v61, v124
    v_max3_f32 v121, v62, v63, v121
    v_max3_f32 v121, v64, v65, v121
    v_max3_f32 v121, v66, v67, v121
    v_max3_f32 v121, v68, v69, v121
    v_max3_f32 v121, v70, v71, v121
    v_max3_f32 v121, v72, v73, v121
    v_max3_f32 v121, v74, v75, v121
    v_mov_b32 v122, v121
    s_nop 1
    v_permlane32_swap_b32 v121, v122
    v_max_f32 v121, v121, v122
    v_sub_f32 v122, v124, v121
    v_exp_f32 v122, v122
    v_mov_b32 v124, v121
    v_sub_f32 v60, v60, v121
    v_sub_f32 v61, v61, v121
    v_sub_f32 v62, v62, v121
    v_sub_f32 v63, v63, v121
    v_sub_f32 v64, v64, v121
    v_sub_f32 v65, v65, v121
    v_sub_f32 v66, v66, v121
    v_sub_f32 v67, v67, v121
    v_sub_f32 v68, v68, v121
    v_sub_f32 v69, v69, v121
    v_sub_f32 v70, v70, v121
    v_sub_f32 v71, v71, v121
    v_sub_f32 v72, v72, v121
    v_sub_f32 v73, v73, v121
    v_sub_f32 v74, v74, v121
    v_sub_f32 v75, v75, v121
    v_exp_f32 v60, v60
    v_exp_f32 v61, v61
    v_exp_f32 v62, v62
    v_exp_f32 v63, v63
    v_exp_f32 v64, v64
    v_exp_f32 v65, v65
    v_exp_f32 v66, v66
    v_exp_f32 v67, v67
    v_exp_f32 v68, v68
    v_exp_f32 v69, v69
    v_exp_f32 v70, v70
    v_exp_f32 v71, v71
    v_exp_f32 v72, v72
    v_exp_f32 v73, v73
    v_exp_f32 v74, v74
    v_exp_f32 v75, v75
    v_mul_f32 v224, v122, v224
    v_mul_f32 v225, v122, v225
    v_mul_f32 v226, v122, v226
    v_mul_f32 v227, v122, v227
    v_mul_f32 v228, v122, v228
    v_mul_f32 v229, v122, v229
    v_mul_f32 v230, v122, v230
    v_mul_f32 v231, v122, v231
    v_mul_f32 v232, v122, v232
    v_mul_f32 v233, v122, v233
    v_mul_f32 v234, v122, v234
    v_mul_f32 v235, v122, v235
    v_mul_f32 v236, v122, v236
    v_mul_f32 v237, v122, v237
    v_mul_f32 v238, v122, v238
    v_mul_f32 v239, v122, v239
    v_cvt_pk_bf16_f32 v92, v60, v61
    v_cvt_pk_bf16_f32 v93, v62, v63
    v_cvt_pk_bf16_f32 v94, v64, v65
    v_cvt_pk_bf16_f32 v95, v66, v67
    v_cvt_pk_bf16_f32 v96, v68, v69
    v_cvt_pk_bf16_f32 v97, v70, v71
    v_cvt_pk_bf16_f32 v98, v72, v73
    v_cvt_pk_bf16_f32 v99, v74, v75
    s_nop 1
    v_mfma_f32_32x32x16_bf16 v[224:239], v[44:47], v[92:95], v[224:239]
    v_mfma_f32_32x32x16_bf16 v[224:239], v[48:51], v[96:99], v[224:239]
    v_max3_f32 v121, v76, v77, v125
    v_max3_f32 v121, v78, v79, v121
    v_max3_f32 v121, v80, v81, v121
    v_max3_f32 v121, v82, v83, v121
    v_max3_f32 v121, v84, v85, v121
    v_max3_f32 v121, v86, v87, v121
    v_max3_f32 v121, v88, v89, v121
    v_max3_f32 v121, v90, v91, v121
    v_mov_b32 v122, v121
    s_nop 1
    v_permlane32_swap_b32 v121, v122
    v_max_f32 v121, v121, v122
    v_sub_f32 v122, v125, v121
    v_exp_f32 v122, v122
    v_mov_b32 v125, v121
    v_sub_f32 v76, v76, v121
    v_sub_f32 v77, v77, v121
    v_sub_f32 v78, v78, v121
    v_sub_f32 v79, v79, v121
    v_sub_f32 v80, v80, v121
    v_sub_f32 v81, v81, v121
    v_sub_f32 v82, v82, v121
    v_sub_f32 v83, v83, v121
    v_sub_f32 v84, v84, v121
    v_sub_f32 v85, v85, v121
    v_sub_f32 v86, v86, v121
    v_sub_f32 v87, v87, v121
    v_sub_f32 v88, v88, v121
    v_sub_f32 v89, v89, v121
    v_sub_f32 v90, v90, v121
    v_sub_f32 v91, v91, v121
    v_exp_f32 v76, v76
    v_exp_f32 v77, v77
    v_exp_f32 v78, v78
    v_exp_f32 v79, v79
    v_exp_f32 v80, v80
    v_exp_f32 v81, v81
    v_exp_f32 v82, v82
    v_exp_f32 v83, v83
    v_exp_f32 v84, v84
    v_exp_f32 v85, v85
    v_exp_f32 v86, v86
    v_exp_f32 v87, v87
    v_exp_f32 v88, v88
    v_exp_f32 v89, v89
    v_exp_f32 v90, v90
    v_exp_f32 v91, v91
    v_mul_f32 v240, v122, v240
    v_mul_f32 v241, v122, v241
    v_mul_f32 v242, v122, v242
    v_mul_f32 v243, v122, v243
    v_mul_f32 v244, v122, v244
    v_mul_f32 v245, v122, v245
    v_mul_f32 v246, v122, v246
    v_mul_f32 v247, v122, v247
    v_mul_f32 v248, v122, v248
    v_mul_f32 v249, v122, v249
    v_mul_f32 v250, v122, v250
    v_mul_f32 v251, v122, v251
    v_mul_f32 v252, v122, v252
    v_mul_f32 v253, v122, v253
    v_mul_f32 v254, v122, v254
    v_mul_f32 v255, v122, v255
    v_cvt_pk_bf16_f32 v100, v76, v77
    v_cvt_pk_bf16_f32 v101, v78, v79
    v_cvt_pk_bf16_f32 v102, v80, v81
    v_cvt_pk_bf16_f32 v103, v82, v83
    v_cvt_pk_bf16_f32 v104, v84, v85
    v_cvt_pk_bf16_f32 v105, v86, v87
    v_cvt_pk_bf16_f32 v106, v88, v89
    v_cvt_pk_bf16_f32 v107, v90, v91
    s_nop 1
    v_mfma_f32_32x32x16_bf16 v[240:255], v[44:47], v[100:103], v[240:255]
    v_mfma_f32_32x32x16_bf16 v[240:255], v[48:51], v[104:107], v[240:255]
    s_nop 15
    s_cmp_lt_u32 s60, 65536
    s_cbranch_scc1 L_A_sloop
    s_branch L_A_fin
L_G:
    s_and_b32 s60, s2, 7
    s_lshr_b32 s61, s2, 3
    s_lshr_b32 s62, s60, 1
    s_lshl_b32 s62, s62, 2
    s_lshr_b32 s63, s61, 3
    s_or_b32 s58, s62, s63
    s_and_b32 s62, s60, 1
    s_lshl_b32 s62, s62, 3
    s_and_b32 s63, s61, 7
    s_or_b32 s59, s62, s63
    s_and_b32 s57, s56, 3
    s_lshl_b32 s80, s58, 4
    s_or_b32 s80, s80, s59
    s_mov_b32 s70, 100000
    s_mov_b32 s84, 0
    s_mov_b32 s85, -1
    s_mov_b32 s88, 0xffff
    s_mov_b32 s89, 0xffff
    s_add_u32 s90, s59, 0
    s_and_b32 s90, s90, 3
    s_add_u32 s91, s59, 1
    s_and_b32 s91, s91, 3
    s_add_u32 s92, s59, 2
    s_and_b32 s92, s92, 3
    s_add_u32 s93, s59, 3
    s_and_b32 s93, s93, 3
    s_waitcnt lgkmcnt(0)
    s_mov_b32 s28, s4
    s_and_b32 s29, s5, 0xffff
    s_mov_b32 s30, 0x200000
    s_mov_b32 s31, 0x20000
    s_mov_b32 s32, s26
    s_and_b32 s33, s27, 0xffff
    s_mov_b32 s34, 0xb00000
    s_mov_b32 s35, 0x20000
    s_and_b32 s60, s57, 1
    s_cmp_eq_u32 s60, 0
    s_cselect_b32 s62, s16, s18
    s_cselect_b32 s63, s17, s19
    s_mov_b32 s36, s62
    s_and_b32 s37, s63, 0xffff
    s_mov_b32 s38, 0x1c0000
    s_mov_b32 s39, 0x20000
    s_mov_b32 s40, s20
    s_and_b32 s41, s21, 0xffff
    s_mov_b32 s42, 0x1c0000
    s_mov_b32 s43, 0x20000
    s_mov_b32 s44, s12
    s_and_b32 s45, s13, 0xffff
    s_mov_b32 s46, 0x80000
    s_mov_b32 s47, 0x20000
    s_mov_b32 s48, s22
    s_and_b32 s49, s23, 0xffff
    s_mov_b32 s50, 0x200000
    s_mov_b32 s51, 0x20000
    v_lshrrev_b32 v6, 4, v0
    v_and_b32 v7, 15, v0
    v_xor_b32 v7, v7, v6
    v_lshlrev_b32 v7, 4, v7
    v_lshl_add_u32 v2, v6, 10, v7
    v_xor_b32 v3, 0x40, v2
    v_xor_b32 v4, 0x80, v2
    v_xor_b32 v5, 0xc0, v2
    s_lshl_b32 s60, s58, 2
    s_add_u32 s60, s60, s57
    s_lshl_b32 s76, s60, 15
    s_lshl_b32 s77, s57, 15
    s_lshl_b32 s52, s90, 8
    s_add_u32 s52, s52, s76
    s_lshl_b32 s53, s91, 8
    s_add_u32 s53, s53, s76
    s_lshl_b32 s54, s92, 8
    s_add_u32 s54, s54, s76
    s_lshl_b32 s55, s93, 8
    s_add_u32 s55, s55, s76
    v_and_b32 v6, 31, v0
    v_lshrrev_b32 v7, 5, v0
    v_and_b32 v8, 15, v0
    v_xor_b32 v8, v8, v7
    v_lshlrev_b32 v8, 4, v8
    v_lshl_add_u32 v8, v6, 8, v8
    s_lshl_b32 s60, s57, 15
    v_add_u32 v8, s60, v8
    v_xor_b32 v9, 0x20, v8
    v_xor_b32 v10, 0x40, v8
    v_xor_b32 v11, 0x60, v8
    v_xor_b32 v23, 0x80, v8
    v_xor_b32 v13, 0xa0, v8
    v_xor_b32 v14, 0xc0, v8
    v_xor_b32 v15, 0xe0, v8
    s_add_u32 m0, s77, 0
    s_add_u32 s60, s52, 0
    buffer_load_dwordx4 v2, s[28:31], s60 offen lds
    s_add_u32 m0, s77, 1024
    s_add_u32 s60, s52, 4096
    buffer_load_dwordx4 v3, s[28:31], s60 offen lds
    s_add_u32 m0, s77, 2048
    s_add_u32 s60, s52, 8192
    buffer_load_dwordx4 v4, s[28:31], s60 offen lds
    s_add_u32 m0, s77, 3072
    s_add_u32 s60, s52, 12288
    buffer_load_dwordx4 v5, s[28:31], s60 offen lds
    s_add_u32 m0, s77, 4096
    s_add_u32 s60, s52, 16384
    buffer_load_dwordx4 v2, s[28:31], s60 offen lds
    s_add_u32 m0, s77, 5120
    s_add_u32 s60, s52, 20480
    buffer_load_dwordx4 v3, s[28:31], s60 offen lds
    s_add_u32 m0, s77, 6144
    s_add_u32 s60, s52, 24576
    buffer_load_dwordx4 v4, s[28:31], s60 offen lds
    s_add_u32 m0, s77, 7168
    s_add_u32 s60, s52, 28672
    buffer_load_dwordx4 v5, s[28:31], s60 offen lds
    s_add_u32 m0, s77, 8192
    s_add_u32 s60, s53, 0
    buffer_load_dwordx4 v2, s[28:31], s60 offen lds
    s_add_u32 m0, s77, 9216
    s_add_u32 s60, s53, 4096
    buffer_load_dwordx4 v3, s[28:31], s60 offen lds
    s_add_u32 m0, s77, 10240
    s_add_u32 s60, s53, 8192
    buffer_load_dwordx4 v4, s[28:31], s60 offen lds
    s_add_u32 m0, s77, 11264
    s_add_u32 s60, s53, 12288
    buffer_load_dwordx4 v5, s[28:31], s60 offen lds
    s_add_u32 m0, s77, 12288
    s_add_u32 s60, s53, 16384
    buffer_load_dwordx4 v2, s[28:31], s60 offen lds
    s_add_u32 m0, s77, 13312
    s_add_u32 s60, s53, 20480
    buffer_load_dwordx4 v3, s[28:31], s60 offen lds
    s_add_u32 m0, s77, 14336
    s_add_u32 s60, s53, 24576
    buffer_load_dwordx4 v4, s[28:31], s60 offen lds
    s_add_u32 m0, s77, 15360
    s_add_u32 s60, s53, 28672
    buffer_load_dwordx4 v5, s[28:31], s60 offen lds
    v_mov_b32 v16, 0
    v_mov_b32 v17, 0
    v_mov_b32 v18, 0
    v_mov_b32 v19, 0
    s_mov_b32 s86, 0x3f803f80
    v_and_b32 v6, 31, v0
    v_lshrrev_b32 v7, 5, v0
    v_lshlrev_b32 v7, 3, v7
    v_sub_u32 v6, v6, v7
    v_and_b32 v7, 1, v6
    v_lshlrev_b32 v7, 4, v7
    v_lshrrev_b32 v6, 1, v6
    v_mov_b32 v32, 0x3f80
    v_lshlrev_b32 v7, v7, v32
    v_cmp_eq_u32 vcc, 0, v6
    s_nop 1
    v_cndmask_b32 v32, 0, v7, vcc
    v_cmp_eq_u32 vcc, 1, v6
    s_nop 1
    v_cndmask_b32 v33, 0, v7, vcc
    v_cmp_eq_u32 vcc, 2, v6
    s_nop 1
    v_cndmask_b32 v34, 0, v7, vcc
    v_cmp_eq_u32 vcc, 3, v6
    s_nop 1
    v_cndmask_b32 v35, 0, v7, vcc
    v_cmp_eq_u32 vcc, 8, v6
    s_nop 1
    v_cndmask_b32 v36, 0, v7, vcc
    v_cmp_eq_u32 vcc, 9, v6
    s_nop 1
    v_cndmask_b32 v37, 0, v7, vcc
    v_cmp_eq_u32 vcc, 10, v6
    s_nop 1
    v_cndmask_b32 v38, 0, v7, vcc
    v_cmp_eq_u32 vcc, 11, v6
    s_nop 1
    v_cndmask_b32 v39, 0, v7, vcc
    v_lshrrev_b32 v22, 3, v0
    v_bfe_u32 v1, v0, 4, 1
    s_and_b32 s60, s57, 1
    s_lshl_b32 s60, s60, 1
    v_or_b32 v1, s60, v1
    v_bfe_u32 v24, v0, 1, 2
    v_xor_b32 v24, v24, v1
    s_lshr_b32 s61, s57, 1
    s_lshl_b32 s61, s61, 3
    v_add_u32 v22, s61, v22
    v_mul_u32_u24 v22, 3584, v22
    v_lshl_add_u32 v22, v24, 5, v22
    v_and_b32 v25, 1, v0
    v_lshl_add_u32 v22, v25, 4, v22
    s_lshl_b32 s61, s59, 7
    v_add_u32 v20, s61, v22
    s_mul_i32 s61, s59, 128
    s_mul_i32 s62, s59, 64
    s_add_u32 s62, s62, 512
    s_cmp_ge_u32 s59, 8
    s_cselect_b32 s61, s62, s61
    s_add_u32 s61, s61, 2048
    v_add_u32 v21, s61, v22
    v_cmp_le_u32 vcc, 4, v24
    v_mov_b32 v25, 0x80000000
    s_nop 0
    v_cndmask_b32 v21, v21, v25, vcc
    s_and_b32 s60, s57, 1
    s_lshl_b32 s60, s60, 11
    s_lshr_b32 s61, s57, 1
    s_lshl_b32 s61, s61, 10
    s_add_u32 s99, s60, s61
    v_cmp_eq_u32 vcc, 0, v0
    v_lshlrev_b32 v22, 2, v0
    v_add_u32 v22, 65792, v22
    v_mov_b32 v30, 65536
    v_cndmask_b32 v28, v22, v30, vcc
    v_mov_b32 v29, 1
    v_lshrrev_b32 v24, 5, v0
    v_lshlrev_b32 v24, 8, v24
    v_bfe_u32 v25, v0, 2, 2
    v_lshl_add_u32 v24, v25, 6, v24
    v_bfe_u32 v25, v0, 4, 1
    v_lshl_add_u32 v24, v25, 5, v24
    v_and_b32 v25, 3, v0
    v_lshl_add_u32 v24, v25, 3, v24
    v_add_u32 v24, 131072, v24
    s_lshl_b32 s60, s57, 11
    s_add_u32 s60, s60, 118784
    v_lshlrev_b32 v12, 4, v0
    v_add_u32 v25, s60, v12
    s_waitcnt vmcnt(8)
    ds_read_b128 v[128:131], v8 offset:0
    ds_read_b128 v[132:135], v9 offset:0
    ds_read_b128 v[136:139], v10 offset:0
    ds_read_b128 v[140:143], v11 offset:0
    ds_read_b128 v[144:147], v23 offset:0
    ds_read_b128 v[148:151], v13 offset:0
    ds_read_b128 v[152:155], v14 offset:0
    ds_read_b128 v[156:159], v15 offset:0
    s_add_u32 m0, s77, 16384
    s_add_u32 s60, s54, 0
    buffer_load_dwordx4 v2, s[28:31], s60 offen lds
    s_add_u32 m0, s77, 17408
    s_add_u32 s60, s54, 4096
    buffer_load_dwordx4 v3, s[28:31], s60 offen lds
    s_add_u32 m0, s77, 18432
    s_add_u32 s60, s54, 8192
    buffer_load_dwordx4 v4, s[28:31], s60 offen lds
    s_add_u32 m0, s77, 19456
    s_add_u32 s60, s54, 12288
    buffer_load_dwordx4 v5, s[28:31], s60 offen lds
    s_add_u32 m0, s77, 20480
    s_add_u32 s60, s54, 16384
    buffer_load_dwordx4 v2, s[28:31], s60 offen lds
    s_add_u32 m0, s77, 21504
    s_add_u32 s60, s54, 20480
    buffer_load_dwordx4 v3, s[28:31], s60 offen lds
    s_add_u32 m0, s77, 22528
    s_add_u32 s60, s54, 24576
    buffer_load_dwordx4 v4, s[28:31], s60 offen lds
    s_add_u32 m0, s77, 23552
    s_add_u32 s60, s54, 28672
    buffer_load_dwordx4 v5, s[28:31], s60 offen lds
    s_waitcnt lgkmcnt(7)
    v_dot2c_f32_bf16 v16, s86, v128
    v_dot2c_f32_bf16 v17, s86, v129
    v_dot2c_f32_bf16 v16, s86, v130
    v_dot2c_f32_bf16 v17, s86, v131
    v_dot2c_f32_bf16 v18, v128, v128
    v_dot2c_f32_bf16 v19, v129, v129
    v_dot2c_f32_bf16 v18, v130, v130
    v_dot2c_f32_bf16 v19, v131, v131
    s_waitcnt lgkmcnt(6)
    v_dot2c_f32_bf16 v16, s86, v132
    v_dot2c_f32_bf16 v17, s86, v133
    v_dot2c_f32_bf16 v16, s86, v134
    v_dot2c_f32_bf16 v17, s86, v135
    v_dot2c_f32_bf16 v18, v132, v132
    v_dot2c_f32_bf16 v19, v133, v133
    v_dot2c_f32_bf16 v18, v134, v134
    v_dot2c_f32_bf16 v19, v135, v135
    s_waitcnt lgkmcnt(5)
    v_dot2c_f32_bf16 v16, s86, v136
    v_dot2c_f32_bf16 v17, s86, v137
    v_dot2c_f32_bf16 v16, s86, v138
    v_dot2c_f32_bf16 v17, s86, v139
    v_dot2c_f32_bf16 v18, v136, v136
    v_dot2c_f32_bf16 v19, v137, v137
    v_dot2c_f32_bf16 v18, v138, v138
    v_dot2c_f32_bf16 v19, v139, v139
    s_waitcnt lgkmcnt(4)
    v_dot2c_f32_bf16 v16, s86, v140
    v_dot2c_f32_bf16 v17, s86, v141
    v_dot2c_f32_bf16 v16, s86, v142
    v_dot2c_f32_bf16 v17, s86, v143
    v_dot2c_f32_bf16 v18, v140, v140
    v_dot2c_f32_bf16 v19, v141, v141
    v_dot2c_f32_bf16 v18, v142, v142
    v_dot2c_f32_bf16 v19, v143, v143
    s_waitcnt lgkmcnt(3)
    v_dot2c_f32_bf16 v16, s86, v144
    v_dot2c_f32_bf16 v17, s86, v145
    v_dot2c_f32_bf16 v16, s86, v146
    v_dot2c_f32_bf16 v17, s86, v147
    v_dot2c_f32_bf16 v18, v144, v144
    v_dot2c_f32_bf16 v19, v145, v145
    v_dot2c_f32_bf16 v18, v146, v146
    v_dot2c_f32_bf16 v19, v147, v147
    s_waitcnt lgkmcnt(2)
    v_dot2c_f32_bf16 v16, s86, v148
    v_dot2c_f32_bf16 v17, s86, v149
    v_dot2c_f32_bf16 v16, s86, v150
    v_dot2c_f32_bf16 v17, s86, v151
    v_dot2c_f32_bf16 v18, v148, v148
    v_dot2c_f32_bf16 v19, v149, v149
    v_dot2c_f32_bf16 v18, v150, v150
    v_dot2c_f32_bf16 v19, v151, v151
    s_waitcnt lgkmcnt(1)
    v_dot2c_f32_bf16 v16, s86, v152
    v_dot2c_f32_bf16 v17, s86, v153
    v_dot2c_f32_bf16 v16, s86, v154
    v_dot2c_f32_bf16 v17, s86, v155
    v_dot2c_f32_bf16 v18, v152, v152
    v_dot2c_f32_bf16 v19, v153, v153
    v_dot2c_f32_bf16 v18, v154, v154
    v_dot2c_f32_bf16 v19, v155, v155
    s_waitcnt lgkmcnt(0)
    v_dot2c_f32_bf16 v16, s86, v156
    v_dot2c_f32_bf16 v17, s86, v157
    v_dot2c_f32_bf16 v16, s86, v158
    v_dot2c_f32_bf16 v17, s86, v159
    v_dot2c_f32_bf16 v18, v156, v156
    v_dot2c_f32_bf16 v19, v157, v157
    v_dot2c_f32_bf16 v18, v158, v158
    v_dot2c_f32_bf16 v19, v159, v159
    s_waitcnt vmcnt(8)
    ds_read_b128 v[160:163], v8 offset:8192
    ds_read_b128 v[164:167], v9 offset:8192
    ds_read_b128 v[168:171], v10 offset:8192
    ds_read_b128 v[172:175], v11 offset:8192
    ds_read_b128 v[176:179], v23 offset:8192
    ds_read_b128 v[180:183], v13 offset:8192
    ds_read_b128 v[184:187], v14 offset:8192
    ds_read_b128 v[188:191], v15 offset:8192
    s_add_u32 m0, s77, 24576
    s_add_u32 s60, s55, 0
    buffer_load_dwordx4 v2, s[28:31], s60 offen lds
    s_add_u32 m0, s77, 25600
    s_add_u32 s60, s55, 4096
    buffer_load_dwordx4 v3, s[28:31], s60 offen lds
    s_add_u32 m0, s77, 26624
    s_add_u32 s60, s55, 8192
    buffer_load_dwordx4 v4, s[28:31], s60 offen lds
    s_add_u32 m0, s77, 27648
    s_add_u32 s60, s55, 12288
    buffer_load_dwordx4 v5, s[28:31], s60 offen lds
    s_add_u32 m0, s77, 28672
    s_add_u32 s60, s55, 16384
    buffer_load_dwordx4 v2, s[28:31], s60 offen lds
    s_add_u32 m0, s77, 29696
    s_add_u32 s60, s55, 20480
    buffer_load_dwordx4 v3, s[28:31], s60 offen lds
    s_add_u32 m0, s77, 30720
    s_add_u32 s60, s55, 24576
    buffer_load_dwordx4 v4, s[28:31], s60 offen lds
    s_add_u32 m0, s77, 31744
    s_add_u32 s60, s55, 28672
    buffer_load_dwordx4 v5, s[28:31], s60 offen lds
    s_mul_i32 s52, s90, 458752
    s_mul_i32 s53, s91, 458752
    s_mul_i32 s54, s92, 458752
    s_mul_i32 s55, s93, 458752
    s_waitcnt lgkmcnt(7)
    v_dot2c_f32_bf16 v16, s86, v160
    v_dot2c_f32_bf16 v17, s86, v161
    v_dot2c_f32_bf16 v16, s86, v162
    v_dot2c_f32_bf16 v17, s86, v163
    v_dot2c_f32_bf16 v18, v160, v160
    v_dot2c_f32_bf16 v19, v161, v161
    v_dot2c_f32_bf16 v18, v162, v162
    v_dot2c_f32_bf16 v19, v163, v163
    s_waitcnt lgkmcnt(6)
    v_dot2c_f32_bf16 v16, s86, v164
    v_dot2c_f32_bf16 v17, s86, v165
    v_dot2c_f32_bf16 v16, s86, v166
    v_dot2c_f32_bf16 v17, s86, v167
    v_dot2c_f32_bf16 v18, v164, v164
    v_dot2c_f32_bf16 v19, v165, v165
    v_dot2c_f32_bf16 v18, v166, v166
    v_dot2c_f32_bf16 v19, v167, v167
    s_waitcnt lgkmcnt(5)
    v_dot2c_f32_bf16 v16, s86, v168
    v_dot2c_f32_bf16 v17, s86, v169
    v_dot2c_f32_bf16 v16, s86, v170
    v_dot2c_f32_bf16 v17, s86, v171
    v_dot2c_f32_bf16 v18, v168, v168
    v_dot2c_f32_bf16 v19, v169, v169
    v_dot2c_f32_bf16 v18, v170, v170
    v_dot2c_f32_bf16 v19, v171, v171
    s_waitcnt lgkmcnt(4)
    v_dot2c_f32_bf16 v16, s86, v172
    v_dot2c_f32_bf16 v17, s86, v173
    v_dot2c_f32_bf16 v16, s86, v174
    v_dot2c_f32_bf16 v17, s86, v175
    v_dot2c_f32_bf16 v18, v172, v172
    v_dot2c_f32_bf16 v19, v173, v173
    v_dot2c_f32_bf16 v18, v174, v174
    v_dot2c_f32_bf16 v19, v175, v175
    s_waitcnt lgkmcnt(3)
    v_dot2c_f32_bf16 v16, s86, v176
    v_dot2c_f32_bf16 v17, s86, v177
    v_dot2c_f32_bf16 v16, s86, v178
    v_dot2c_f32_bf16 v17, s86, v179
    v_dot2c_f32_bf16 v18, v176, v176
    v_dot2c_f32_bf16 v19, v177, v177
    v_dot2c_f32_bf16 v18, v178, v178
    v_dot2c_f32_bf16 v19, v179, v179
    s_waitcnt lgkmcnt(2)
    v_dot2c_f32_bf16 v16, s86, v180
    v_dot2c_f32_bf16 v17, s86, v181
    v_dot2c_f32_bf16 v16, s86, v182
    v_dot2c_f32_bf16 v17, s86, v183
    v_dot2c_f32_bf16 v18, v180, v180
    v_dot2c_f32_bf16 v19, v181, v181
    v_dot2c_f32_bf16 v18, v182, v182
    v_dot2c_f32_bf16 v19, v183, v183
    s_waitcnt lgkmcnt(1)
    v_dot2c_f32_bf16 v16, s86, v184
    v_dot2c_f32_bf16 v17, s86, v185
    v_dot2c_f32_bf16 v16, s86, v186
    v_dot2c_f32_bf16 v17, s86, v187
    v_dot2c_f32_bf16 v18, v184, v184
    v_dot2c_f32_bf16 v19, v185, v185
    v_dot2c_f32_bf16 v18, v186, v186
    v_dot2c_f32_bf16 v19, v187, v187
    s_waitcnt lgkmcnt(0)
    v_dot2c_f32_bf16 v16, s86, v188
    v_dot2c_f32_bf16 v17, s86, v189
    v_dot2c_f32_bf16 v16, s86, v190
    v_dot2c_f32_bf16 v17, s86, v191
    v_dot2c_f32_bf16 v18, v188, v188
    v_dot2c_f32_bf16 v19, v189, v189
    v_dot2c_f32_bf16 v18, v190, v190
    v_dot2c_f32_bf16 v19, v191, v191
    s_waitcnt vmcnt(8)
    ds_read_b128 v[192:195], v8 offset:16384
    ds_read_b128 v[196:199], v9 offset:16384
    ds_read_b128 v[200:203], v10 offset:16384
    ds_read_b128 v[204:207], v11 offset:16384
    ds_read_b128 v[208:211], v23 offset:16384
    ds_read_b128 v[212:215], v13 offset:16384
    ds_read_b128 v[216:219], v14 offset:16384
    ds_read_b128 v[220:223], v15 offset:16384
    s_waitcnt lgkmcnt(7)
    v_dot2c_f32_bf16 v16, s86, v192
    v_dot2c_f32_bf16 v17, s86, v193
    v_dot2c_f32_bf16 v16, s86, v194
    v_dot2c_f32_bf16 v17, s86, v195
    v_dot2c_f32_bf16 v18, v192, v192
    v_dot2c_f32_bf16 v19, v193, v193
    v_dot2c_f32_bf16 v18, v194, v194
    v_dot2c_f32_bf16 v19, v195, v195
    s_waitcnt lgkmcnt(6)
    v_dot2c_f32_bf16 v16, s86, v196
    v_dot2c_f32_bf16 v17, s86, v197
    v_dot2c_f32_bf16 v16, s86, v198
    v_dot2c_f32_bf16 v17, s86, v199
    v_dot2c_f32_bf16 v18, v196, v196
    v_dot2c_f32_bf16 v19, v197, v197
    v_dot2c_f32_bf16 v18, v198, v198
    v_dot2c_f32_bf16 v19, v199, v199
    s_waitcnt lgkmcnt(5)
    v_dot2c_f32_bf16 v16, s86, v200
    v_dot2c_f32_bf16 v17, s86, v201
    v_dot2c_f32_bf16 v16, s86, v202
    v_dot2c_f32_bf16 v17, s86, v203
    v_dot2c_f32_bf16 v18, v200, v200
    v_dot2c_f32_bf16 v19, v201, v201
    v_dot2c_f32_bf16 v18, v202, v202
    v_dot2c_f32_bf16 v19, v203, v203
    s_waitcnt lgkmcnt(4)
    v_dot2c_f32_bf16 v16, s86, v204
    v_dot2c_f32_bf16 v17, s86, v205
    v_dot2c_f32_bf16 v16, s86, v206
    v_dot2c_f32_bf16 v17, s86, v207
    v_dot2c_f32_bf16 v18, v204, v204
    v_dot2c_f32_bf16 v19, v205, v205
    v_dot2c_f32_bf16 v18, v206, v206
    v_dot2c_f32_bf16 v19, v207, v207
    s_waitcnt lgkmcnt(3)
    v_dot2c_f32_bf16 v16, s86, v208
    v_dot2c_f32_bf16 v17, s86, v209
    v_dot2c_f32_bf16 v16, s86, v210
    v_dot2c_f32_bf16 v17, s86, v211
    v_dot2c_f32_bf16 v18, v208, v208
    v_dot2c_f32_bf16 v19, v209, v209
    v_dot2c_f32_bf16 v18, v210, v210
    v_dot2c_f32_bf16 v19, v211, v211
    s_waitcnt lgkmcnt(2)
    v_dot2c_f32_bf16 v16, s86, v212
    v_dot2c_f32_bf16 v17, s86, v213
    v_dot2c_f32_bf16 v16, s86, v214
    v_dot2c_f32_bf16 v17, s86, v215
    v_dot2c_f32_bf16 v18, v212, v212
    v_dot2c_f32_bf16 v19, v213, v213
    v_dot2c_f32_bf16 v18, v214, v214
    v_dot2c_f32_bf16 v19, v215, v215
    s_waitcnt lgkmcnt(1)
    v_dot2c_f32_bf16 v16, s86, v216
    v_dot2c_f32_bf16 v17, s86, v217
    v_dot2c_f32_bf16 v16, s86, v218
    v_dot2c_f32_bf16 v17, s86, v219
    v_dot2c_f32_bf16 v18, v216, v216
    v_dot2c_f32_bf16 v19, v217, v217
    v_dot2c_f32_bf16 v18, v218, v218
    v_dot2c_f32_bf16 v19, v219, v219
    s_waitcnt lgkmcnt(0)
    v_dot2c_f32_bf16 v16, s86, v220
    v_dot2c_f32_bf16 v17, s86, v221
    v_dot2c_f32_bf16 v16, s86, v222
    v_dot2c_f32_bf16 v17, s86, v223
    v_dot2c_f32_bf16 v18, v220, v220
    v_dot2c_f32_bf16 v19, v221, v221
    v_dot2c_f32_bf16 v18, v222, v222
    v_dot2c_f32_bf16 v19, v223, v223
    s_waitcnt vmcnt(0)
    ds_read_b128 v[224:227], v8 offset:24576
    ds_read_b128 v[228:231], v9 offset:24576
    ds_read_b128 v[232:235], v10 offset:24576
    ds_read_b128 v[236:239], v11 offset:24576
    ds_read_b128 v[240:243], v23 offset:24576
    ds_read_b128 v[244:247], v13 offset:24576
    ds_read_b128 v[248:251], v14 offset:24576
    ds_read_b128 v[252:255], v15 offset:24576
    s_waitcnt lgkmcnt(7)
    v_dot2c_f32_bf16 v16, s86, v224
    v_dot2c_f32_bf16 v17, s86, v225
    v_dot2c_f32_bf16 v16, s86, v226
    v_dot2c_f32_bf16 v17, s86, v227
    s_waitcnt lgkmcnt(6)
    v_dot2c_f32_bf16 v16, s86, v228
    v_dot2c_f32_bf16 v17, s86, v229
    v_dot2c_f32_bf16 v16, s86, v230
    v_dot2c_f32_bf16 v17, s86, v231
    s_waitcnt lgkmcnt(5)
    v_dot2c_f32_bf16 v16, s86, v232
    v_dot2c_f32_bf16 v17, s86, v233
    v_dot2c_f32_bf16 v16, s86, v234
    v_dot2c_f32_bf16 v17, s86, v235
    s_waitcnt lgkmcnt(4)
    v_dot2c_f32_bf16 v16, s86, v236
    v_dot2c_f32_bf16 v17, s86, v237
    v_dot2c_f32_bf16 v16, s86, v238
    v_dot2c_f32_bf16 v17, s86, v239
    s_waitcnt lgkmcnt(3)
    v_dot2c_f32_bf16 v16, s86, v240
    v_dot2c_f32_bf16 v17, s86, v241
    v_dot2c_f32_bf16 v16, s86, v242
    v_dot2c_f32_bf16 v17, s86, v243
    s_waitcnt lgkmcnt(2)
    v_dot2c_f32_bf16 v16, s86, v244
    v_dot2c_f32_bf16 v17, s86, v245
    v_dot2c_f32_bf16 v16, s86, v246
    v_dot2c_f32_bf16 v17, s86, v247
    s_waitcnt lgkmcnt(1)
    v_dot2c_f32_bf16 v16, s86, v248
    v_dot2c_f32_bf16 v17, s86, v249
    v_dot2c_f32_bf16 v16, s86, v250
    v_dot2c_f32_bf16 v17, s86, v251
    s_waitcnt lgkmcnt(0)
    v_dot2c_f32_bf16 v16, s86, v252
    v_dot2c_f32_bf16 v17, s86, v253
    v_dot2c_f32_bf16 v16, s86, v254
    v_dot2c_f32_bf16 v17, s86, v255
    s_barrier
    ds_read_b64_tr_b16 v[40:41], v24 offset:0
    ds_read_b64_tr_b16 v[42:43], v24 offset:512
    ds_read_b64_tr_b16 v[44:45], v24 offset:1024
    ds_read_b64_tr_b16 v[46:47], v24 offset:1536
    ds_read_b64_tr_b16 v[48:49], v24 offset:2048
    ds_read_b64_tr_b16 v[50:51], v24 offset:2560
    ds_read_b64_tr_b16 v[52:53], v24 offset:3072
    ds_read_b64_tr_b16 v[54:55], v24 offset:3584
    v_add_f32 v16, v16, v17
    v_mov_b32 v17, v16
    s_nop 1
    v_permlane32_swap_b32 v16, v17
    v_add_f32 v16, v16, v17
    v_mul_f32 v16, 0xbb000000, v16
    v_mov_b32 v64, v16
    v_mov_b32 v65, v16
    v_mov_b32 v66, v16
    v_mov_b32 v67, v16
    v_mov_b32 v68, v16
    v_mov_b32 v69, v16
    v_mov_b32 v70, v16
    v_mov_b32 v71, v16
    v_mov_b32 v72, v16
    v_mov_b32 v73, v16
    v_mov_b32 v74, v16
    v_mov_b32 v75, v16
    v_mov_b32 v76, v16
    v_mov_b32 v77, v16
    v_mov_b32 v78, v16
    v_mov_b32 v79, v16
    v_dot2c_f32_bf16 v18, v224, v224
    v_dot2c_f32_bf16 v19, v225, v225
    v_dot2c_f32_bf16 v18, v226, v226
    v_dot2c_f32_bf16 v19, v227, v227
    v_dot2c_f32_bf16 v18, v228, v228
    v_dot2c_f32_bf16 v19, v229, v229
    v_dot2c_f32_bf16 v18, v230, v230
    v_dot2c_f32_bf16 v19, v231, v231
    v_dot2c_f32_bf16 v18, v232, v232
    v_dot2c_f32_bf16 v19, v233, v233
    v_dot2c_f32_bf16 v18, v234, v234
    v_dot2c_f32_bf16 v19, v235, v235
    v_dot2c_f32_bf16 v18, v236, v236
    v_dot2c_f32_bf16 v19, v237, v237
    v_dot2c_f32_bf16 v18, v238, v238
    v_dot2c_f32_bf16 v19, v239, v239
    v_dot2c_f32_bf16 v18, v240, v240
    v_dot2c_f32_bf16 v19, v241, v241
    v_dot2c_f32_bf16 v18, v242, v242
    v_dot2c_f32_bf16 v19, v243, v243
    v_dot2c_f32_bf16 v18, v244, v244
    v_dot2c_f32_bf16 v19, v245, v245
    v_dot2c_f32_bf16 v18, v246, v246
    v_dot2c_f32_bf16 v19, v247, v247
    v_dot2c_f32_bf16 v18, v248, v248
    v_dot2c_f32_bf16 v19, v249, v249
    v_dot2c_f32_bf16 v18, v250, v250
    v_dot2c_f32_bf16 v19, v251, v251
    v_dot2c_f32_bf16 v18, v252, v252
    v_dot2c_f32_bf16 v19, v253, v253
    v_dot2c_f32_bf16 v18, v254, v254
    v_dot2c_f32_bf16 v19, v255, v255
    v_mfma_f32_32x32x16_bf16 v[80:95], v[32:35], v[128:131], v[64:79]
    v_mfma_f32_32x32x16_bf16 v[80:95], v[36:39], v[132:135], v[80:95]
    v_mfma_f32_32x32x16_bf16 v[96:111], v[32:35], v[136:139], v[64:79]
    v_mfma_f32_32x32x16_bf16 v[96:111], v[36:39], v[140:143], v[96:111]
    s_nop 9
    v_cvt_pk_bf16_f32 v128, v80, v81
    v_cvt_pk_bf16_f32 v129, v82, v83
    v_cvt_pk_bf16_f32 v130, v84, v85
    v_cvt_pk_bf16_f32 v131, v86, v87
    v_cvt_pk_bf16_f32 v132, v88, v89
    v_cvt_pk_bf16_f32 v133, v90, v91
    v_cvt_pk_bf16_f32 v134, v92, v93
    v_cvt_pk_bf16_f32 v135, v94, v95
    v_mfma_f32_32x32x16_bf16 v[80:95], v[32:35], v[144:147], v[64:79]
    v_mfma_f32_32x32x16_bf16 v[80:95], v[36:39], v[148:151], v[80:95]
    v_cvt_pk_bf16_f32 v136, v96, v97
    v_cvt_pk_bf16_f32 v137, v98, v99
    v_cvt_pk_bf16_f32 v138, v100, v101
    v_cvt_pk_bf16_f32 v139, v102, v103
    v_cvt_pk_bf16_f32 v140, v104, v105
    v_cvt_pk_bf16_f32 v141, v106, v107
    v_cvt_pk_bf16_f32 v142, v108, v109
    v_cvt_pk_bf16_f32 v143, v110, v111
    s_waitcnt lgkmcnt(4)
    v_mfma_f32_32x32x16_bf16 v[112:127], v[40:43], v[128:131], 0
    ds_read_b64_tr_b16 v[56:57], v24 offset:4096
    ds_read_b64_tr_b16 v[58:59], v24 offset:4608
    v_mfma_f32_32x32x16_bf16 v[112:127], v[44:47], v[132:135], v[112:127]
    ds_read_b64_tr_b16 v[60:61], v24 offset:5120
    ds_read_b64_tr_b16 v[62:63], v24 offset:5632
    v_mfma_f32_32x32x16_bf16 v[96:111], v[32:35], v[152:155], v[64:79]
    v_mfma_f32_32x32x16_bf16 v[96:111], v[36:39], v[156:159], v[96:111]
    v_add_f32 v18, v18, v19
    v_mov_b32 v19, v18
    v_cvt_pk_bf16_f32 v144, v80, v81
    v_cvt_pk_bf16_f32 v145, v82, v83
    v_cvt_pk_bf16_f32 v146, v84, v85
    v_cvt_pk_bf16_f32 v147, v86, v87
    v_cvt_pk_bf16_f32 v148, v88, v89
    v_cvt_pk_bf16_f32 v149, v90, v91
    v_cvt_pk_bf16_f32 v150, v92, v93
    v_cvt_pk_bf16_f32 v151, v94, v95
    s_waitcnt lgkmcnt(4)
    v_mfma_f32_32x32x16_bf16 v[112:127], v[48:51], v[136:139], v[112:127]
    ds_read_b64_tr_b16 v[40:41], v24 offset:6144
    ds_read_b64_tr_b16 v[42:43], v24 offset:6656
    v_mfma_f32_32x32x16_bf16 v[112:127], v[52:55], v[140:143], v[112:127]
    ds_read_b64_tr_b16 v[44:45], v24 offset:7168
    ds_read_b64_tr_b16 v[46:47], v24 offset:7680
    v_mfma_f32_32x32x16_bf16 v[80:95], v[32:35], v[160:163], v[64:79]
    v_mfma_f32_32x32x16_bf16 v[80:95], v[36:39], v[164:167], v[80:95]
    v_permlane32_swap_b32 v18, v19
    v_add_f32 v18, v18, v19
    v_cvt_pk_bf16_f32 v152, v96, v97
    v_cvt_pk_bf16_f32 v153, v98, v99
    v_cvt_pk_bf16_f32 v154, v100, v101
    v_cvt_pk_bf16_f32 v155, v102, v103
    v_cvt_pk_bf16_f32 v156, v104, v105
    v_cvt_pk_bf16_f32 v157, v106, v107
    v_cvt_pk_bf16_f32 v158, v108, v109
    v_cvt_pk_bf16_f32 v159, v110, v111
    s_waitcnt lgkmcnt(4)
    v_mfma_f32_32x32x16_bf16 v[112:127], v[56:59], v[144:147], v[112:127]
    ds_read_b64_tr_b16 v[48:49], v24 offset:8192
    ds_read_b64_tr_b16 v[50:51], v24 offset:8704
    v_mfma_f32_32x32x16_bf16 v[112:127], v[60:63], v[148:151], v[112:127]
    ds_read_b64_tr_b16 v[52:53], v24 offset:9216
    ds_read_b64_tr_b16 v[54:55], v24 offset:9728
    v_mfma_f32_32x32x16_bf16 v[96:111], v[32:35], v[168:171], v[64:79]
    v_mfma_f32_32x32x16_bf16 v[96:111], v[36:39], v[172:175], v[96:111]
    v_mul_f32 v18, 0x3b000000, v18
    v_fma_f32 v18, -v16, v16, v18
    v_cvt_pk_bf16_f32 v160, v80, v81
    v_cvt_pk_bf16_f32 v161, v82, v83
    v_cvt_pk_bf16_f32 v162, v84, v85
    v_cvt_pk_bf16_f32 v163, v86, v87
    v_cvt_pk_bf16_f32 v164, v88, v89
    v_cvt_pk_bf16_f32 v165, v90, v91
    v_cvt_pk_bf16_f32 v166, v92, v93
    v_cvt_pk_bf16_f32 v167, v94, v95
    s_waitcnt lgkmcnt(4)
    v_mfma_f32_32x32x16_bf16 v[112:127], v[40:43], v[152:155], v[112:127]
    ds_read_b64_tr_b16 v[56:57], v24 offset:10240
    ds_read_b64_tr_b16 v[58:59], v24 offset:10752
    v_mfma_f32_32x32x16_bf16 v[112:127], v[44:47], v[156:159], v[112:127]
    ds_read_b64_tr_b16 v[60:61], v24 offset:11264
    ds_read_b64_tr_b16 v[62:63], v24 offset:11776
    v_mfma_f32_32x32x16_bf16 v[80:95], v[32:35], v[176:179], v[64:79]
    v_mfma_f32_32x32x16_bf16 v[80:95], v[36:39], v[180:183], v[80:95]
    v_max_f32 v18, 0, v18
    v_add_f32 v27, 0x3727c5ac, v18
    v_rsq_f32 v17, v27
    v_cvt_pk_bf16_f32 v168, v96, v97
    v_cvt_pk_bf16_f32 v169, v98, v99
    v_cvt_pk_bf16_f32 v170, v100, v101
    v_cvt_pk_bf16_f32 v171, v102, v103
    v_cvt_pk_bf16_f32 v172, v104, v105
    v_cvt_pk_bf16_f32 v173, v106, v107
    v_cvt_pk_bf16_f32 v174, v108, v109
    v_cvt_pk_bf16_f32 v175, v110, v111
    s_waitcnt lgkmcnt(4)
    v_mfma_f32_32x32x16_bf16 v[112:127], v[48:51], v[160:163], v[112:127]
    ds_read_b64_tr_b16 v[40:41], v24 offset:12288
    ds_read_b64_tr_b16 v[42:43], v24 offset:12800
    v_mfma_f32_32x32x16_bf16 v[112:127], v[52:55], v[164:167], v[112:127]
    ds_read_b64_tr_b16 v[44:45], v24 offset:13312
    ds_read_b64_tr_b16 v[46:47], v24 offset:13824
    v_mfma_f32_32x32x16_bf16 v[96:111], v[32:35], v[184:187], v[64:79]
    v_mfma_f32_32x32x16_bf16 v[96:111], v[36:39], v[188:191], v[96:111]
    s_barrier
    v_cvt_pk_bf16_f32 v176, v80, v81
    v_cvt_pk_bf16_f32 v177, v82, v83
    v_cvt_pk_bf16_f32 v178, v84, v85
    v_cvt_pk_bf16_f32 v179, v86, v87
    v_cvt_pk_bf16_f32 v180, v88, v89
    v_cvt_pk_bf16_f32 v181, v90, v91
    v_cvt_pk_bf16_f32 v182, v92, v93
    v_cvt_pk_bf16_f32 v183, v94, v95
    s_waitcnt lgkmcnt(4)
    v_mfma_f32_32x32x16_bf16 v[112:127], v[56:59], v[168:171], v[112:127]
    ds_read_b64_tr_b16 v[48:49], v24 offset:14336
    ds_read_b64_tr_b16 v[50:51], v24 offset:14848
    v_mfma_f32_32x32x16_bf16 v[112:127], v[60:63], v[172:175], v[112:127]
    ds_read_b64_tr_b16 v[52:53], v24 offset:15360
    ds_read_b64_tr_b16 v[54:55], v24 offset:15872
    v_mfma_f32_32x32x16_bf16 v[80:95], v[32:35], v[192:195], v[64:79]
    v_mfma_f32_32x32x16_bf16 v[80:95], v[36:39], v[196:199], v[80:95]
    v_cvt_pk_bf16_f32 v184, v96, v97
    v_cvt_pk_bf16_f32 v185, v98, v99
    v_cvt_pk_bf16_f32 v186, v100, v101
    v_cvt_pk_bf16_f32 v187, v102, v103
    v_cvt_pk_bf16_f32 v188, v104, v105
    v_cvt_pk_bf16_f32 v189, v106, v107
    v_cvt_pk_bf16_f32 v190, v108, v109
    v_cvt_pk_bf16_f32 v191, v110, v111
    s_waitcnt lgkmcnt(4)
    v_mfma_f32_32x32x16_bf16 v[112:127], v[40:43], v[176:179], v[112:127]
    ds_read_b64_tr_b16 v[56:57], v24 offset:16384
    ds_read_b64_tr_b16 v[58:59], v24 offset:16896
    v_mfma_f32_32x32x16_bf16 v[112:127], v[44:47], v[180:183], v[112:127]
    ds_read_b64_tr_b16 v[60:61], v24 offset:17408
    ds_read_b64_tr_b16 v[62:63], v24 offset:17920
    v_mfma_f32_32x32x16_bf16 v[96:111], v[32:35], v[200:203], v[64:79]
    v_mfma_f32_32x32x16_bf16 v[96:111], v[36:39], v[204:207], v[96:111]
    v_mov_b32 v2, 65600
    ds_read_b64 v[4:5], v2
    v_cvt_pk_bf16_f32 v192, v80, v81
    v_cvt_pk_bf16_f32 v193, v82, v83
    v_cvt_pk_bf16_f32 v194, v84, v85
    v_cvt_pk_bf16_f32 v195, v86, v87
    v_cvt_pk_bf16_f32 v196, v88, v89
    v_cvt_pk_bf16_f32 v197, v90, v91
    v_cvt_pk_bf16_f32 v198, v92, v93
    v_cvt_pk_bf16_f32 v199, v94, v95
    s_waitcnt lgkmcnt(5)
    v_mfma_f32_32x32x16_bf16 v[112:127], v[48:51], v[184:187], v[112:127]
    ds_read_b64_tr_b16 v[40:41], v24 offset:18432
    ds_read_b64_tr_b16 v[42:43], v24 offset:18944
    v_mfma_f32_32x32x16_bf16 v[112:127], v[52:55], v[188:191], v[112:127]
    ds_read_b64_tr_b16 v[44:45], v24 offset:19456
    ds_read_b64_tr_b16 v[46:47], v24 offset:19968
    v_mfma_f32_32x32x16_bf16 v[80:95], v[32:35], v[208:211], v[64:79]
    v_mfma_f32_32x32x16_bf16 v[80:95], v[36:39], v[212:215], v[80:95]
    v_mul_f32 v26, 0xbfb8aa3b, v17
    v_mul_f32 v10, 0x3eb8aa3b, v17
    v_cvt_pk_bf16_f32 v200, v96, v97
    v_cvt_pk_bf16_f32 v201, v98, v99
    v_cvt_pk_bf16_f32 v202, v100, v101
    v_cvt_pk_bf16_f32 v203, v102, v103
    v_cvt_pk_bf16_f32 v204, v104, v105
    v_cvt_pk_bf16_f32 v205, v106, v107
    v_cvt_pk_bf16_f32 v206, v108, v109
    v_cvt_pk_bf16_f32 v207, v110, v111
    s_waitcnt lgkmcnt(5)
    v_mfma_f32_32x32x16_bf16 v[112:127], v[56:59], v[192:195], v[112:127]
    ds_read_b64_tr_b16 v[48:49], v24 offset:20480
    ds_read_b64_tr_b16 v[50:51], v24 offset:20992
    v_mfma_f32_32x32x16_bf16 v[112:127], v[60:63], v[196:199], v[112:127]
    ds_read_b64_tr_b16 v[52:53], v24 offset:21504
    ds_read_b64_tr_b16 v[54:55], v24 offset:22016
    v_mfma_f32_32x32x16_bf16 v[96:111], v[32:35], v[216:219], v[64:79]
    v_mfma_f32_32x32x16_bf16 v[96:111], v[36:39], v[220:223], v[96:111]
    v_cvt_pk_bf16_f32 v208, v80, v81
    v_cvt_pk_bf16_f32 v209, v82, v83
    v_cvt_pk_bf16_f32 v210, v84, v85
    v_cvt_pk_bf16_f32 v211, v86, v87
    v_cvt_pk_bf16_f32 v212, v88, v89
    v_cvt_pk_bf16_f32 v213, v90, v91
    v_cvt_pk_bf16_f32 v214, v92, v93
    v_cvt_pk_bf16_f32 v215, v94, v95
    s_waitcnt lgkmcnt(4)
    v_mfma_f32_32x32x16_bf16 v[112:127], v[40:43], v[200:203], v[112:127]
    ds_read_b64_tr_b16 v[56:57], v24 offset:22528
    ds_read_b64_tr_b16 v[58:59], v24 offset:23040
    v_mfma_f32_32x32x16_bf16 v[112:127], v[44:47], v[204:207], v[112:127]
    ds_read_b64_tr_b16 v[60:61], v24 offset:23552
    ds_read_b64_tr_b16 v[62:63], v24 offset:24064
    v_mfma_f32_32x32x16_bf16 v[80:95], v[32:35], v[224:227], v[64:79]
    v_mfma_f32_32x32x16_bf16 v[80:95], v[36:39], v[228:231], v[80:95]
    v_cvt_pk_bf16_f32 v216, v96, v97
    v_cvt_pk_bf16_f32 v217, v98, v99
    v_cvt_pk_bf16_f32 v218, v100, v101
    v_cvt_pk_bf16_f32 v219, v102, v103
    v_cvt_pk_bf16_f32 v220, v104, v105
    v_cvt_pk_bf16_f32 v221, v106, v107
    v_cvt_pk_bf16_f32 v222, v108, v109
    v_cvt_pk_bf16_f32 v223, v110, v111
    s_waitcnt lgkmcnt(4)
    v_mfma_f32_32x32x16_bf16 v[112:127], v[48:51], v[208:211], v[112:127]
    ds_read_b64_tr_b16 v[40:41], v24 offset:24576
    ds_read_b64_tr_b16 v[42:43], v24 offset:25088
    v_mfma_f32_32x32x16_bf16 v[112:127], v[52:55], v[212:215], v[112:127]
    ds_read_b64_tr_b16 v[44:45], v24 offset:25600
    ds_read_b64_tr_b16 v[46:47], v24 offset:26112
    v_mfma_f32_32x32x16_bf16 v[96:111], v[32:35], v[232:235], v[64:79]
    v_mfma_f32_32x32x16_bf16 v[96:111], v[36:39], v[236:239], v[96:111]
    v_cvt_pk_bf16_f32 v224, v80, v81
    v_cvt_pk_bf16_f32 v225, v82, v83
    v_cvt_pk_bf16_f32 v226, v84, v85
    v_cvt_pk_bf16_f32 v227, v86, v87
    v_cvt_pk_bf16_f32 v228, v88, v89
    v_cvt_pk_bf16_f32 v229, v90, v91
    v_cvt_pk_bf16_f32 v230, v92, v93
    v_cvt_pk_bf16_f32 v231, v94, v95
    s_waitcnt lgkmcnt(4)
    v_mfma_f32_32x32x16_bf16 v[112:127], v[56:59], v[216:219], v[112:127]
    ds_read_b64_tr_b16 v[48:49], v24 offset:26624
    ds_read_b64_tr_b16 v[50:51], v24 offset:27136
    v_mfma_f32_32x32x16_bf16 v[112:127], v[60:63], v[220:223], v[112:127]
    ds_read_b64_tr_b16 v[52:53], v24 offset:27648
    ds_read_b64_tr_b16 v[54:55], v24 offset:28160
    v_mfma_f32_32x32x16_bf16 v[80:95], v[32:35], v[240:243], v[64:79]
    v_mfma_f32_32x32x16_bf16 v[80:95], v[36:39], v[244:247], v[80:95]
    v_cvt_pk_bf16_f32 v232, v96, v97
    v_cvt_pk_bf16_f32 v233, v98, v99
    v_cvt_pk_bf16_f32 v234, v100, v101
    v_cvt_pk_bf16_f32 v235, v102, v103
    v_cvt_pk_bf16_f32 v236, v104, v105
    v_cvt_pk_bf16_f32 v237, v106, v107
    v_cvt_pk_bf16_f32 v238, v108, v109
    v_cvt_pk_bf16_f32 v239, v110, v111
    s_waitcnt lgkmcnt(4)
    v_mfma_f32_32x32x16_bf16 v[112:127], v[40:43], v[224:227], v[112:127]
    ds_read_b64_tr_b16 v[56:57], v24 offset:28672
    ds_read_b64_tr_b16 v[58:59], v24 offset:29184
    v_mfma_f32_32x32x16_bf16 v[112:127], v[44:47], v[228:231], v[112:127]
    ds_read_b64_tr_b16 v[60:61], v24 offset:29696
    ds_read_b64_tr_b16 v[62:63], v24 offset:30208
    v_mfma_f32_32x32x16_bf16 v[96:111], v[32:35], v[248:251], v[64:79]
    v_mfma_f32_32x32x16_bf16 v[96:111], v[36:39], v[252:255], v[96:111]
    s_nop 3
    v_cvt_pk_bf16_f32 v240, v80, v81
    v_cvt_pk_bf16_f32 v241, v82, v83
    v_cvt_pk_bf16_f32 v242, v84, v85
    v_cvt_pk_bf16_f32 v243, v86, v87
    v_cvt_pk_bf16_f32 v244, v88, v89
    v_cvt_pk_bf16_f32 v245, v90, v91
    v_cvt_pk_bf16_f32 v246, v92, v93
    v_cvt_pk_bf16_f32 v247, v94, v95
    s_waitcnt lgkmcnt(4)
    v_mfma_f32_32x32x16_bf16 v[112:127], v[48:51], v[232:235], v[112:127]
    ds_read_b64_tr_b16 v[40:41], v24 offset:30720
    ds_read_b64_tr_b16 v[42:43], v24 offset:31232
    v_mfma_f32_32x32x16_bf16 v[112:127], v[52:55], v[236:239], v[112:127]
    ds_read_b64_tr_b16 v[44:45], v24 offset:31744
    ds_read_b64_tr_b16 v[46:47], v24 offset:32256
    s_nop 3
    v_cvt_pk_bf16_f32 v248, v96, v97
    v_cvt_pk_bf16_f32 v249, v98, v99
    v_cvt_pk_bf16_f32 v250, v100, v101
    v_cvt_pk_bf16_f32 v251, v102, v103
    v_cvt_pk_bf16_f32 v252, v104, v105
    v_cvt_pk_bf16_f32 v253, v106, v107
    v_cvt_pk_bf16_f32 v254, v108, v109
    v_cvt_pk_bf16_f32 v255, v110, v111
    s_waitcnt lgkmcnt(4)
    v_mfma_f32_32x32x16_bf16 v[112:127], v[56:59], v[240:243], v[112:127]
    v_mfma_f32_32x32x16_bf16 v[112:127], v[60:63], v[244:247], v[112:127]
    s_nop 3
    s_waitcnt lgkmcnt(0)
    v_mfma_f32_32x32x16_bf16 v[112:127], v[40:43], v[248:251], v[112:127]
    v_mfma_f32_32x32x16_bf16 v[112:127], v[44:47], v[252:255], v[112:127]
    s_nop 3
    v_readfirstlane_b32 s72, v4
    v_readfirstlane_b32 s73, v5
    s_nop 7
    v_pk_mul_f32 v[112:113], v[112:113], v[10:11] op_sel_hi:[1,0]
    v_pk_mul_f32 v[114:115], v[114:115], v[10:11] op_sel_hi:[1,0]
    v_pk_mul_f32 v[116:117], v[116:117], v[10:11] op_sel_hi:[1,0]
    v_pk_mul_f32 v[118:119], v[118:119], v[10:11] op_sel_hi:[1,0]
    v_pk_mul_f32 v[120:121], v[120:121], v[10:11] op_sel_hi:[1,0]
    v_pk_mul_f32 v[122:123], v[122:123], v[10:11] op_sel_hi:[1,0]
    v_pk_mul_f32 v[124:125], v[124:125], v[10:11] op_sel_hi:[1,0]
    v_pk_mul_f32 v[126:127], v[126:127], v[10:11] op_sel_hi:[1,0]
    v_cvt_pk_bf16_f32 v80, v112, v113
    v_cvt_pk_bf16_f32 v81, v114, v115
    v_cvt_pk_bf16_f32 v82, v116, v117
    v_cvt_pk_bf16_f32 v83, v118, v119
    v_cvt_pk_bf16_f32 v84, v120, v121
    v_cvt_pk_bf16_f32 v85, v122, v123
    v_cvt_pk_bf16_f32 v86, v124, v125
    v_cvt_pk_bf16_f32 v87, v126, v127
    ds_write_b128 v25, v[80:83]
    ds_write_b128 v25, v[84:87] offset:1024
    s_mov_b64 exec, 1
    ds_add_u32 v30, v29 offset:4
    s_mov_b64 exec, -1
    s_setprio 2
    s_add_u32 m0, s99, 69632
    s_add_u32 s60, s52, 0
    buffer_load_dwordx4 v20, s[36:39], s60 offen lds
    s_add_u32 m0, s99, 73728
    s_add_u32 s60, s52, 57344
    buffer_load_dwordx4 v20, s[36:39], s60 offen lds
    s_add_u32 m0, s99, 77824
    s_add_u32 s60, s52, 114688
    buffer_load_dwordx4 v20, s[36:39], s60 offen lds
    s_add_u32 m0, s99, 81920
    s_add_u32 s60, s52, 172032
    buffer_load_dwordx4 v20, s[36:39], s60 offen lds
    s_add_u32 m0, s99, 86016
    s_add_u32 s60, s52, 229376
    buffer_load_dwordx4 v20, s[36:39], s60 offen lds
    s_add_u32 m0, s99, 90112
    s_add_u32 s60, s52, 286720
    buffer_load_dwordx4 v20, s[36:39], s60 offen lds
    s_add_u32 m0, s99, 94208
    s_add_u32 s60, s52, 344064
    buffer_load_dwordx4 v20, s[36:39], s60 offen lds
    s_add_u32 m0, s99, 98304
    s_add_u32 s60, s52, 401408
    buffer_load_dwordx4 v20, s[36:39], s60 offen lds
    v_bfe_u32 v2, v0, 4, 1
    v_bfe_u32 v3, v0, 2, 2
    v_lshrrev_b32 v4, 5, v0
    v_lshlrev_b32 v5, 11, v2
    v_lshl_add_u32 v5, v4, 9, v5
    v_lshl_add_u32 v5, v3, 7, v5
    v_and_b32 v6, 3, v0
    v_lshl_add_u32 v5, v6, 3, v5
    v_lshrrev_b32 v3, 1, v3
    v_lshl_or_b32 v3, v2, 1, v3
    v_lshl_add_u32 v8, v3, 5, v5
    v_add_u32 v8, 69632, v8
    v_xor_b32 v9, 0x20, v8
    v_xor_b32 v10, 0x40, v8
    v_xor_b32 v11, 0x60, v8
    v_add_u32 v16, 0x10000, v8
    v_add_u32 v17, 0x10000, v9
    v_add_u32 v18, 0x10000, v10
    v_add_u32 v19, 0x10000, v11
    s_lshl_b32 s60, s58, 2
    s_add_u32 s60, s60, s57
    s_mul_i32 s60, s60, 112
    s_mul_i32 s61, s59, 8
    s_mul_i32 s62, s59, 6
    s_add_u32 s62, s62, 16
    s_cmp_ge_u32 s59, 8
    s_cselect_b32 s61, s62, s61
    s_add_u32 s60, s60, s61
    s_lshl_b32 s60, s60, 10
    s_add_u32 s76, s60, 1048576
    s_waitcnt vmcnt(6)
    ds_add_u32 v28, v29
L_pl_9:
    ds_read_b32 v13, v30 offset:0
    s_waitcnt lgkmcnt(0)
    v_cmp_le_u32 vcc, 4, v13
    s_cbranch_vccnz L_pld_10
    s_sub_u32 s70, s70, 1
    s_cbranch_scc1 L_pld_10_x
    s_sleep 1
    s_branch L_pl_9
L_pld_10_x:
    s_mov_b32 s70, 0
L_pld_10:
    s_waitcnt vmcnt(4)
    ds_add_u32 v28, v29
    s_setprio 0
    ds_read_b64_tr_b16 v[32:33], v8 offset:0
    ds_read_b64_tr_b16 v[34:35], v8 offset:1024
    ds_read_b64_tr_b16 v[36:37], v9 offset:0
    ds_read_b64_tr_b16 v[38:39], v9 offset:1024
    ds_read_b64_tr_b16 v[40:41], v10 offset:0
    ds_read_b64_tr_b16 v[42:43], v10 offset:1024
    ds_read_b64_tr_b16 v[44:45], v11 offset:0
    ds_read_b64_tr_b16 v[46:47], v11 offset:1024
    ds_read_b64_tr_b16 v[48:49], v8 offset:4096
    ds_read_b64_tr_b16 v[50:51], v8 offset:5120
    ds_read_b64_tr_b16 v[52:53], v9 offset:4096
    ds_read_b64_tr_b16 v[54:55], v9 offset:5120
    ds_read_b32 v13, v30
    ds_read_b64_tr_b16 v[56:57], v10 offset:4096
    ds_read_b64_tr_b16 v[58:59], v10 offset:5120
    ds_read_b64_tr_b16 v[60:61], v11 offset:4096
    ds_read_b64_tr_b16 v[62:63], v11 offset:5120
    s_waitcnt lgkmcnt(13)
    v_mfma_f32_32x32x16_bf16 v[64:79], v[32:35], v[128:131], 0
    s_setprio 2
    s_waitcnt lgkmcnt(4)
    v_cmp_le_u32 vcc, 8, v13
    s_cbranch_vccz L_gs_11
L_gs_11_r:
L_pl_12:
    ds_read_b32 v13, v30 offset:8
    s_waitcnt lgkmcnt(0)
    v_cmp_le_u32 vcc, 4, v13
    s_cbranch_vccnz L_pld_13
    s_sub_u32 s70, s70, 1
    s_cbranch_scc1 L_pld_13_x
    s_sleep 1
    s_branch L_pl_12
L_pld_13_x:
    s_mov_b32 s70, 0
L_pld_13:
    s_setprio 0
    s_waitcnt vmcnt(2)
    ds_add_u32 v28, v29
    ds_read_b64_tr_b16 v[32:33], v8 offset:8192
    ds_read_b64_tr_b16 v[34:35], v8 offset:9216
    s_add_u32 m0, s99, 102400
    s_add_u32 s60, s53, 0
    buffer_load_dwordx4 v20, s[36:39], s60 offen lds
    v_mfma_f32_32x32x16_bf16 v[80:95], v[36:39], v[128:131], 0
    ds_read_b64_tr_b16 v[36:37], v9 offset:8192
    ds_read_b64_tr_b16 v[38:39], v9 offset:9216
    s_add_u32 m0, s99, 106496
    s_add_u32 s60, s53, 57344
    buffer_load_dwordx4 v20, s[36:39], s60 offen lds
    v_mfma_f32_32x32x16_bf16 v[96:111], v[40:43], v[128:131], 0
    ds_read_b64_tr_b16 v[40:41], v10 offset:8192
    ds_read_b64_tr_b16 v[42:43], v10 offset:9216
    s_add_u32 m0, s99, 110592
    s_add_u32 s60, s53, 114688
    buffer_load_dwordx4 v20, s[36:39], s60 offen lds
    v_mfma_f32_32x32x16_bf16 v[112:127], v[44:47], v[128:131], 0
    ds_read_b64_tr_b16 v[44:45], v11 offset:8192
    ds_read_b64_tr_b16 v[46:47], v11 offset:9216
    s_add_u32 m0, s99, 114688
    s_add_u32 s60, s53, 172032
    buffer_load_dwordx4 v20, s[36:39], s60 offen lds
    v_mfma_f32_32x32x16_bf16 v[64:79], v[48:51], v[132:135], v[64:79]
    ds_read_b64_tr_b16 v[48:49], v8 offset:12288
    ds_read_b64_tr_b16 v[50:51], v8 offset:13312
    s_add_u32 m0, s99, 118784
    s_add_u32 s60, s53, 229376
    buffer_load_dwordx4 v20, s[36:39], s60 offen lds
    v_mfma_f32_32x32x16_bf16 v[80:95], v[52:55], v[132:135], v[80:95]
    ds_read_b64_tr_b16 v[52:53], v9 offset:12288
    ds_read_b64_tr_b16 v[54:55], v9 offset:13312
    ds_read_b32 v13, v30
    s_add_u32 m0, s99, 122880
    s_add_u32 s60, s53, 286720
    buffer_load_dwordx4 v20, s[36:39], s60 offen lds
    v_mfma_f32_32x32x16_bf16 v[96:111], v[56:59], v[132:135], v[96:111]
    ds_read_b64_tr_b16 v[56:57], v10 offset:12288
    ds_read_b64_tr_b16 v[58:59], v10 offset:13312
    v_mfma_f32_32x32x16_bf16 v[112:127], v[60:63], v[132:135], v[112:127]
    ds_read_b64_tr_b16 v[60:61], v11 offset:12288
    ds_read_b64_tr_b16 v[62:63], v11 offset:13312
    s_waitcnt lgkmcnt(13)
    v_mfma_f32_32x32x16_bf16 v[64:79], v[32:35], v[136:139], v[64:79]
    s_setprio 2
    s_waitcnt lgkmcnt(4)
    v_cmp_le_u32 vcc, 12, v13
    s_cbranch_vccz L_gs_14
L_gs_14_r:
    s_lshl_b32 s60, s57, 2
    v_add_u32 v1, s60, v30
    s_mul_i32 s68, s57, 16384
    s_add_u32 s68, s68, 0
    s_lshl_b32 s69, s57, 14
L_pl_15:
    ds_read_b32 v13, v1 offset:16
    s_waitcnt lgkmcnt(0)
    v_cmp_le_u32 vcc, 1, v13
    s_cbranch_vccnz L_pld_16
    s_sub_u32 s70, s70, 1
    s_cbranch_scc1 L_pld_16_x
    s_sleep 1
    s_branch L_pl_15
L_pld_16_x:
    s_mov_b32 s70, 0
L_pld_16:
    s_setprio 0
    s_waitcnt vmcnt(6)
    ds_add_u32 v28, v29
    ds_read_b64_tr_b16 v[32:33], v8 offset:16384
    ds_read_b64_tr_b16 v[34:35], v8 offset:17408
    s_add_u32 m0, s68, 4096
    s_add_u32 s60, s69, 70656
    buffer_load_dwordx4 v12, s[32:35], s60 offen sc1 lds
    s_add_u32 m0, s68, 12288
    s_add_u32 s60, s69, 6144
    buffer_load_dwordx4 v12, s[32:35], s60 offen sc1 lds
    v_mfma_f32_32x32x16_bf16 v[80:95], v[36:39], v[136:139], v[80:95]
    ds_read_b64_tr_b16 v[36:37], v9 offset:16384
    ds_read_b64_tr_b16 v[38:39], v9 offset:17408
    s_add_u32 m0, s68, 5120
    s_add_u32 s60, s69, 71680
    buffer_load_dwordx4 v12, s[32:35], s60 offen sc1 lds
    s_add_u32 m0, s68, 13312
    s_add_u32 s60, s69, 7168
    buffer_load_dwordx4 v12, s[32:35], s60 offen sc1 lds
    v_mfma_f32_32x32x16_bf16 v[96:111], v[40:43], v[136:139], v[96:111]
    ds_read_b64_tr_b16 v[40:41], v10 offset:16384
    ds_read_b64_tr_b16 v[42:43], v10 offset:17408
    s_add_u32 m0, s99, 126976
    s_add_u32 s60, s53, 344064
    buffer_load_dwordx4 v20, s[36:39], s60 offen lds
    v_mfma_f32_32x32x16_bf16 v[112:127], v[44:47], v[136:139], v[112:127]
    ds_read_b64_tr_b16 v[44:45], v11 offset:16384
    ds_read_b64_tr_b16 v[46:47], v11 offset:17408
    s_add_u32 m0, s99, 131072
    s_add_u32 s60, s53, 401408
    buffer_load_dwordx4 v20, s[36:39], s60 offen lds
    v_mfma_f32_32x32x16_bf16 v[64:79], v[48:51], v[140:143], v[64:79]
    ds_read_b64_tr_b16 v[48:49], v8 offset:20480
    ds_read_b64_tr_b16 v[50:51], v8 offset:21504
    s_add_u32 m0, s99, 135168
    s_add_u32 s60, s54, 0
    buffer_load_dwordx4 v20, s[36:39], s60 offen lds
    v_mfma_f32_32x32x16_bf16 v[80:95], v[52:55], v[140:143], v[80:95]
    ds_read_b64_tr_b16 v[52:53], v9 offset:20480
    ds_read_b64_tr_b16 v[54:55], v9 offset:21504
    ds_read_b32 v13, v30
    s_add_u32 m0, s99, 139264
    s_add_u32 s60, s54, 57344
    buffer_load_dwordx4 v20, s[36:39], s60 offen lds
    v_mfma_f32_32x32x16_bf16 v[96:111], v[56:59], v[140:143], v[96:111]
    ds_read_b64_tr_b16 v[56:57], v10 offset:20480
    ds_read_b64_tr_b16 v[58:59], v10 offset:21504
    s_add_u32 m0, s99, 143360
    s_add_u32 s60, s54, 114688
    buffer_load_dwordx4 v20, s[36:39], s60 offen lds
    v_mfma_f32_32x32x16_bf16 v[112:127], v[60:63], v[140:143], v[112:127]
    ds_read_b64_tr_b16 v[60:61], v11 offset:20480
    ds_read_b64_tr_b16 v[62:63], v11 offset:21504
    s_add_u32 m0, s99, 147456
    s_add_u32 s60, s54, 172032
    buffer_load_dwordx4 v20, s[36:39], s60 offen lds
    s_waitcnt lgkmcnt(13)
    v_mfma_f32_32x32x16_bf16 v[64:79], v[32:35], v[144:147], v[64:79]
    s_setprio 2
    s_waitcnt lgkmcnt(4)
    v_cmp_le_u32 vcc, 16, v13
    s_cbranch_vccz L_gs_17
L_gs_17_r:
    s_setprio 0
    s_waitcnt vmcnt(14)
    ds_add_u32 v28, v29
    ds_read_b64_tr_b16 v[32:33], v8 offset:24576
    ds_read_b64_tr_b16 v[34:35], v8 offset:25600
    s_add_u32 m0, s68, 6144
    s_add_u32 s60, s69, 72704
    buffer_load_dwordx4 v12, s[32:35], s60 offen sc1 lds
    s_add_u32 m0, s68, 14336
    s_add_u32 s60, s69, 8192
    buffer_load_dwordx4 v12, s[32:35], s60 offen sc1 lds
    v_mfma_f32_32x32x16_bf16 v[80:95], v[36:39], v[144:147], v[80:95]
    ds_read_b64_tr_b16 v[36:37], v9 offset:24576
    ds_read_b64_tr_b16 v[38:39], v9 offset:25600
    s_add_u32 m0, s68, 7168
    s_add_u32 s60, s69, 73728
    buffer_load_dwordx4 v12, s[32:35], s60 offen sc1 lds
    s_add_u32 m0, s68, 15360
    s_add_u32 s60, s69, 9216
    buffer_load_dwordx4 v12, s[32:35], s60 offen sc1 lds
    v_mfma_f32_32x32x16_bf16 v[96:111], v[40:43], v[144:147], v[96:111]
    ds_read_b64_tr_b16 v[40:41], v10 offset:24576
    ds_read_b64_tr_b16 v[42:43], v10 offset:25600
    s_add_u32 m0, s99, 151552
    s_add_u32 s60, s54, 229376
    buffer_load_dwordx4 v20, s[36:39], s60 offen lds
    v_mfma_f32_32x32x16_bf16 v[112:127], v[44:47], v[144:147], v[112:127]
    ds_read_b64_tr_b16 v[44:45], v11 offset:24576
    ds_read_b64_tr_b16 v[46:47], v11 offset:25600
    s_add_u32 m0, s99, 155648
    s_add_u32 s60, s54, 286720
    buffer_load_dwordx4 v20, s[36:39], s60 offen lds
    v_mfma_f32_32x32x16_bf16 v[64:79], v[48:51], v[148:151], v[64:79]
    ds_read_b64_tr_b16 v[48:49], v8 offset:28672
    ds_read_b64_tr_b16 v[50:51], v8 offset:29696
    s_add_u32 m0, s99, 69632
    s_add_u32 s60, s54, 344064
    buffer_load_dwordx4 v20, s[36:39], s60 offen lds
    v_mfma_f32_32x32x16_bf16 v[80:95], v[52:55], v[148:151], v[80:95]
    ds_read_b64_tr_b16 v[52:53], v9 offset:28672
    ds_read_b64_tr_b16 v[54:55], v9 offset:29696
    ds_read_b32 v13, v30
    s_add_u32 m0, s99, 73728
    s_add_u32 s60, s54, 401408
    buffer_load_dwordx4 v20, s[36:39], s60 offen lds
    s_waitcnt lgkmcnt(14)
    v_mfma_f32_32x32x16_bf16 v[96:111], v[56:59], v[148:151], v[96:111]
    ds_read_b64_tr_b16 v[56:57], v10 offset:28672
    ds_read_b64_tr_b16 v[58:59], v10 offset:29696
    s_add_u32 m0, s99, 77824
    s_add_u32 s60, s55, 0
    buffer_load_dwordx4 v20, s[36:39], s60 offen lds
    v_mfma_f32_32x32x16_bf16 v[112:127], v[60:63], v[148:151], v[112:127]
    ds_read_b64_tr_b16 v[60:61], v11 offset:28672
    ds_read_b64_tr_b16 v[62:63], v11 offset:29696
    s_add_u32 m0, s99, 81920
    s_add_u32 s60, s55, 57344
    buffer_load_dwordx4 v20, s[36:39], s60 offen lds
    s_waitcnt lgkmcnt(13)
    v_mfma_f32_32x32x16_bf16 v[64:79], v[32:35], v[152:155], v[64:79]
    s_setprio 2
    s_waitcnt lgkmcnt(4)
    v_cmp_le_u32 vcc, 20, v13
    s_cbranch_vccz L_gs_18
L_gs_18_r:
    s_setprio 0
    s_waitcnt vmcnt(22)
    ds_add_u32 v28, v29
    ds_read_b64_tr_b16 v[32:33], v8 offset:32768
    ds_read_b64_tr_b16 v[34:35], v8 offset:33792
    s_add_u32 m0, s99, 86016
    s_add_u32 s60, s55, 114688
    buffer_load_dwordx4 v20, s[36:39], s60 offen lds
    v_mfma_f32_32x32x16_bf16 v[80:95], v[36:39], v[152:155], v[80:95]
    ds_read_b64_tr_b16 v[36:37], v9 offset:32768
    ds_read_b64_tr_b16 v[38:39], v9 offset:33792
    s_add_u32 m0, s99, 90112
    s_add_u32 s60, s55, 172032
    buffer_load_dwordx4 v20, s[36:39], s60 offen lds
    v_mfma_f32_32x32x16_bf16 v[96:111], v[40:43], v[152:155], v[96:111]
    ds_read_b64_tr_b16 v[40:41], v10 offset:32768
    ds_read_b64_tr_b16 v[42:43], v10 offset:33792
    v_mfma_f32_32x32x16_bf16 v[112:127], v[44:47], v[152:155], v[112:127]
    ds_read_b64_tr_b16 v[44:45], v11 offset:32768
    ds_read_b64_tr_b16 v[46:47], v11 offset:33792
    v_mfma_f32_32x32x16_bf16 v[64:79], v[48:51], v[156:159], v[64:79]
    ds_read_b64_tr_b16 v[48:49], v8 offset:36864
    ds_read_b64_tr_b16 v[50:51], v8 offset:37888
    v_mfma_f32_32x32x16_bf16 v[80:95], v[52:55], v[156:159], v[80:95]
    ds_read_b64_tr_b16 v[52:53], v9 offset:36864
    ds_read_b64_tr_b16 v[54:55], v9 offset:37888
    ds_read_b32 v13, v30
    s_waitcnt lgkmcnt(14)
    v_mfma_f32_32x32x16_bf16 v[96:111], v[56:59], v[156:159], v[96:111]
    ds_read_b64_tr_b16 v[56:57], v10 offset:36864
    ds_read_b64_tr_b16 v[58:59], v10 offset:37888
    v_mfma_f32_32x32x16_bf16 v[112:127], v[60:63], v[156:159], v[112:127]
    ds_read_b64_tr_b16 v[60:61], v11 offset:36864
    ds_read_b64_tr_b16 v[62:63], v11 offset:37888
    s_waitcnt lgkmcnt(13)
    v_mfma_f32_32x32x16_bf16 v[64:79], v[32:35], v[160:163], v[64:79]
    s_setprio 2
    s_waitcnt lgkmcnt(4)
    v_cmp_le_u32 vcc, 24, v13
    s_cbranch_vccz L_gs_19
L_gs_19_r:
    s_setprio 0
    s_waitcnt vmcnt(22)
    ds_add_u32 v28, v29
    ds_read_b64_tr_b16 v[32:33], v8 offset:40960
    ds_read_b64_tr_b16 v[34:35], v8 offset:41984
    s_add_u32 m0, s99, 94208
    s_add_u32 s60, s55, 229376
    buffer_load_dwordx4 v20, s[36:39], s60 offen lds
    v_mfma_f32_32x32x16_bf16 v[80:95], v[36:39], v[160:163], v[80:95]
    ds_read_b64_tr_b16 v[36:37], v9 offset:40960
    ds_read_b64_tr_b16 v[38:39], v9 offset:41984
    s_add_u32 m0, s99, 98304
    s_add_u32 s60, s55, 286720
    buffer_load_dwordx4 v20, s[36:39], s60 offen lds
    v_mfma_f32_32x32x16_bf16 v[96:111], v[40:43], v[160:163], v[96:111]
    ds_read_b64_tr_b16 v[40:41], v10 offset:40960
    ds_read_b64_tr_b16 v[42:43], v10 offset:41984
    v_mfma_f32_32x32x16_bf16 v[112:127], v[44:47], v[160:163], v[112:127]
    ds_read_b64_tr_b16 v[44:45], v11 offset:40960
    ds_read_b64_tr_b16 v[46:47], v11 offset:41984
    v_mfma_f32_32x32x16_bf16 v[64:79], v[48:51], v[164:167], v[64:79]
    ds_read_b64_tr_b16 v[48:49], v8 offset:45056
    ds_read_b64_tr_b16 v[50:51], v8 offset:46080
    v_mfma_f32_32x32x16_bf16 v[80:95], v[52:55], v[164:167], v[80:95]
    ds_read_b64_tr_b16 v[52:53], v9 offset:45056
    ds_read_b64_tr_b16 v[54:55], v9 offset:46080
    ds_read_b32 v13, v30
    s_waitcnt lgkmcnt(14)
    v_mfma_f32_32x32x16_bf16 v[96:111], v[56:59], v[164:167], v[96:111]
    ds_read_b64_tr_b16 v[56:57], v10 offset:45056
    ds_read_b64_tr_b16 v[58:59], v10 offset:46080
    v_mfma_f32_32x32x16_bf16 v[112:127], v[60:63], v[164:167], v[112:127]
    ds_read_b64_tr_b16 v[60:61], v11 offset:45056
    ds_read_b64_tr_b16 v[62:63], v11 offset:46080
    s_waitcnt lgkmcnt(13)
    v_mfma_f32_32x32x16_bf16 v[64:79], v[32:35], v[168:171], v[64:79]
    s_setprio 2
    s_waitcnt lgkmcnt(4)
    v_cmp_le_u32 vcc, 28, v13
    s_cbranch_vccz L_gs_20
L_gs_20_r:
    s_setprio 0
    s_waitcnt vmcnt(18)
    ds_add_u32 v28, v29
    s_waitcnt vmcnt(10)
    s_mov_b64 exec, 1
    ds_add_u32 v1, v29 offset:32
    s_mov_b64 exec, -1
    ds_read_b64_tr_b16 v[32:33], v8 offset:49152
    ds_read_b64_tr_b16 v[34:35], v8 offset:50176
    s_add_u32 m0, s99, 102400
    s_add_u32 s60, s55, 344064
    buffer_load_dwordx4 v20, s[36:39], s60 offen lds
    v_mfma_f32_32x32x16_bf16 v[80:95], v[36:39], v[168:171], v[80:95]
    ds_read_b64_tr_b16 v[36:37], v9 offset:49152
    ds_read_b64_tr_b16 v[38:39], v9 offset:50176
    s_add_u32 m0, s99, 106496
    s_add_u32 s60, s55, 401408
    buffer_load_dwordx4 v20, s[36:39], s60 offen lds
    v_mfma_f32_32x32x16_bf16 v[96:111], v[40:43], v[168:171], v[96:111]
    ds_read_b64_tr_b16 v[40:41], v10 offset:49152
    ds_read_b64_tr_b16 v[42:43], v10 offset:50176
    v_mfma_f32_32x32x16_bf16 v[112:127], v[44:47], v[168:171], v[112:127]
    ds_read_b64_tr_b16 v[44:45], v11 offset:49152
    ds_read_b64_tr_b16 v[46:47], v11 offset:50176
    v_mfma_f32_32x32x16_bf16 v[64:79], v[48:51], v[172:175], v[64:79]
    ds_read_b64_tr_b16 v[48:49], v8 offset:53248
    ds_read_b64_tr_b16 v[50:51], v8 offset:54272
    v_mfma_f32_32x32x16_bf16 v[80:95], v[52:55], v[172:175], v[80:95]
    ds_read_b64_tr_b16 v[52:53], v9 offset:53248
    ds_read_b64_tr_b16 v[54:55], v9 offset:54272
    ds_read_b32 v13, v30
    s_waitcnt lgkmcnt(15)
    v_mfma_f32_32x32x16_bf16 v[96:111], v[56:59], v[172:175], v[96:111]
    ds_read_b64_tr_b16 v[56:57], v10 offset:53248
    ds_read_b64_tr_b16 v[58:59], v10 offset:54272
    v_mfma_f32_32x32x16_bf16 v[112:127], v[60:63], v[172:175], v[112:127]
    ds_read_b64_tr_b16 v[60:61], v11 offset:53248
    ds_read_b64_tr_b16 v[62:63], v11 offset:54272
    s_waitcnt lgkmcnt(13)
    v_mfma_f32_32x32x16_bf16 v[64:79], v[32:35], v[176:179], v[64:79]
    s_setprio 2
    s_waitcnt lgkmcnt(4)
    v_cmp_le_u32 vcc, 32, v13
    s_cbranch_vccz L_gs_21
L_gs_21_r:
    s_setprio 0
    ds_add_u32 v28, v29
    ds_read_b64_tr_b16 v[32:33], v8 offset:57344
    ds_read_b64_tr_b16 v[34:35], v8 offset:58368
    s_add_u32 m0, s99, 110592
    s_add_u32 s60, s52, 0
    buffer_load_dwordx4 v21, s[36:39], s60 offen lds
    v_mfma_f32_32x32x16_bf16 v[80:95], v[36:39], v[176:179], v[80:95]
    ds_read_b64_tr_b16 v[36:37], v9 offset:57344
    ds_read_b64_tr_b16 v[38:39], v9 offset:58368
    s_add_u32 m0, s99, 114688
    s_add_u32 s60, s52, 57344
    buffer_load_dwordx4 v21, s[36:39], s60 offen lds
    v_mfma_f32_32x32x16_bf16 v[96:111], v[40:43], v[176:179], v[96:111]
    ds_read_b64_tr_b16 v[40:41], v10 offset:57344
    ds_read_b64_tr_b16 v[42:43], v10 offset:58368
    v_mfma_f32_32x32x16_bf16 v[112:127], v[44:47], v[176:179], v[112:127]
    ds_read_b64_tr_b16 v[44:45], v11 offset:57344
    ds_read_b64_tr_b16 v[46:47], v11 offset:58368
    v_mfma_f32_32x32x16_bf16 v[64:79], v[48:51], v[180:183], v[64:79]
    ds_read_b64_tr_b16 v[48:49], v8 offset:61440
    ds_read_b64_tr_b16 v[50:51], v8 offset:62464
    v_mfma_f32_32x32x16_bf16 v[80:95], v[52:55], v[180:183], v[80:95]
    ds_read_b64_tr_b16 v[52:53], v9 offset:61440
    ds_read_b64_tr_b16 v[54:55], v9 offset:62464
    ds_read_b32 v13, v30
    s_waitcnt lgkmcnt(14)
    v_mfma_f32_32x32x16_bf16 v[96:111], v[56:59], v[180:183], v[96:111]
    ds_read_b64_tr_b16 v[56:57], v10 offset:61440
    ds_read_b64_tr_b16 v[58:59], v10 offset:62464
    v_mfma_f32_32x32x16_bf16 v[112:127], v[60:63], v[180:183], v[112:127]
    ds_read_b64_tr_b16 v[60:61], v11 offset:61440
    ds_read_b64_tr_b16 v[62:63], v11 offset:62464
    s_waitcnt lgkmcnt(13)
    v_mfma_f32_32x32x16_bf16 v[64:79], v[32:35], v[184:187], v[64:79]
    s_setprio 2
    s_waitcnt lgkmcnt(4)
    v_cmp_le_u32 vcc, 36, v13
    s_cbranch_vccz L_gs_22
L_gs_22_r:
    s_setprio 0
    ds_add_u32 v28, v29
    ds_read_b64_tr_b16 v[32:33], v16 offset:0
    ds_read_b64_tr_b16 v[34:35], v16 offset:1024
    s_add_u32 m0, s99, 118784
    s_add_u32 s60, s52, 114688
    buffer_load_dwordx4 v21, s[36:39], s60 offen lds
    v_mfma_f32_32x32x16_bf16 v[80:95], v[36:39], v[184:187], v[80:95]
    ds_read_b64_tr_b16 v[36:37], v17 offset:0
    ds_read_b64_tr_b16 v[38:39], v17 offset:1024
    s_add_u32 m0, s99, 122880
    s_add_u32 s60, s52, 172032
    buffer_load_dwordx4 v21, s[36:39], s60 offen lds
    v_mfma_f32_32x32x16_bf16 v[96:111], v[40:43], v[184:187], v[96:111]
    ds_read_b64_tr_b16 v[40:41], v18 offset:0
    ds_read_b64_tr_b16 v[42:43], v18 offset:1024
    v_mfma_f32_32x32x16_bf16 v[112:127], v[44:47], v[184:187], v[112:127]
    ds_read_b64_tr_b16 v[44:45], v19 offset:0
    ds_read_b64_tr_b16 v[46:47], v19 offset:1024
    v_mfma_f32_32x32x16_bf16 v[64:79], v[48:51], v[188:191], v[64:79]
    ds_read_b64_tr_b16 v[48:49], v16 offset:4096
    ds_read_b64_tr_b16 v[50:51], v16 offset:5120
    v_mfma_f32_32x32x16_bf16 v[80:95], v[52:55], v[188:191], v[80:95]
    ds_read_b64_tr_b16 v[52:53], v17 offset:4096
    ds_read_b64_tr_b16 v[54:55], v17 offset:5120
    ds_read_b32 v13, v30
    s_waitcnt lgkmcnt(14)
    v_mfma_f32_32x32x16_bf16 v[96:111], v[56:59], v[188:191], v[96:111]
    ds_read_b64_tr_b16 v[56:57], v18 offset:4096
    ds_read_b64_tr_b16 v[58:59], v18 offset:5120
    v_mfma_f32_32x32x16_bf16 v[112:127], v[60:63], v[188:191], v[112:127]
    ds_read_b64_tr_b16 v[60:61], v19 offset:4096
    ds_read_b64_tr_b16 v[62:63], v19 offset:5120
    s_waitcnt lgkmcnt(13)
    v_mfma_f32_32x32x16_bf16 v[64:79], v[32:35], v[192:195], v[64:79]
    s_setprio 2
    s_waitcnt lgkmcnt(4)
    v_cmp_le_u32 vcc, 40, v13
    s_cbranch_vccz L_gs_23
L_gs_23_r:
    s_setprio 0
    s_waitcnt vmcnt(14)
    ds_add_u32 v28, v29
    ds_read_b64_tr_b16 v[32:33], v16 offset:8192
    ds_read_b64_tr_b16 v[34:35], v16 offset:9216
    s_add_u32 m0, s99, 126976
    s_add_u32 s60, s52, 229376
    buffer_load_dwordx4 v21, s[36:39], s60 offen lds
    v_mfma_f32_32x32x16_bf16 v[80:95], v[36:39], v[192:195], v[80:95]
    ds_read_b64_tr_b16 v[36:37], v17 offset:8192
    ds_read_b64_tr_b16 v[38:39], v17 offset:9216
    s_add_u32 m0, s99, 131072
    s_add_u32 s60, s52, 286720
    buffer_load_dwordx4 v21, s[36:39], s60 offen lds
    v_mfma_f32_32x32x16_bf16 v[96:111], v[40:43], v[192:195], v[96:111]
    ds_read_b64_tr_b16 v[40:41], v18 offset:8192
    ds_read_b64_tr_b16 v[42:43], v18 offset:9216
    v_mfma_f32_32x32x16_bf16 v[112:127], v[44:47], v[192:195], v[112:127]
    ds_read_b64_tr_b16 v[44:45], v19 offset:8192
    ds_read_b64_tr_b16 v[46:47], v19 offset:9216
    v_mfma_f32_32x32x16_bf16 v[64:79], v[48:51], v[196:199], v[64:79]
    ds_read_b64_tr_b16 v[48:49], v16 offset:12288
    ds_read_b64_tr_b16 v[50:51], v16 offset:13312
    v_mfma_f32_32x32x16_bf16 v[80:95], v[52:55], v[196:199], v[80:95]
    ds_read_b64_tr_b16 v[52:53], v17 offset:12288
    ds_read_b64_tr_b16 v[54:55], v17 offset:13312
    ds_read_b32 v13, v30
    s_waitcnt lgkmcnt(14)
    v_mfma_f32_32x32x16_bf16 v[96:111], v[56:59], v[196:199], v[96:111]
    ds_read_b64_tr_b16 v[56:57], v18 offset:12288
    ds_read_b64_tr_b16 v[58:59], v18 offset:13312
    v_mfma_f32_32x32x16_bf16 v[112:127], v[60:63], v[196:199], v[112:127]
    ds_read_b64_tr_b16 v[60:61], v19 offset:12288
    ds_read_b64_tr_b16 v[62:63], v19 offset:13312
    s_waitcnt lgkmcnt(13)
    v_mfma_f32_32x32x16_bf16 v[64:79], v[32:35], v[200:203], v[64:79]
    s_setprio 2
    s_waitcnt lgkmcnt(4)
    v_cmp_le_u32 vcc, 44, v13
    s_cbranch_vccz L_gs_24
L_gs_24_r:
    s_setprio 0
    s_waitcnt vmcnt(14)
    ds_add_u32 v28, v29
    ds_read_b64_tr_b16 v[32:33], v16 offset:16384
    ds_read_b64_tr_b16 v[34:35], v16 offset:17408
    s_add_u32 m0, s99, 135168
    s_add_u32 s60, s52, 344064
    buffer_load_dwordx4 v21, s[36:39], s60 offen lds
    v_mfma_f32_32x32x16_bf16 v[80:95], v[36:39], v[200:203], v[80:95]
    ds_read_b64_tr_b16 v[36:37], v17 offset:16384
    ds_read_b64_tr_b16 v[38:39], v17 offset:17408
    s_add_u32 m0, s99, 139264
    s_add_u32 s60, s52, 401408
    buffer_load_dwordx4 v21, s[36:39], s60 offen lds
    v_mfma_f32_32x32x16_bf16 v[96:111], v[40:43], v[200:203], v[96:111]
    ds_read_b64_tr_b16 v[40:41], v18 offset:16384
    ds_read_b64_tr_b16 v[42:43], v18 offset:17408
    v_mfma_f32_32x32x16_bf16 v[112:127], v[44:47], v[200:203], v[112:127]
    ds_read_b64_tr_b16 v[44:45], v19 offset:16384
    ds_read_b64_tr_b16 v[46:47], v19 offset:17408
    v_mfma_f32_32x32x16_bf16 v[64:79], v[48:51], v[204:207], v[64:79]
    ds_read_b64_tr_b16 v[48:49], v16 offset:20480
    ds_read_b64_tr_b16 v[50:51], v16 offset:21504
    v_mfma_f32_32x32x16_bf16 v[80:95], v[52:55], v[204:207], v[80:95]
    ds_read_b64_tr_b16 v[52:53], v17 offset:20480
    ds_read_b64_tr_b16 v[54:55], v17 offset:21504
    ds_read_b32 v13, v30
    s_waitcnt lgkmcnt(14)
    v_mfma_f32_32x32x16_bf16 v[96:111], v[56:59], v[204:207], v[96:111]
    ds_read_b64_tr_b16 v[56:57], v18 offset:20480
    ds_read_b64_tr_b16 v[58:59], v18 offset:21504
    v_mfma_f32_32x32x16_bf16 v[112:127], v[60:63], v[204:207], v[112:127]
    ds_read_b64_tr_b16 v[60:61], v19 offset:20480
    ds_read_b64_tr_b16 v[62:63], v19 offset:21504
    s_waitcnt lgkmcnt(13)
    v_mfma_f32_32x32x16_bf16 v[64:79], v[32:35], v[208:211], v[64:79]
    s_setprio 2
    s_waitcnt lgkmcnt(4)
    v_cmp_le_u32 vcc, 48, v13
    s_cbranch_vccz L_gs_25
L_gs_25_r:
    s_setprio 0
    s_waitcnt vmcnt(14)
    ds_add_u32 v28, v29
    ds_read_b64_tr_b16 v[32:33], v8 offset:0
    ds_read_b64_tr_b16 v[34:35], v8 offset:1024
    s_add_u32 m0, s99, 143360
    s_add_u32 s60, s53, 0
    buffer_load_dwordx4 v21, s[36:39], s60 offen lds
    v_mfma_f32_32x32x16_bf16 v[80:95], v[36:39], v[208:211], v[80:95]
    ds_read_b64_tr_b16 v[36:37], v9 offset:0
    ds_read_b64_tr_b16 v[38:39], v9 offset:1024
    s_add_u32 m0, s99, 147456
    s_add_u32 s60, s53, 57344
    buffer_load_dwordx4 v21, s[36:39], s60 offen lds
    v_mfma_f32_32x32x16_bf16 v[96:111], v[40:43], v[208:211], v[96:111]
    ds_read_b64_tr_b16 v[40:41], v10 offset:0
    ds_read_b64_tr_b16 v[42:43], v10 offset:1024
    v_mfma_f32_32x32x16_bf16 v[112:127], v[44:47], v[208:211], v[112:127]
    ds_read_b64_tr_b16 v[44:45], v11 offset:0
    ds_read_b64_tr_b16 v[46:47], v11 offset:1024
    v_mfma_f32_32x32x16_bf16 v[64:79], v[48:51], v[212:215], v[64:79]
    ds_read_b64_tr_b16 v[48:49], v8 offset:4096
    ds_read_b64_tr_b16 v[50:51], v8 offset:5120
    v_mfma_f32_32x32x16_bf16 v[80:95], v[52:55], v[212:215], v[80:95]
    ds_read_b64_tr_b16 v[52:53], v9 offset:4096
    ds_read_b64_tr_b16 v[54:55], v9 offset:5120
    ds_read_b32 v13, v30
    s_waitcnt lgkmcnt(14)
    v_mfma_f32_32x32x16_bf16 v[96:111], v[56:59], v[212:215], v[96:111]
    ds_read_b64_tr_b16 v[56:57], v10 offset:4096
    ds_read_b64_tr_b16 v[58:59], v10 offset:5120
    v_mfma_f32_32x32x16_bf16 v[112:127], v[60:63], v[212:215], v[112:127]
    ds_read_b64_tr_b16 v[60:61], v11 offset:4096
    ds_read_b64_tr_b16 v[62:63], v11 offset:5120
    s_waitcnt lgkmcnt(13)
    v_mfma_f32_32x32x16_bf16 v[64:79], v[32:35], v[216:219], v[64:79]
    s_setprio 2
    s_waitcnt lgkmcnt(4)
    v_cmp_le_u32 vcc, 52, v13
    s_cbranch_vccz L_gs_26
L_gs_26_r:
    s_setprio 0
    s_waitcnt vmcnt(14)
    ds_add_u32 v28, v29
    ds_read_b64_tr_b16 v[32:33], v8 offset:8192
    ds_read_b64_tr_b16 v[34:35], v8 offset:9216
    s_add_u32 m0, s99, 151552
    s_add_u32 s60, s53, 114688
    buffer_load_dwordx4 v21, s[36:39], s60 offen lds
    v_mfma_f32_32x32x16_bf16 v[80:95], v[36:39], v[216:219], v[80:95]
    ds_read_b64_tr_b16 v[36:37], v9 offset:8192
    ds_read_b64_tr_b16 v[38:39], v9 offset:9216
    s_add_u32 m0, s99, 155648
    s_add_u32 s60, s53, 172032
    buffer_load_dwordx4 v21, s[36:39], s60 offen lds
    v_mfma_f32_32x32x16_bf16 v[96:111], v[40:43], v[216:219], v[96:111]
    ds_read_b64_tr_b16 v[40:41], v10 offset:8192
    ds_read_b64_tr_b16 v[42:43], v10 offset:9216
    v_mfma_f32_32x32x16_bf16 v[112:127], v[44:47], v[216:219], v[112:127]
    ds_read_b64_tr_b16 v[44:45], v11 offset:8192
    ds_read_b64_tr_b16 v[46:47], v11 offset:9216
    v_mfma_f32_32x32x16_bf16 v[64:79], v[48:51], v[220:223], v[64:79]
    ds_read_b64_tr_b16 v[48:49], v8 offset:12288
    ds_read_b64_tr_b16 v[50:51], v8 offset:13312
    v_mfma_f32_32x32x16_bf16 v[80:95], v[52:55], v[220:223], v[80:95]
    ds_read_b64_tr_b16 v[52:53], v9 offset:12288
    ds_read_b64_tr_b16 v[54:55], v9 offset:13312
    ds_read_b32 v13, v30
    s_waitcnt lgkmcnt(14)
    v_mfma_f32_32x32x16_bf16 v[96:111], v[56:59], v[220:223], v[96:111]
    ds_read_b64_tr_b16 v[56:57], v10 offset:12288
    ds_read_b64_tr_b16 v[58:59], v10 offset:13312
    v_mfma_f32_32x32x16_bf16 v[112:127], v[60:63], v[220:223], v[112:127]
    ds_read_b64_tr_b16 v[60:61], v11 offset:12288
    ds_read_b64_tr_b16 v[62:63], v11 offset:13312
    s_waitcnt lgkmcnt(13)
    v_mfma_f32_32x32x16_bf16 v[64:79], v[32:35], v[224:227], v[64:79]
    s_setprio 2
    s_waitcnt lgkmcnt(4)
    v_cmp_le_u32 vcc, 56, v13
    s_cbranch_vccz L_gs_27
L_gs_27_r:
    s_setprio 0
    s_waitcnt vmcnt(14)
    ds_add_u32 v28, v29
    ds_read_b64_tr_b16 v[32:33], v8 offset:16384
    ds_read_b64_tr_b16 v[34:35], v8 offset:17408
    s_add_u32 m0, s99, 69632
    s_add_u32 s60, s53, 229376
    buffer_load_dwordx4 v21, s[36:39], s60 offen lds
    v_mfma_f32_32x32x16_bf16 v[80:95], v[36:39], v[224:227], v[80:95]
    ds_read_b64_tr_b16 v[36:37], v9 offset:16384
    ds_read_b64_tr_b16 v[38:39], v9 offset:17408
    s_add_u32 m0, s99, 73728
    s_add_u32 s60, s53, 286720
    buffer_load_dwordx4 v21, s[36:39], s60 offen lds
    v_mfma_f32_32x32x16_bf16 v[96:111], v[40:43], v[224:227], v[96:111]
    ds_read_b64_tr_b16 v[40:41], v10 offset:16384
    ds_read_b64_tr_b16 v[42:43], v10 offset:17408
    v_mfma_f32_32x32x16_bf16 v[112:127], v[44:47], v[224:227], v[112:127]
    ds_read_b64_tr_b16 v[44:45], v11 offset:16384
    ds_read_b64_tr_b16 v[46:47], v11 offset:17408
    v_mfma_f32_32x32x16_bf16 v[64:79], v[48:51], v[228:231], v[64:79]
    ds_read_b64_tr_b16 v[48:49], v8 offset:20480
    ds_read_b64_tr_b16 v[50:51], v8 offset:21504
    v_mfma_f32_32x32x16_bf16 v[80:95], v[52:55], v[228:231], v[80:95]
    ds_read_b64_tr_b16 v[52:53], v9 offset:20480
    ds_read_b64_tr_b16 v[54:55], v9 offset:21504
    ds_read_b32 v13, v30
    s_waitcnt lgkmcnt(14)
    v_mfma_f32_32x32x16_bf16 v[96:111], v[56:59], v[228:231], v[96:111]
    ds_read_b64_tr_b16 v[56:57], v10 offset:20480
    ds_read_b64_tr_b16 v[58:59], v10 offset:21504
    v_mfma_f32_32x32x16_bf16 v[112:127], v[60:63], v[228:231], v[112:127]
    ds_read_b64_tr_b16 v[60:61], v11 offset:20480
    ds_read_b64_tr_b16 v[62:63], v11 offset:21504
    s_waitcnt lgkmcnt(13)
    v_mfma_f32_32x32x16_bf16 v[64:79], v[32:35], v[232:235], v[64:79]
    s_setprio 2
    s_waitcnt lgkmcnt(4)
    v_cmp_le_u32 vcc, 60, v13
    s_cbranch_vccz L_gs_28
L_gs_28_r:
L_pl_29:
    ds_read_b32 v13, v1 offset:16
    s_waitcnt lgkmcnt(0)
    v_cmp_le_u32 vcc, 2, v13
    s_cbranch_vccnz L_pld_30
    s_sub_u32 s70, s70, 1
    s_cbranch_scc1 L_pld_30_x
    s_sleep 1
    s_branch L_pl_29
L_pld_30_x:
    s_mov_b32 s70, 0
L_pld_30:
    s_setprio 0
    s_waitcnt vmcnt(14)
    ds_add_u32 v28, v29
    ds_read_b64_tr_b16 v[32:33], v8 offset:24576
    ds_read_b64_tr_b16 v[34:35], v8 offset:25600
    s_add_u32 m0, s68, 0
    s_add_u32 s60, s69, 74752
    buffer_load_dwordx4 v12, s[32:35], s60 offen sc1 lds
    s_add_u32 m0, s68, 8192
    s_add_u32 s60, s69, 10240
    buffer_load_dwordx4 v12, s[32:35], s60 offen sc1 lds
    v_mfma_f32_32x32x16_bf16 v[80:95], v[36:39], v[232:235], v[80:95]
    ds_read_b64_tr_b16 v[36:37], v9 offset:24576
    ds_read_b64_tr_b16 v[38:39], v9 offset:25600
    s_add_u32 m0, s68, 1024
    s_add_u32 s60, s69, 75776
    buffer_load_dwordx4 v12, s[32:35], s60 offen sc1 lds
    s_add_u32 m0, s68, 9216
    s_add_u32 s60, s69, 11264
    buffer_load_dwordx4 v12, s[32:35], s60 offen sc1 lds
    v_mfma_f32_32x32x16_bf16 v[96:111], v[40:43], v[232:235], v[96:111]
    ds_read_b64_tr_b16 v[40:41], v10 offset:24576
    ds_read_b64_tr_b16 v[42:43], v10 offset:25600
    s_setprio 2
    s_and_b32 s61, s58, 3
    v_lshlrev_b32 v22, 10, v0
    s_add_u32 s62, s59, 0
    s_and_b32 s62, s62, 7
    s_lshl_b32 s62, s62, 7
    s_lshl_b32 s63, s61, 2
    s_add_u32 s63, s63, s57
    s_mul_i32 s14, s63, 64
    s_mul_i32 s15, s63, 32
    s_add_u32 s15, s15, 256
    s_cmp_ge_u32 s63, 8
    s_cselect_b32 s15, s15, s14
    s_add_u32 s15, s15, 1024
    s_min_u32 s15, s15, 1728
    s_lshl_b32 s15, s15, 10
    s_add_u32 s15, s15, s62
    s_lshl_b32 s14, s63, 16
    s_add_u32 s14, s14, s62
    s_lshl_b32 s3, s63, 15
    s_add_u32 s3, s3, s62
    s_lshl_b32 s98, s57, 10
    s_add_u32 s98, s98, 159744
    s_setprio 0
    v_mfma_f32_32x32x16_bf16 v[112:127], v[44:47], v[232:235], v[112:127]
    ds_read_b64_tr_b16 v[44:45], v11 offset:24576
    ds_read_b64_tr_b16 v[46:47], v11 offset:25600
    s_add_u32 m0, s98, 0
    s_add_u32 s60, s14, 0
    s_mov_b64 exec, 0xff
    buffer_load_dword v22, s[40:43], s60 offen lds
    s_mov_b64 exec, -1
    v_mfma_f32_32x32x16_bf16 v[64:79], v[48:51], v[236:239], v[64:79]
    ds_read_b64_tr_b16 v[48:49], v8 offset:28672
    ds_read_b64_tr_b16 v[50:51], v8 offset:29696
    s_add_u32 m0, s98, 32
    s_add_u32 s60, s14, 8192
    s_mov_b64 exec, 0xff
    buffer_load_dword v22, s[40:43], s60 offen lds
    s_mov_b64 exec, -1
    v_mfma_f32_32x32x16_bf16 v[80:95], v[52:55], v[236:239], v[80:95]
    ds_read_b64_tr_b16 v[52:53], v9 offset:28672
    ds_read_b64_tr_b16 v[54:55], v9 offset:29696
    ds_read_b32 v13, v30
    s_add_u32 m0, s99, 77824
    s_add_u32 s60, s53, 344064
    buffer_load_dwordx4 v21, s[36:39], s60 offen lds
    v_mfma_f32_32x32x16_bf16 v[96:111], v[56:59], v[236:239], v[96:111]
    ds_read_b64_tr_b16 v[56:57], v10 offset:28672
    ds_read_b64_tr_b16 v[58:59], v10 offset:29696
    s_add_u32 m0, s99, 81920
    s_add_u32 s60, s53, 401408
    buffer_load_dwordx4 v21, s[36:39], s60 offen lds
    v_mfma_f32_32x32x16_bf16 v[112:127], v[60:63], v[236:239], v[112:127]
    ds_read_b64_tr_b16 v[60:61], v11 offset:28672
    ds_read_b64_tr_b16 v[62:63], v11 offset:29696
    s_waitcnt lgkmcnt(13)
    v_mfma_f32_32x32x16_bf16 v[64:79], v[32:35], v[240:243], v[64:79]
    s_setprio 2
    s_waitcnt lgkmcnt(4)
    v_cmp_le_u32 vcc, 64, v13
    s_cbranch_vccz L_gs_31
L_gs_31_r:
    s_setprio 0
    s_waitcnt vmcnt(20)
    ds_add_u32 v28, v29
    ds_read_b64_tr_b16 v[32:33], v8 offset:32768
    ds_read_b64_tr_b16 v[34:35], v8 offset:33792
    s_add_u32 m0, s68, 2048
    s_add_u32 s60, s69, 76800
    buffer_load_dwordx4 v12, s[32:35], s60 offen sc1 lds
    s_add_u32 m0, s68, 10240
    s_add_u32 s60, s69, 12288
    buffer_load_dwordx4 v12, s[32:35], s60 offen sc1 lds
    v_mfma_f32_32x32x16_bf16 v[80:95], v[36:39], v[240:243], v[80:95]
    ds_read_b64_tr_b16 v[36:37], v9 offset:32768
    ds_read_b64_tr_b16 v[38:39], v9 offset:33792
    s_add_u32 m0, s68, 3072
    s_add_u32 s60, s69, 77824
    buffer_load_dwordx4 v12, s[32:35], s60 offen sc1 lds
    v_mfma_f32_32x32x16_bf16 v[96:111], v[40:43], v[240:243], v[96:111]
    ds_read_b64_tr_b16 v[40:41], v10 offset:32768
    ds_read_b64_tr_b16 v[42:43], v10 offset:33792
    s_add_u32 m0, s68, 11264
    s_add_u32 s60, s69, 13312
    buffer_load_dwordx4 v12, s[32:35], s60 offen sc1 lds
    v_mfma_f32_32x32x16_bf16 v[112:127], v[44:47], v[240:243], v[112:127]
    ds_read_b64_tr_b16 v[44:45], v11 offset:32768
    ds_read_b64_tr_b16 v[46:47], v11 offset:33792
    s_add_u32 m0, s98, 64
    s_add_u32 s60, s14, 16384
    s_mov_b64 exec, 0xff
    buffer_load_dword v22, s[40:43], s60 offen lds
    s_mov_b64 exec, -1
    v_mfma_f32_32x32x16_bf16 v[64:79], v[48:51], v[244:247], v[64:79]
    ds_read_b64_tr_b16 v[48:49], v8 offset:36864
    ds_read_b64_tr_b16 v[50:51], v8 offset:37888
    s_add_u32 m0, s98, 96
    s_add_u32 s60, s14, 24576
    s_mov_b64 exec, 0xff
    buffer_load_dword v22, s[40:43], s60 offen lds
    s_mov_b64 exec, -1
    v_mfma_f32_32x32x16_bf16 v[80:95], v[52:55], v[244:247], v[80:95]
    ds_read_b64_tr_b16 v[52:53], v9 offset:36864
    ds_read_b64_tr_b16 v[54:55], v9 offset:37888
    ds_read_b32 v13, v30
    s_add_u32 m0, s99, 86016
    s_add_u32 s60, s54, 0
    buffer_load_dwordx4 v21, s[36:39], s60 offen lds
    s_waitcnt lgkmcnt(14)
    v_mfma_f32_32x32x16_bf16 v[96:111], v[56:59], v[244:247], v[96:111]
    ds_read_b64_tr_b16 v[56:57], v10 offset:36864
    ds_read_b64_tr_b16 v[58:59], v10 offset:37888
    s_add_u32 m0, s99, 90112
    s_add_u32 s60, s54, 57344
    buffer_load_dwordx4 v21, s[36:39], s60 offen lds
    v_mfma_f32_32x32x16_bf16 v[112:127], v[60:63], v[244:247], v[112:127]
    ds_read_b64_tr_b16 v[60:61], v11 offset:36864
    ds_read_b64_tr_b16 v[62:63], v11 offset:37888
    s_waitcnt lgkmcnt(13)
    v_mfma_f32_32x32x16_bf16 v[64:79], v[32:35], v[248:251], v[64:79]
    s_setprio 2
    s_waitcnt lgkmcnt(4)
    v_cmp_le_u32 vcc, 68, v13
    s_cbranch_vccz L_gs_32
L_gs_32_r:
    s_setprio 0
    s_waitcnt vmcnt(26)
    ds_add_u32 v28, v29
    ds_read_b64_tr_b16 v[32:33], v8 offset:40960
    ds_read_b64_tr_b16 v[34:35], v8 offset:41984
    s_add_u32 m0, s98, 128
    s_add_u32 s60, s14, 32768
    s_mov_b64 exec, 0xff
    buffer_load_dword v22, s[40:43], s60 offen lds
    s_mov_b64 exec, -1
    v_mfma_f32_32x32x16_bf16 v[80:95], v[36:39], v[248:251], v[80:95]
    ds_read_b64_tr_b16 v[36:37], v9 offset:40960
    ds_read_b64_tr_b16 v[38:39], v9 offset:41984
    s_add_u32 m0, s99, 94208
    s_add_u32 s60, s54, 114688
    buffer_load_dwordx4 v21, s[36:39], s60 offen lds
    v_mfma_f32_32x32x16_bf16 v[96:111], v[40:43], v[248:251], v[96:111]
    ds_read_b64_tr_b16 v[40:41], v10 offset:40960
    ds_read_b64_tr_b16 v[42:43], v10 offset:41984
    s_add_u32 m0, s99, 98304
    s_add_u32 s60, s54, 172032
    buffer_load_dwordx4 v21, s[36:39], s60 offen lds
    v_mfma_f32_32x32x16_bf16 v[112:127], v[44:47], v[248:251], v[112:127]
    ds_read_b64_tr_b16 v[44:45], v11 offset:40960
    ds_read_b64_tr_b16 v[46:47], v11 offset:41984
    v_mfma_f32_32x32x16_bf16 v[64:79], v[48:51], v[252:255], v[64:79]
    ds_read_b64_tr_b16 v[48:49], v8 offset:45056
    ds_read_b64_tr_b16 v[50:51], v8 offset:46080
    v_mfma_f32_32x32x16_bf16 v[80:95], v[52:55], v[252:255], v[80:95]
    ds_read_b64_tr_b16 v[52:53], v9 offset:45056
    ds_read_b64_tr_b16 v[54:55], v9 offset:46080
    ds_read_b32 v13, v30
    s_waitcnt lgkmcnt(14)
    v_mfma_f32_32x32x16_bf16 v[96:111], v[56:59], v[252:255], v[96:111]
    ds_read_b64_tr_b16 v[56:57], v10 offset:45056
    ds_read_b64_tr_b16 v[58:59], v10 offset:46080
    v_mfma_f32_32x32x16_bf16 v[112:127], v[60:63], v[252:255], v[112:127]
    ds_read_b64_tr_b16 v[60:61], v11 offset:45056
    ds_read_b64_tr_b16 v[62:63], v11 offset:46080
    s_setprio 2
    s_nop 7
    v_pk_mul_f32 v[2:3], v[64:65], v[26:27] op_sel_hi:[1,0]
    v_pk_mul_f32 v[4:5], v[66:67], v[26:27] op_sel_hi:[1,0]
    v_pk_mul_f32 v[6:7], v[68:69], v[26:27] op_sel_hi:[1,0]
    v_pk_mul_f32 v[14:15], v[70:71], v[26:27] op_sel_hi:[1,0]
    v_exp_f32 v2, v2
    v_exp_f32 v3, v3
    v_exp_f32 v4, v4
    v_exp_f32 v5, v5
    v_exp_f32 v6, v6
    v_exp_f32 v7, v7
    v_exp_f32 v14, v14
    v_exp_f32 v15, v15
    v_pk_mul_f32 v[64:65], v[64:65], v[72:73]
    v_pk_mul_f32 v[66:67], v[66:67], v[74:75]
    v_pk_mul_f32 v[68:69], v[68:69], v[76:77]
    v_pk_mul_f32 v[70:71], v[70:71], v[78:79]
    v_pk_fma_f32 v[2:3], v[2:3], v[26:27], v[26:27] op_sel:[0,1,1] op_sel_hi:[1,1,1]
    v_pk_fma_f32 v[4:5], v[4:5], v[26:27], v[26:27] op_sel:[0,1,1] op_sel_hi:[1,1,1]
    v_pk_fma_f32 v[6:7], v[6:7], v[26:27], v[26:27] op_sel:[0,1,1] op_sel_hi:[1,1,1]
    v_pk_fma_f32 v[14:15], v[14:15], v[26:27], v[26:27] op_sel:[0,1,1] op_sel_hi:[1,1,1]
    v_rcp_f32 v2, v2
    v_rcp_f32 v3, v3
    v_rcp_f32 v4, v4
    v_rcp_f32 v5, v5
    v_rcp_f32 v6, v6
    v_rcp_f32 v7, v7
    v_rcp_f32 v14, v14
    v_rcp_f32 v15, v15
    s_nop 0
    v_pk_mul_f32 v[64:65], v[64:65], v[2:3]
    v_pk_mul_f32 v[66:67], v[66:67], v[4:5]
    v_pk_mul_f32 v[68:69], v[68:69], v[6:7]
    v_pk_mul_f32 v[70:71], v[70:71], v[14:15]
    v_cvt_pk_bf16_f32 v72, v64, v65
    v_cvt_pk_bf16_f32 v73, v66, v67
    v_cvt_pk_bf16_f32 v74, v68, v69
    v_cvt_pk_bf16_f32 v75, v70, v71
    buffer_store_dwordx4 v[72:75], v12, s[32:35], s76 offen offset:0 sc1
    v_pk_mul_f32 v[2:3], v[80:81], v[26:27] op_sel_hi:[1,0]
    v_pk_mul_f32 v[4:5], v[82:83], v[26:27] op_sel_hi:[1,0]
    v_pk_mul_f32 v[6:7], v[84:85], v[26:27] op_sel_hi:[1,0]
    v_pk_mul_f32 v[14:15], v[86:87], v[26:27] op_sel_hi:[1,0]
    v_exp_f32 v2, v2
    v_exp_f32 v3, v3
    v_exp_f32 v4, v4
    v_exp_f32 v5, v5
    v_exp_f32 v6, v6
    v_exp_f32 v7, v7
    v_exp_f32 v14, v14
    v_exp_f32 v15, v15
    v_pk_mul_f32 v[80:81], v[80:81], v[88:89]
    v_pk_mul_f32 v[82:83], v[82:83], v[90:91]
    v_pk_mul_f32 v[84:85], v[84:85], v[92:93]
    v_pk_mul_f32 v[86:87], v[86:87], v[94:95]
    v_pk_fma_f32 v[2:3], v[2:3], v[26:27], v[26:27] op_sel:[0,1,1] op_sel_hi:[1,1,1]
    v_pk_fma_f32 v[4:5], v[4:5], v[26:27], v[26:27] op_sel:[0,1,1] op_sel_hi:[1,1,1]
    v_pk_fma_f32 v[6:7], v[6:7], v[26:27], v[26:27] op_sel:[0,1,1] op_sel_hi:[1,1,1]
    v_pk_fma_f32 v[14:15], v[14:15], v[26:27], v[26:27] op_sel:[0,1,1] op_sel_hi:[1,1,1]
    v_rcp_f32 v2, v2
    v_rcp_f32 v3, v3
    v_rcp_f32 v4, v4
    v_rcp_f32 v5, v5
    v_rcp_f32 v6, v6
    v_rcp_f32 v7, v7
    v_rcp_f32 v14, v14
    v_rcp_f32 v15, v15
    s_nop 0
    v_pk_mul_f32 v[80:81], v[80:81], v[2:3]
    v_pk_mul_f32 v[82:83], v[82:83], v[4:5]
    v_pk_mul_f32 v[84:85], v[84:85], v[6:7]
    v_pk_mul_f32 v[86:87], v[86:87], v[14:15]
    v_cvt_pk_bf16_f32 v88, v80, v81
    v_cvt_pk_bf16_f32 v89, v82, v83
    v_cvt_pk_bf16_f32 v90, v84, v85
    v_cvt_pk_bf16_f32 v91, v86, v87
    buffer_store_dwordx4 v[88:91], v12, s[32:35], s76 offen offset:1024 sc1
    v_pk_mul_f32 v[2:3], v[96:97], v[26:27] op_sel_hi:[1,0]
    v_pk_mul_f32 v[4:5], v[98:99], v[26:27] op_sel_hi:[1,0]
    v_pk_mul_f32 v[6:7], v[100:101], v[26:27] op_sel_hi:[1,0]
    v_pk_mul_f32 v[14:15], v[102:103], v[26:27] op_sel_hi:[1,0]
    v_exp_f32 v2, v2
    v_exp_f32 v3, v3
    v_exp_f32 v4, v4
    v_exp_f32 v5, v5
    v_exp_f32 v6, v6
    v_exp_f32 v7, v7
    v_exp_f32 v14, v14
    v_exp_f32 v15, v15
    v_pk_mul_f32 v[96:97], v[96:97], v[104:105]
    v_pk_mul_f32 v[98:99], v[98:99], v[106:107]
    v_pk_mul_f32 v[100:101], v[100:101], v[108:109]
    v_pk_mul_f32 v[102:103], v[102:103], v[110:111]
    v_pk_fma_f32 v[2:3], v[2:3], v[26:27], v[26:27] op_sel:[0,1,1] op_sel_hi:[1,1,1]
    v_pk_fma_f32 v[4:5], v[4:5], v[26:27], v[26:27] op_sel:[0,1,1] op_sel_hi:[1,1,1]
    v_pk_fma_f32 v[6:7], v[6:7], v[26:27], v[26:27] op_sel:[0,1,1] op_sel_hi:[1,1,1]
    v_pk_fma_f32 v[14:15], v[14:15], v[26:27], v[26:27] op_sel:[0,1,1] op_sel_hi:[1,1,1]
    v_rcp_f32 v2, v2
    v_rcp_f32 v3, v3
    v_rcp_f32 v4, v4
    v_rcp_f32 v5, v5
    v_rcp_f32 v6, v6
    v_rcp_f32 v7, v7
    v_rcp_f32 v14, v14
    v_rcp_f32 v15, v15
    s_nop 0
    v_pk_mul_f32 v[96:97], v[96:97], v[2:3]
    v_pk_mul_f32 v[98:99], v[98:99], v[4:5]
    v_pk_mul_f32 v[100:101], v[100:101], v[6:7]
    v_pk_mul_f32 v[102:103], v[102:103], v[14:15]
    v_cvt_pk_bf16_f32 v104, v96, v97
    v_cvt_pk_bf16_f32 v105, v98, v99
    v_cvt_pk_bf16_f32 v106, v100, v101
    v_cvt_pk_bf16_f32 v107, v102, v103
    buffer_store_dwordx4 v[104:107], v12, s[32:35], s76 offen offset:2048 sc1
    v_pk_mul_f32 v[2:3], v[112:113], v[26:27] op_sel_hi:[1,0]
    v_pk_mul_f32 v[4:5], v[114:115], v[26:27] op_sel_hi:[1,0]
    v_pk_mul_f32 v[6:7], v[116:117], v[26:27] op_sel_hi:[1,0]
    v_pk_mul_f32 v[14:15], v[118:119], v[26:27] op_sel_hi:[1,0]
    v_exp_f32 v2, v2
    v_exp_f32 v3, v3
    v_exp_f32 v4, v4
    v_exp_f32 v5, v5
    v_exp_f32 v6, v6
    v_exp_f32 v7, v7
    v_exp_f32 v14, v14
    v_exp_f32 v15, v15
    v_pk_mul_f32 v[112:113], v[112:113], v[120:121]
    v_pk_mul_f32 v[114:115], v[114:115], v[122:123]
    v_pk_mul_f32 v[116:117], v[116:117], v[124:125]
    v_pk_mul_f32 v[118:119], v[118:119], v[126:127]
    v_pk_fma_f32 v[2:3], v[2:3], v[26:27], v[26:27] op_sel:[0,1,1] op_sel_hi:[1,1,1]
    v_pk_fma_f32 v[4:5], v[4:5], v[26:27], v[26:27] op_sel:[0,1,1] op_sel_hi:[1,1,1]
    v_pk_fma_f32 v[6:7], v[6:7], v[26:27], v[26:27] op_sel:[0,1,1] op_sel_hi:[1,1,1]
    v_pk_fma_f32 v[14:15], v[14:15], v[26:27], v[26:27] op_sel:[0,1,1] op_sel_hi:[1,1,1]
    v_rcp_f32 v2, v2
    v_rcp_f32 v3, v3
    v_rcp_f32 v4, v4
    v_rcp_f32 v5, v5
    v_rcp_f32 v6, v6
    v_rcp_f32 v7, v7
    v_rcp_f32 v14, v14
    v_rcp_f32 v15, v15
    s_nop 0
    v_pk_mul_f32 v[112:113], v[112:113], v[2:3]
    v_pk_mul_f32 v[114:115], v[114:115], v[4:5]
    v_pk_mul_f32 v[116:117], v[116:117], v[6:7]
    v_pk_mul_f32 v[118:119], v[118:119], v[14:15]
    v_cvt_pk_bf16_f32 v120, v112, v113
    v_cvt_pk_bf16_f32 v121, v114, v115
    v_cvt_pk_bf16_f32 v122, v116, v117
    v_cvt_pk_bf16_f32 v123, v118, v119
    buffer_store_dwordx4 v[120:123], v12, s[32:35], s76 offen offset:3072 sc1
    s_setprio 0
    s_waitcnt lgkmcnt(13)
    v_mfma_f32_32x32x16_bf16 v[64:79], v[32:35], v[128:131], 0
    s_setprio 2
    s_waitcnt lgkmcnt(4)
    v_cmp_le_u32 vcc, 72, v13
    s_cbranch_vccz L_gs_33
L_gs_33_r:
    s_setprio 0
    s_waitcnt vmcnt(31)
    ds_add_u32 v28, v29
    ds_read_b64_tr_b16 v[32:33], v8 offset:49152
    ds_read_b64_tr_b16 v[34:35], v8 offset:50176
    s_add_u32 m0, s98, 160
    s_add_u32 s60, s14, 40960
    s_mov_b64 exec, 0xff
    buffer_load_dword v22, s[40:43], s60 offen lds
    s_mov_b64 exec, -1
    v_mfma_f32_32x32x16_bf16 v[80:95], v[36:39], v[128:131], 0
    ds_read_b64_tr_b16 v[36:37], v9 offset:49152
    ds_read_b64_tr_b16 v[38:39], v9 offset:50176
    s_add_u32 m0, s99, 102400
    s_add_u32 s60, s54, 229376
    buffer_load_dwordx4 v21, s[36:39], s60 offen lds
    v_mfma_f32_32x32x16_bf16 v[96:111], v[40:43], v[128:131], 0
    ds_read_b64_tr_b16 v[40:41], v10 offset:49152
    ds_read_b64_tr_b16 v[42:43], v10 offset:50176
    s_add_u32 m0, s99, 106496
    s_add_u32 s60, s54, 286720
    buffer_load_dwordx4 v21, s[36:39], s60 offen lds
    v_mfma_f32_32x32x16_bf16 v[112:127], v[44:47], v[128:131], 0
    ds_read_b64_tr_b16 v[44:45], v11 offset:49152
    ds_read_b64_tr_b16 v[46:47], v11 offset:50176
    v_mfma_f32_32x32x16_bf16 v[64:79], v[48:51], v[132:135], v[64:79]
    ds_read_b64_tr_b16 v[48:49], v8 offset:53248
    ds_read_b64_tr_b16 v[50:51], v8 offset:54272
    v_mfma_f32_32x32x16_bf16 v[80:95], v[52:55], v[132:135], v[80:95]
    ds_read_b64_tr_b16 v[52:53], v9 offset:53248
    ds_read_b64_tr_b16 v[54:55], v9 offset:54272
    ds_read_b32 v13, v30
    s_waitcnt lgkmcnt(14)
    v_mfma_f32_32x32x16_bf16 v[96:111], v[56:59], v[132:135], v[96:111]
    ds_read_b64_tr_b16 v[56:57], v10 offset:53248
    ds_read_b64_tr_b16 v[58:59], v10 offset:54272
    v_mfma_f32_32x32x16_bf16 v[112:127], v[60:63], v[132:135], v[112:127]
    ds_read_b64_tr_b16 v[60:61], v11 offset:53248
    ds_read_b64_tr_b16 v[62:63], v11 offset:54272
    s_waitcnt lgkmcnt(13)
    v_mfma_f32_32x32x16_bf16 v[64:79], v[32:35], v[136:139], v[64:79]
    s_setprio 2
    s_waitcnt lgkmcnt(4)
    v_cmp_le_u32 vcc, 76, v13
    s_cbranch_vccz L_gs_34
L_gs_34_r:
    s_setprio 0
    s_waitcnt vmcnt(32)
    ds_add_u32 v28, v29
    s_waitcnt vmcnt(14)
    s_mov_b64 exec, 1
    ds_add_u32 v1, v29 offset:32
    s_mov_b64 exec, -1
    ds_read_b64_tr_b16 v[32:33], v8 offset:57344
    ds_read_b64_tr_b16 v[34:35], v8 offset:58368
    s_add_u32 m0, s98, 192
    s_add_u32 s60, s14, 49152
    s_mov_b64 exec, 0xff
    buffer_load_dword v22, s[40:43], s60 offen lds
    s_mov_b64 exec, -1
    v_mfma_f32_32x32x16_bf16 v[80:95], v[36:39], v[136:139], v[80:95]
    ds_read_b64_tr_b16 v[36:37], v9 offset:57344
    ds_read_b64_tr_b16 v[38:39], v9 offset:58368
    s_add_u32 m0, s99, 110592
    s_add_u32 s60, s54, 344064
    buffer_load_dwordx4 v21, s[36:39], s60 offen lds
    v_mfma_f32_32x32x16_bf16 v[96:111], v[40:43], v[136:139], v[96:111]
    ds_read_b64_tr_b16 v[40:41], v10 offset:57344
    ds_read_b64_tr_b16 v[42:43], v10 offset:58368
    s_add_u32 m0, s99, 114688
    s_add_u32 s60, s54, 401408
    buffer_load_dwordx4 v21, s[36:39], s60 offen lds
    v_mfma_f32_32x32x16_bf16 v[112:127], v[44:47], v[136:139], v[112:127]
    ds_read_b64_tr_b16 v[44:45], v11 offset:57344
    ds_read_b64_tr_b16 v[46:47], v11 offset:58368
    v_mfma_f32_32x32x16_bf16 v[64:79], v[48:51], v[140:143], v[64:79]
    ds_read_b64_tr_b16 v[48:49], v8 offset:61440
    ds_read_b64_tr_b16 v[50:51], v8 offset:62464
    v_mfma_f32_32x32x16_bf16 v[80:95], v[52:55], v[140:143], v[80:95]
    ds_read_b64_tr_b16 v[52:53], v9 offset:61440
    ds_read_b64_tr_b16 v[54:55], v9 offset:62464
    ds_read_b32 v13, v30
    s_waitcnt lgkmcnt(15)
    v_mfma_f32_32x32x16_bf16 v[96:111], v[56:59], v[140:143], v[96:111]
    ds_read_b64_tr_b16 v[56:57], v10 offset:61440
    ds_read_b64_tr_b16 v[58:59], v10 offset:62464
    v_mfma_f32_32x32x16_bf16 v[112:127], v[60:63], v[140:143], v[112:127]
    ds_read_b64_tr_b16 v[60:61], v11 offset:61440
    ds_read_b64_tr_b16 v[62:63], v11 offset:62464
    s_waitcnt lgkmcnt(13)
    v_mfma_f32_32x32x16_bf16 v[64:79], v[32:35], v[144:147], v[64:79]
    s_setprio 2
    s_waitcnt lgkmcnt(4)
    v_cmp_le_u32 vcc, 80, v13
    s_cbranch_vccz L_gs_35
L_gs_35_r:
    s_setprio 0
    ds_add_u32 v28, v29
    s_waitcnt vmcnt(6)
    s_setprio 2
    s_lshl_b32 s60, s80, 2
    s_add_u32 s60, s60, s57
    s_lshl_b32 s60, s60, 3
    v_mov_b32 v2, s60
    v_mov_b32 v4, s72
    v_mov_b32 v5, s73
    s_mov_b32 s87, 159744
    s_mov_b64 exec, 1
    buffer_store_dwordx2 v[4:5], v2, s[32:35], s87 offen sc1
    s_mov_b64 exec, -1
    s_setprio 0
    ds_read_b64_tr_b16 v[32:33], v16 offset:0
    ds_read_b64_tr_b16 v[34:35], v16 offset:1024
    s_add_u32 m0, s98, 224
    s_add_u32 s60, s14, 57344
    s_mov_b64 exec, 0xff
    buffer_load_dword v22, s[40:43], s60 offen lds
    s_mov_b64 exec, -1
    v_mfma_f32_32x32x16_bf16 v[80:95], v[36:39], v[144:147], v[80:95]
    ds_read_b64_tr_b16 v[36:37], v17 offset:0
    ds_read_b64_tr_b16 v[38:39], v17 offset:1024
    s_add_u32 m0, s99, 118784
    s_add_u32 s60, s55, 0
    buffer_load_dwordx4 v21, s[36:39], s60 offen lds
    v_mfma_f32_32x32x16_bf16 v[96:111], v[40:43], v[144:147], v[96:111]
    ds_read_b64_tr_b16 v[40:41], v18 offset:0
    ds_read_b64_tr_b16 v[42:43], v18 offset:1024
    s_add_u32 m0, s99, 122880
    s_add_u32 s60, s55, 57344
    buffer_load_dwordx4 v21, s[36:39], s60 offen lds
    v_mfma_f32_32x32x16_bf16 v[112:127], v[44:47], v[144:147], v[112:127]
    ds_read_b64_tr_b16 v[44:45], v19 offset:0
    ds_read_b64_tr_b16 v[46:47], v19 offset:1024
    v_mfma_f32_32x32x16_bf16 v[64:79], v[48:51], v[148:151], v[64:79]
    ds_read_b64_tr_b16 v[48:49], v16 offset:4096
    ds_read_b64_tr_b16 v[50:51], v16 offset:5120
    v_mfma_f32_32x32x16_bf16 v[80:95], v[52:55], v[148:151], v[80:95]
    ds_read_b64_tr_b16 v[52:53], v17 offset:4096
    ds_read_b64_tr_b16 v[54:55], v17 offset:5120
    ds_read_b32 v13, v30
    s_waitcnt lgkmcnt(14)
    v_mfma_f32_32x32x16_bf16 v[96:111], v[56:59], v[148:151], v[96:111]
    ds_read_b64_tr_b16 v[56:57], v18 offset:4096
    ds_read_b64_tr_b16 v[58:59], v18 offset:5120
    v_mfma_f32_32x32x16_bf16 v[112:127], v[60:63], v[148:151], v[112:127]
    ds_read_b64_tr_b16 v[60:61], v19 offset:4096
    ds_read_b64_tr_b16 v[62:63], v19 offset:5120
    s_waitcnt lgkmcnt(13)
    v_mfma_f32_32x32x16_bf16 v[64:79], v[32:35], v[152:155], v[64:79]
    s_setprio 2
    s_waitcnt lgkmcnt(4)
    v_cmp_le_u32 vcc, 84, v13
    s_cbranch_vccz L_gs_36
L_gs_36_r:
    s_setprio 0
    ds_add_u32 v28, v29
    ds_read_b64_tr_b16 v[32:33], v16 offset:8192
    ds_read_b64_tr_b16 v[34:35], v16 offset:9216
    s_add_u32 m0, s98, 256
    s_add_u32 s60, s15, 0
    s_mov_b64 exec, 0xff
    buffer_load_dword v22, s[40:43], s60 offen lds
    s_mov_b64 exec, -1
    v_mfma_f32_32x32x16_bf16 v[80:95], v[36:39], v[152:155], v[80:95]
    ds_read_b64_tr_b16 v[36:37], v17 offset:8192
    ds_read_b64_tr_b16 v[38:39], v17 offset:9216
    s_add_u32 m0, s99, 126976
    s_add_u32 s60, s55, 114688
    buffer_load_dwordx4 v21, s[36:39], s60 offen lds
    v_mfma_f32_32x32x16_bf16 v[96:111], v[40:43], v[152:155], v[96:111]
    ds_read_b64_tr_b16 v[40:41], v18 offset:8192
    ds_read_b64_tr_b16 v[42:43], v18 offset:9216
    s_add_u32 m0, s99, 131072
    s_add_u32 s60, s55, 172032
    buffer_load_dwordx4 v21, s[36:39], s60 offen lds
    v_mfma_f32_32x32x16_bf16 v[112:127], v[44:47], v[152:155], v[112:127]
    ds_read_b64_tr_b16 v[44:45], v19 offset:8192
    ds_read_b64_tr_b16 v[46:47], v19 offset:9216
    v_mfma_f32_32x32x16_bf16 v[64:79], v[48:51], v[156:159], v[64:79]
    ds_read_b64_tr_b16 v[48:49], v16 offset:12288
    ds_read_b64_tr_b16 v[50:51], v16 offset:13312
    v_mfma_f32_32x32x16_bf16 v[80:95], v[52:55], v[156:159], v[80:95]
    ds_read_b64_tr_b16 v[52:53], v17 offset:12288
    ds_read_b64_tr_b16 v[54:55], v17 offset:13312
    ds_read_b32 v13, v30
    s_waitcnt lgkmcnt(14)
    v_mfma_f32_32x32x16_bf16 v[96:111], v[56:59], v[156:159], v[96:111]
    ds_read_b64_tr_b16 v[56:57], v18 offset:12288
    ds_read_b64_tr_b16 v[58:59], v18 offset:13312
    v_mfma_f32_32x32x16_bf16 v[112:127], v[60:63], v[156:159], v[112:127]
    ds_read_b64_tr_b16 v[60:61], v19 offset:12288
    ds_read_b64_tr_b16 v[62:63], v19 offset:13312
    s_waitcnt lgkmcnt(13)
    v_mfma_f32_32x32x16_bf16 v[64:79], v[32:35], v[160:163], v[64:79]
    s_setprio 2
    s_waitcnt lgkmcnt(4)
    v_cmp_le_u32 vcc, 88, v13
    s_cbranch_vccz L_gs_37
L_gs_37_r:
    s_setprio 0
    ds_add_u32 v28, v29
    ds_read_b64_tr_b16 v[32:33], v16 offset:16384
    ds_read_b64_tr_b16 v[34:35], v16 offset:17408
    s_add_u32 m0, s98, 288
    s_add_u32 s60, s15, 8192
    s_mov_b64 exec, 0xff
    buffer_load_dword v22, s[40:43], s60 offen lds
    s_mov_b64 exec, -1
    v_mfma_f32_32x32x16_bf16 v[80:95], v[36:39], v[160:163], v[80:95]
    ds_read_b64_tr_b16 v[36:37], v17 offset:16384
    ds_read_b64_tr_b16 v[38:39], v17 offset:17408
    s_add_u32 m0, s99, 135168
    s_add_u32 s60, s55, 229376
    buffer_load_dwordx4 v21, s[36:39], s60 offen lds
    v_mfma_f32_32x32x16_bf16 v[96:111], v[40:43], v[160:163], v[96:111]
    ds_read_b64_tr_b16 v[40:41], v18 offset:16384
    ds_read_b64_tr_b16 v[42:43], v18 offset:17408
    s_add_u32 m0, s99, 139264
    s_add_u32 s60, s55, 286720
    buffer_load_dwordx4 v21, s[36:39], s60 offen lds
    v_mfma_f32_32x32x16_bf16 v[112:127], v[44:47], v[160:163], v[112:127]
    ds_read_b64_tr_b16 v[44:45], v19 offset:16384
    ds_read_b64_tr_b16 v[46:47], v19 offset:17408
    v_mfma_f32_32x32x16_bf16 v[64:79], v[48:51], v[164:167], v[64:79]
    ds_read_b64_tr_b16 v[48:49], v16 offset:20480
    ds_read_b64_tr_b16 v[50:51], v16 offset:21504
    v_mfma_f32_32x32x16_bf16 v[80:95], v[52:55], v[164:167], v[80:95]
    ds_read_b64_tr_b16 v[52:53], v17 offset:20480
    ds_read_b64_tr_b16 v[54:55], v17 offset:21504
    ds_read_b32 v13, v30
    s_waitcnt lgkmcnt(14)
    v_mfma_f32_32x32x16_bf16 v[96:111], v[56:59], v[164:167], v[96:111]
    ds_read_b64_tr_b16 v[56:57], v18 offset:20480
    ds_read_b64_tr_b16 v[58:59], v18 offset:21504
    v_mfma_f32_32x32x16_bf16 v[112:127], v[60:63], v[164:167], v[112:127]
    ds_read_b64_tr_b16 v[60:61], v19 offset:20480
    ds_read_b64_tr_b16 v[62:63], v19 offset:21504
    s_waitcnt lgkmcnt(13)
    v_mfma_f32_32x32x16_bf16 v[64:79], v[32:35], v[168:171], v[64:79]
    s_setprio 2
    s_waitcnt lgkmcnt(4)
    v_cmp_le_u32 vcc, 92, v13
    s_cbranch_vccz L_gs_38
L_gs_38_r:
    s_setprio 0
    ds_add_u32 v28, v29
    ds_read_b64_tr_b16 v[32:33], v8 offset:0
    ds_read_b64_tr_b16 v[34:35], v8 offset:1024
    s_add_u32 m0, s98, 320
    s_add_u32 s60, s15, 16384
    s_mov_b64 exec, 0xff
    buffer_load_dword v22, s[40:43], s60 offen lds
    s_mov_b64 exec, -1
    v_mfma_f32_32x32x16_bf16 v[80:95], v[36:39], v[168:171], v[80:95]
    ds_read_b64_tr_b16 v[36:37], v9 offset:0
    ds_read_b64_tr_b16 v[38:39], v9 offset:1024
    s_add_u32 m0, s99, 143360
    s_add_u32 s60, s55, 344064
    buffer_load_dwordx4 v21, s[36:39], s60 offen lds
    v_mfma_f32_32x32x16_bf16 v[96:111], v[40:43], v[168:171], v[96:111]
    ds_read_b64_tr_b16 v[40:41], v10 offset:0
    ds_read_b64_tr_b16 v[42:43], v10 offset:1024
    s_add_u32 m0, s99, 147456
    s_add_u32 s60, s55, 401408
    buffer_load_dwordx4 v21, s[36:39], s60 offen lds
    v_mfma_f32_32x32x16_bf16 v[112:127], v[44:47], v[168:171], v[112:127]
    ds_read_b64_tr_b16 v[44:45], v11 offset:0
    ds_read_b64_tr_b16 v[46:47], v11 offset:1024
    v_mfma_f32_32x32x16_bf16 v[64:79], v[48:51], v[172:175], v[64:79]
    ds_read_b64_tr_b16 v[48:49], v8 offset:4096
    ds_read_b64_tr_b16 v[50:51], v8 offset:5120
    v_mfma_f32_32x32x16_bf16 v[80:95], v[52:55], v[172:175], v[80:95]
    ds_read_b64_tr_b16 v[52:53], v9 offset:4096
    ds_read_b64_tr_b16 v[54:55], v9 offset:5120
    ds_read_b32 v13, v30
    s_waitcnt lgkmcnt(14)
    v_mfma_f32_32x32x16_bf16 v[96:111], v[56:59], v[172:175], v[96:111]
    ds_read_b64_tr_b16 v[56:57], v10 offset:4096
    ds_read_b64_tr_b16 v[58:59], v10 offset:5120
    v_mfma_f32_32x32x16_bf16 v[112:127], v[60:63], v[172:175], v[112:127]
    ds_read_b64_tr_b16 v[60:61], v11 offset:4096
    ds_read_b64_tr_b16 v[62:63], v11 offset:5120
    s_waitcnt lgkmcnt(13)
    v_mfma_f32_32x32x16_bf16 v[64:79], v[32:35], v[176:179], v[64:79]
    s_setprio 2
    s_waitcnt lgkmcnt(4)
    v_cmp_le_u32 vcc, 96, v13
    s_cbranch_vccz L_gs_39
L_gs_39_r:
    s_setprio 0
    ds_add_u32 v28, v29
    ds_read_b64_tr_b16 v[32:33], v8 offset:8192
    ds_read_b64_tr_b16 v[34:35], v8 offset:9216
    s_add_u32 m0, s98, 352
    s_add_u32 s60, s15, 24576
    s_mov_b64 exec, 0xff
    buffer_load_dword v22, s[40:43], s60 offen lds
    s_mov_b64 exec, -1
    v_mfma_f32_32x32x16_bf16 v[80:95], v[36:39], v[176:179], v[80:95]
    ds_read_b64_tr_b16 v[36:37], v9 offset:8192
    ds_read_b64_tr_b16 v[38:39], v9 offset:9216
    v_mfma_f32_32x32x16_bf16 v[96:111], v[40:43], v[176:179], v[96:111]
    ds_read_b64_tr_b16 v[40:41], v10 offset:8192
    ds_read_b64_tr_b16 v[42:43], v10 offset:9216
    v_mfma_f32_32x32x16_bf16 v[112:127], v[44:47], v[176:179], v[112:127]
    ds_read_b64_tr_b16 v[44:45], v11 offset:8192
    ds_read_b64_tr_b16 v[46:47], v11 offset:9216
    v_mfma_f32_32x32x16_bf16 v[64:79], v[48:51], v[180:183], v[64:79]
    ds_read_b64_tr_b16 v[48:49], v8 offset:12288
    ds_read_b64_tr_b16 v[50:51], v8 offset:13312
    v_mfma_f32_32x32x16_bf16 v[80:95], v[52:55], v[180:183], v[80:95]
    ds_read_b64_tr_b16 v[52:53], v9 offset:12288
    ds_read_b64_tr_b16 v[54:55], v9 offset:13312
    ds_read_b32 v13, v30
    s_waitcnt lgkmcnt(14)
    v_mfma_f32_32x32x16_bf16 v[96:111], v[56:59], v[180:183], v[96:111]
    ds_read_b64_tr_b16 v[56:57], v10 offset:12288
    ds_read_b64_tr_b16 v[58:59], v10 offset:13312
    v_mfma_f32_32x32x16_bf16 v[112:127], v[60:63], v[180:183], v[112:127]
    ds_read_b64_tr_b16 v[60:61], v11 offset:12288
    ds_read_b64_tr_b16 v[62:63], v11 offset:13312
    s_waitcnt lgkmcnt(13)
    v_mfma_f32_32x32x16_bf16 v[64:79], v[32:35], v[184:187], v[64:79]
    s_setprio 2
    s_waitcnt lgkmcnt(4)
    v_cmp_le_u32 vcc, 100, v13
    s_cbranch_vccz L_gs_40
L_gs_40_r:
    s_setprio 0
    ds_add_u32 v28, v29
    ds_read_b64_tr_b16 v[32:33], v8 offset:16384
    ds_read_b64_tr_b16 v[34:35], v8 offset:17408
    s_add_u32 m0, s98, 384
    s_add_u32 s60, s15, 32768
    s_mov_b64 exec, 0xff
    buffer_load_dword v22, s[40:43], s60 offen lds
    s_mov_b64 exec, -1
    v_mfma_f32_32x32x16_bf16 v[80:95], v[36:39], v[184:187], v[80:95]
    ds_read_b64_tr_b16 v[36:37], v9 offset:16384
    ds_read_b64_tr_b16 v[38:39], v9 offset:17408
    v_mfma_f32_32x32x16_bf16 v[96:111], v[40:43], v[184:187], v[96:111]
    ds_read_b64_tr_b16 v[40:41], v10 offset:16384
    ds_read_b64_tr_b16 v[42:43], v10 offset:17408
    v_mfma_f32_32x32x16_bf16 v[112:127], v[44:47], v[184:187], v[112:127]
    ds_read_b64_tr_b16 v[44:45], v11 offset:16384
    ds_read_b64_tr_b16 v[46:47], v11 offset:17408
    v_mfma_f32_32x32x16_bf16 v[64:79], v[48:51], v[188:191], v[64:79]
    ds_read_b64_tr_b16 v[48:49], v8 offset:20480
    ds_read_b64_tr_b16 v[50:51], v8 offset:21504
    v_mfma_f32_32x32x16_bf16 v[80:95], v[52:55], v[188:191], v[80:95]
    ds_read_b64_tr_b16 v[52:53], v9 offset:20480
    ds_read_b64_tr_b16 v[54:55], v9 offset:21504
    ds_read_b32 v13, v30
    s_waitcnt lgkmcnt(14)
    v_mfma_f32_32x32x16_bf16 v[96:111], v[56:59], v[188:191], v[96:111]
    ds_read_b64_tr_b16 v[56:57], v10 offset:20480
    ds_read_b64_tr_b16 v[58:59], v10 offset:21504
    v_mfma_f32_32x32x16_bf16 v[112:127], v[60:63], v[188:191], v[112:127]
    ds_read_b64_tr_b16 v[60:61], v11 offset:20480
    ds_read_b64_tr_b16 v[62:63], v11 offset:21504
    s_waitcnt lgkmcnt(13)
    v_mfma_f32_32x32x16_bf16 v[64:79], v[32:35], v[192:195], v[64:79]
    s_setprio 2
    s_waitcnt lgkmcnt(4)
    v_cmp_le_u32 vcc, 104, v13
    s_cbranch_vccz L_gs_41
L_gs_41_r:
    s_setprio 0
    s_waitcnt vmcnt(18)
    ds_add_u32 v28, v29
    ds_read_b64_tr_b16 v[32:33], v8 offset:24576
    ds_read_b64_tr_b16 v[34:35], v8 offset:25600
    s_add_u32 m0, s98, 416
    s_add_u32 s60, s15, 40960
    s_mov_b64 exec, 0xff
    buffer_load_dword v22, s[40:43], s60 offen lds
    s_mov_b64 exec, -1
    v_mfma_f32_32x32x16_bf16 v[80:95], v[36:39], v[192:195], v[80:95]
    ds_read_b64_tr_b16 v[36:37], v9 offset:24576
    ds_read_b64_tr_b16 v[38:39], v9 offset:25600
    v_mfma_f32_32x32x16_bf16 v[96:111], v[40:43], v[192:195], v[96:111]
    ds_read_b64_tr_b16 v[40:41], v10 offset:24576
    ds_read_b64_tr_b16 v[42:43], v10 offset:25600
    v_mfma_f32_32x32x16_bf16 v[112:127], v[44:47], v[192:195], v[112:127]
    ds_read_b64_tr_b16 v[44:45], v11 offset:24576
    ds_read_b64_tr_b16 v[46:47], v11 offset:25600
    v_mfma_f32_32x32x16_bf16 v[64:79], v[48:51], v[196:199], v[64:79]
    ds_read_b64_tr_b16 v[48:49], v8 offset:28672
    ds_read_b64_tr_b16 v[50:51], v8 offset:29696
    v_mfma_f32_32x32x16_bf16 v[80:95], v[52:55], v[196:199], v[80:95]
    ds_read_b64_tr_b16 v[52:53], v9 offset:28672
    ds_read_b64_tr_b16 v[54:55], v9 offset:29696
    ds_read_b32 v13, v30
    s_waitcnt lgkmcnt(14)
    v_mfma_f32_32x32x16_bf16 v[96:111], v[56:59], v[196:199], v[96:111]
    ds_read_b64_tr_b16 v[56:57], v10 offset:28672
    ds_read_b64_tr_b16 v[58:59], v10 offset:29696
    v_mfma_f32_32x32x16_bf16 v[112:127], v[60:63], v[196:199], v[112:127]
    ds_read_b64_tr_b16 v[60:61], v11 offset:28672
    ds_read_b64_tr_b16 v[62:63], v11 offset:29696
    s_waitcnt lgkmcnt(13)
    v_mfma_f32_32x32x16_bf16 v[64:79], v[32:35], v[200:203], v[64:79]
    s_setprio 2
    s_waitcnt lgkmcnt(4)
    v_cmp_le_u32 vcc, 108, v13
    s_cbranch_vccz L_gs_42
L_gs_42_r:
    s_setprio 0
    s_waitcnt vmcnt(16)
    ds_add_u32 v28, v29
    ds_read_b64_tr_b16 v[32:33], v8 offset:32768
    ds_read_b64_tr_b16 v[34:35], v8 offset:33792
    s_add_u32 m0, s98, 448
    s_add_u32 s60, s15, 49152
    s_mov_b64 exec, 0xff
    buffer_load_dword v22, s[40:43], s60 offen lds
    s_mov_b64 exec, -1
    v_mfma_f32_32x32x16_bf16 v[80:95], v[36:39], v[200:203], v[80:95]
    ds_read_b64_tr_b16 v[36:37], v9 offset:32768
    ds_read_b64_tr_b16 v[38:39], v9 offset:33792
    v_mfma_f32_32x32x16_bf16 v[96:111], v[40:43], v[200:203], v[96:111]
    ds_read_b64_tr_b16 v[40:41], v10 offset:32768
    ds_read_b64_tr_b16 v[42:43], v10 offset:33792
    v_mfma_f32_32x32x16_bf16 v[112:127], v[44:47], v[200:203], v[112:127]
    ds_read_b64_tr_b16 v[44:45], v11 offset:32768
    ds_read_b64_tr_b16 v[46:47], v11 offset:33792
    v_mfma_f32_32x32x16_bf16 v[64:79], v[48:51], v[204:207], v[64:79]
    ds_read_b64_tr_b16 v[48:49], v8 offset:36864
    ds_read_b64_tr_b16 v[50:51], v8 offset:37888
    v_mfma_f32_32x32x16_bf16 v[80:95], v[52:55], v[204:207], v[80:95]
    ds_read_b64_tr_b16 v[52:53], v9 offset:36864
    ds_read_b64_tr_b16 v[54:55], v9 offset:37888
    ds_read_b32 v13, v30
    s_waitcnt lgkmcnt(14)
    v_mfma_f32_32x32x16_bf16 v[96:111], v[56:59], v[204:207], v[96:111]
    ds_read_b64_tr_b16 v[56:57], v10 offset:36864
    ds_read_b64_tr_b16 v[58:59], v10 offset:37888
    v_mfma_f32_32x32x16_bf16 v[112:127], v[60:63], v[204:207], v[112:127]
    ds_read_b64_tr_b16 v[60:61], v11 offset:36864
    ds_read_b64_tr_b16 v[62:63], v11 offset:37888
    s_waitcnt lgkmcnt(13)
    v_mfma_f32_32x32x16_bf16 v[64:79], v[32:35], v[208:211], v[64:79]
    s_setprio 2
    s_waitcnt lgkmcnt(4)
    v_cmp_le_u32 vcc, 112, v13
    s_cbranch_vccz L_gs_43
L_gs_43_r:
    s_setprio 0
    s_waitcnt vmcnt(13)
    ds_add_u32 v28, v29
    ds_read_b64_tr_b16 v[32:33], v8 offset:40960
    ds_read_b64_tr_b16 v[34:35], v8 offset:41984
    s_add_u32 m0, s98, 480
    s_add_u32 s60, s15, 57344
    s_mov_b64 exec, 0xff
    buffer_load_dword v22, s[40:43], s60 offen lds
    s_mov_b64 exec, -1
    v_mfma_f32_32x32x16_bf16 v[80:95], v[36:39], v[208:211], v[80:95]
    ds_read_b64_tr_b16 v[36:37], v9 offset:40960
    ds_read_b64_tr_b16 v[38:39], v9 offset:41984
    v_mfma_f32_32x32x16_bf16 v[96:111], v[40:43], v[208:211], v[96:111]
    ds_read_b64_tr_b16 v[40:41], v10 offset:40960
    ds_read_b64_tr_b16 v[42:43], v10 offset:41984
    v_mfma_f32_32x32x16_bf16 v[112:127], v[44:47], v[208:211], v[112:127]
    ds_read_b64_tr_b16 v[44:45], v11 offset:40960
    ds_read_b64_tr_b16 v[46:47], v11 offset:41984
    v_mfma_f32_32x32x16_bf16 v[64:79], v[48:51], v[212:215], v[64:79]
    ds_read_b64_tr_b16 v[48:49], v8 offset:45056
    ds_read_b64_tr_b16 v[50:51], v8 offset:46080
    v_mfma_f32_32x32x16_bf16 v[80:95], v[52:55], v[212:215], v[80:95]
    ds_read_b64_tr_b16 v[52:53], v9 offset:45056
    ds_read_b64_tr_b16 v[54:55], v9 offset:46080
    ds_read_b32 v13, v30
    s_waitcnt lgkmcnt(14)
    v_mfma_f32_32x32x16_bf16 v[96:111], v[56:59], v[212:215], v[96:111]
    ds_read_b64_tr_b16 v[56:57], v10 offset:45056
    ds_read_b64_tr_b16 v[58:59], v10 offset:46080
    v_mfma_f32_32x32x16_bf16 v[112:127], v[60:63], v[212:215], v[112:127]
    ds_read_b64_tr_b16 v[60:61], v11 offset:45056
    ds_read_b64_tr_b16 v[62:63], v11 offset:46080
    s_waitcnt lgkmcnt(13)
    v_mfma_f32_32x32x16_bf16 v[64:79], v[32:35], v[216:219], v[64:79]
    s_setprio 2
    s_waitcnt lgkmcnt(4)
    v_cmp_le_u32 vcc, 116, v13
    s_cbranch_vccz L_gs_44
L_gs_44_r:
L_pl_45:
    ds_read_b32 v13, v1 offset:16
    s_waitcnt lgkmcnt(0)
    v_cmp_le_u32 vcc, 3, v13
    s_cbranch_vccnz L_pld_46
    s_sub_u32 s70, s70, 1
    s_cbranch_scc1 L_pld_46_x
    s_sleep 1
    s_branch L_pl_45
L_pld_46_x:
    s_mov_b32 s70, 0
L_pld_46:
    s_setprio 0
    s_waitcnt vmcnt(11)
    ds_add_u32 v28, v29
    s_setprio 2
    v_bfe_u32 v2, v0, 1, 2
    v_lshlrev_b32 v2, 4, v2
    v_and_b32 v3, 1, v0
    v_add_u32 v2, v2, v3
    s_lshl_b32 s60, s58, 6
    s_lshl_b32 s61, s57, 2
    s_add_u32 s60, s60, s61
    s_lshr_b32 s61, s59, 3
    s_lshl_b32 s61, s61, 1
    s_add_u32 s60, s60, s61
    v_add_u32 v2, s60, v2
    v_lshlrev_b32 v24, 3, v2
    s_mov_b32 s87, 159744
    s_setprio 0
    buffer_load_dwordx2 v[14:15], v24, s[32:35], s87 offen sc1
    ds_read_b64_tr_b16 v[32:33], v8 offset:49152
    ds_read_b64_tr_b16 v[34:35], v8 offset:50176
    s_add_u32 m0, s68, 4096
    s_add_u32 s60, s69, 78848
    buffer_load_dwordx4 v12, s[32:35], s60 offen sc1 lds
    v_mfma_f32_32x32x16_bf16 v[80:95], v[36:39], v[216:219], v[80:95]
    ds_read_b64_tr_b16 v[36:37], v9 offset:49152
    ds_read_b64_tr_b16 v[38:39], v9 offset:50176
    s_add_u32 m0, s68, 12288
    s_add_u32 s60, s69, 14336
    buffer_load_dwordx4 v12, s[32:35], s60 offen sc1 lds
    v_mfma_f32_32x32x16_bf16 v[96:111], v[40:43], v[216:219], v[96:111]
    ds_read_b64_tr_b16 v[40:41], v10 offset:49152
    ds_read_b64_tr_b16 v[42:43], v10 offset:50176
    s_add_u32 m0, s68, 5120
    s_add_u32 s60, s69, 79872
    buffer_load_dwordx4 v12, s[32:35], s60 offen sc1 lds
    v_mfma_f32_32x32x16_bf16 v[112:127], v[44:47], v[216:219], v[112:127]
    ds_read_b64_tr_b16 v[44:45], v11 offset:49152
    ds_read_b64_tr_b16 v[46:47], v11 offset:50176
    s_add_u32 m0, s68, 13312
    s_add_u32 s60, s69, 15360
    buffer_load_dwordx4 v12, s[32:35], s60 offen sc1 lds
    v_mfma_f32_32x32x16_bf16 v[64:79], v[48:51], v[220:223], v[64:79]
    ds_read_b64_tr_b16 v[48:49], v8 offset:53248
    ds_read_b64_tr_b16 v[50:51], v8 offset:54272
    s_add_u32 m0, s98, 512
    s_add_u32 s60, s3, 0
    s_mov_b64 exec, 0xff
    buffer_load_dword v22, s[44:47], s60 offen lds
    s_mov_b64 exec, -1
    v_mfma_f32_32x32x16_bf16 v[80:95], v[52:55], v[220:223], v[80:95]
    ds_read_b64_tr_b16 v[52:53], v9 offset:53248
    ds_read_b64_tr_b16 v[54:55], v9 offset:54272
    ds_read_b32 v13, v30
    v_mfma_f32_32x32x16_bf16 v[96:111], v[56:59], v[220:223], v[96:111]
    ds_read_b64_tr_b16 v[56:57], v10 offset:53248
    ds_read_b64_tr_b16 v[58:59], v10 offset:54272
    v_mfma_f32_32x32x16_bf16 v[112:127], v[60:63], v[220:223], v[112:127]
    ds_read_b64_tr_b16 v[60:61], v11 offset:53248
    ds_read_b64_tr_b16 v[62:63], v11 offset:54272
    s_waitcnt lgkmcnt(13)
    v_mfma_f32_32x32x16_bf16 v[64:79], v[32:35], v[224:227], v[64:79]
    s_setprio 2
    s_waitcnt lgkmcnt(4)
    v_cmp_le_u32 vcc, 120, v13
    s_cbranch_vccz L_gs_47
L_gs_47_r:
    s_setprio 0
    s_waitcnt vmcnt(14)
    ds_add_u32 v28, v29
    ds_read_b64_tr_b16 v[32:33], v8 offset:57344
    ds_read_b64_tr_b16 v[34:35], v8 offset:58368
    s_add_u32 m0, s68, 6144
    s_add_u32 s60, s69, 80896
    buffer_load_dwordx4 v12, s[32:35], s60 offen sc1 lds
    v_mfma_f32_32x32x16_bf16 v[80:95], v[36:39], v[224:227], v[80:95]
    ds_read_b64_tr_b16 v[36:37], v9 offset:57344
    ds_read_b64_tr_b16 v[38:39], v9 offset:58368
    s_add_u32 m0, s98, 544
    s_add_u32 s60, s3, 8192
    s_mov_b64 exec, 0xff
    buffer_load_dword v22, s[44:47], s60 offen lds
    s_mov_b64 exec, -1
    v_mfma_f32_32x32x16_bf16 v[96:111], v[40:43], v[224:227], v[96:111]
    ds_read_b64_tr_b16 v[40:41], v10 offset:57344
    ds_read_b64_tr_b16 v[42:43], v10 offset:58368
    v_mfma_f32_32x32x16_bf16 v[112:127], v[44:47], v[224:227], v[112:127]
    ds_read_b64_tr_b16 v[44:45], v11 offset:57344
    ds_read_b64_tr_b16 v[46:47], v11 offset:58368
    v_mfma_f32_32x32x16_bf16 v[64:79], v[48:51], v[228:231], v[64:79]
    ds_read_b64_tr_b16 v[48:49], v8 offset:61440
    ds_read_b64_tr_b16 v[50:51], v8 offset:62464
    v_mfma_f32_32x32x16_bf16 v[80:95], v[52:55], v[228:231], v[80:95]
    ds_read_b64_tr_b16 v[52:53], v9 offset:61440
    ds_read_b64_tr_b16 v[54:55], v9 offset:62464
    ds_read_b32 v13, v30
    s_waitcnt lgkmcnt(14)
    v_mfma_f32_32x32x16_bf16 v[96:111], v[56:59], v[228:231], v[96:111]
    ds_read_b64_tr_b16 v[56:57], v10 offset:61440
    ds_read_b64_tr_b16 v[58:59], v10 offset:62464
    v_mfma_f32_32x32x16_bf16 v[112:127], v[60:63], v[228:231], v[112:127]
    ds_read_b64_tr_b16 v[60:61], v11 offset:61440
    ds_read_b64_tr_b16 v[62:63], v11 offset:62464
    s_waitcnt lgkmcnt(13)
    v_mfma_f32_32x32x16_bf16 v[64:79], v[32:35], v[232:235], v[64:79]
    s_setprio 2
    s_waitcnt lgkmcnt(4)
    v_cmp_le_u32 vcc, 124, v13
    s_cbranch_vccz L_gs_48
L_gs_48_r:
    s_setprio 0
    s_waitcnt vmcnt(13)
    ds_add_u32 v28, v29
    ds_read_b64_tr_b16 v[32:33], v16 offset:0
    ds_read_b64_tr_b16 v[34:35], v16 offset:1024
    s_add_u32 m0, s98, 576
    s_add_u32 s60, s3, 16384
    s_mov_b64 exec, 0xff
    buffer_load_dword v22, s[44:47], s60 offen lds
    s_mov_b64 exec, -1
    v_mfma_f32_32x32x16_bf16 v[80:95], v[36:39], v[232:235], v[80:95]
    ds_read_b64_tr_b16 v[36:37], v17 offset:0
    ds_read_b64_tr_b16 v[38:39], v17 offset:1024
    v_mfma_f32_32x32x16_bf16 v[96:111], v[40:43], v[232:235], v[96:111]
    ds_read_b64_tr_b16 v[40:41], v18 offset:0
    ds_read_b64_tr_b16 v[42:43], v18 offset:1024
    v_mfma_f32_32x32x16_bf16 v[112:127], v[44:47], v[232:235], v[112:127]
    ds_read_b64_tr_b16 v[44:45], v19 offset:0
    ds_read_b64_tr_b16 v[46:47], v19 offset:1024
    v_mfma_f32_32x32x16_bf16 v[64:79], v[48:51], v[236:239], v[64:79]
    ds_read_b64_tr_b16 v[48:49], v16 offset:4096
    ds_read_b64_tr_b16 v[50:51], v16 offset:5120
    v_mfma_f32_32x32x16_bf16 v[80:95], v[52:55], v[236:239], v[80:95]
    ds_read_b64_tr_b16 v[52:53], v17 offset:4096
    ds_read_b64_tr_b16 v[54:55], v17 offset:5120
    ds_read_b32 v13, v30
    s_waitcnt lgkmcnt(14)
    v_mfma_f32_32x32x16_bf16 v[96:111], v[56:59], v[236:239], v[96:111]
    ds_read_b64_tr_b16 v[56:57], v18 offset:4096
    ds_read_b64_tr_b16 v[58:59], v18 offset:5120
    v_mfma_f32_32x32x16_bf16 v[112:127], v[60:63], v[236:239], v[112:127]
    ds_read_b64_tr_b16 v[60:61], v19 offset:4096
    ds_read_b64_tr_b16 v[62:63], v19 offset:5120
    s_waitcnt lgkmcnt(13)
    v_mfma_f32_32x32x16_bf16 v[64:79], v[32:35], v[240:243], v[64:79]
    s_setprio 2
    s_waitcnt lgkmcnt(4)
    v_cmp_le_u32 vcc, 128, v13
    s_cbranch_vccz L_gs_49
L_gs_49_r:
    s_setprio 0
    s_waitcnt vmcnt(2)
    s_mov_b64 exec, 1
    ds_add_u32 v1, v29 offset:32
    s_mov_b64 exec, -1
    ds_read_b64_tr_b16 v[32:33], v16 offset:8192
    ds_read_b64_tr_b16 v[34:35], v16 offset:9216
    s_add_u32 m0, s98, 608
    s_add_u32 s60, s3, 24576
    s_mov_b64 exec, 0xff
    buffer_load_dword v22, s[44:47], s60 offen lds
    s_mov_b64 exec, -1
    v_mfma_f32_32x32x16_bf16 v[80:95], v[36:39], v[240:243], v[80:95]
    ds_read_b64_tr_b16 v[36:37], v17 offset:8192
    ds_read_b64_tr_b16 v[38:39], v17 offset:9216
    v_mfma_f32_32x32x16_bf16 v[96:111], v[40:43], v[240:243], v[96:111]
    ds_read_b64_tr_b16 v[40:41], v18 offset:8192
    ds_read_b64_tr_b16 v[42:43], v18 offset:9216
    v_mfma_f32_32x32x16_bf16 v[112:127], v[44:47], v[240:243], v[112:127]
    ds_read_b64_tr_b16 v[44:45], v19 offset:8192
    ds_read_b64_tr_b16 v[46:47], v19 offset:9216
    v_mfma_f32_32x32x16_bf16 v[64:79], v[48:51], v[244:247], v[64:79]
    ds_read_b64_tr_b16 v[48:49], v16 offset:12288
    ds_read_b64_tr_b16 v[50:51], v16 offset:13312
    v_mfma_f32_32x32x16_bf16 v[80:95], v[52:55], v[244:247], v[80:95]
    ds_read_b64_tr_b16 v[52:53], v17 offset:12288
    ds_read_b64_tr_b16 v[54:55], v17 offset:13312
    s_waitcnt lgkmcnt(13)
    v_mfma_f32_32x32x16_bf16 v[96:111], v[56:59], v[244:247], v[96:111]
    ds_read_b64_tr_b16 v[56:57], v18 offset:12288
    ds_read_b64_tr_b16 v[58:59], v18 offset:13312
    v_mfma_f32_32x32x16_bf16 v[112:127], v[60:63], v[244:247], v[112:127]
    ds_read_b64_tr_b16 v[60:61], v19 offset:12288
    ds_read_b64_tr_b16 v[62:63], v19 offset:13312
    s_waitcnt lgkmcnt(12)
    v_mfma_f32_32x32x16_bf16 v[64:79], v[32:35], v[248:251], v[64:79]
    v_mfma_f32_32x32x16_bf16 v[80:95], v[36:39], v[248:251], v[80:95]
    s_waitcnt lgkmcnt(8)
    v_mfma_f32_32x32x16_bf16 v[96:111], v[40:43], v[248:251], v[96:111]
    v_mfma_f32_32x32x16_bf16 v[112:127], v[44:47], v[248:251], v[112:127]
    s_waitcnt lgkmcnt(4)
    v_mfma_f32_32x32x16_bf16 v[64:79], v[48:51], v[252:255], v[64:79]
    v_mfma_f32_32x32x16_bf16 v[80:95], v[52:55], v[252:255], v[80:95]
    s_waitcnt lgkmcnt(0)
    v_mfma_f32_32x32x16_bf16 v[96:111], v[56:59], v[252:255], v[96:111]
    v_mfma_f32_32x32x16_bf16 v[112:127], v[60:63], v[252:255], v[112:127]
    ds_add_u32 v28, v29
    s_setprio 2
    v_lshrrev_b32 v2, 3, v0
    v_bfe_u32 v3, v0, 4, 1
    v_lshlrev_b32 v3, 2, v3
    v_and_b32 v4, 7, v0
    v_xor_b32 v3, v3, v4
    v_lshlrev_b32 v2, 10, v2
    v_lshl_add_u32 v2, v3, 4, v2
    s_add_u32 s60, s59, 0
    s_and_b32 s60, s60, 7
    s_lshl_b32 s60, s60, 7
    v_add_u32 v20, s60, v2
    v_add_u32 v21, 7168, v20
    s_mul_i32 s74, s57, 65536
    s_mul_i32 s75, s57, 32768
    s_mul_i32 s68, s57, 65536
    s_mul_i32 s99, s57, 32768
    s_mul_i32 s71, s57, 16384
    s_add_u32 s71, s71, 69632
    s_lshl_b32 s64, s58, 2
    s_lshr_b32 s60, s59, 3
    s_lshl_b32 s60, s60, 1
    s_add_u32 s64, s64, s60
    v_and_b32 v16, 31, v0
    v_lshlrev_b32 v16, 10, v16
    v_lshrrev_b32 v3, 5, v0
    v_lshl_add_u32 v16, v3, 4, v16
    s_lshr_b32 s60, s57, 1
    s_add_u32 s60, s60, s64
    s_lshl_b32 s60, s60, 15
    s_add_u32 s61, s59, 0
    s_and_b32 s61, s61, 7
    s_lshl_b32 s61, s61, 7
    s_add_u32 s65, s60, s61
    s_and_b32 s61, s57, 1
    s_lshl_b32 s61, s61, 6
    s_add_u32 s65, s65, s61
    v_bfe_u32 v2, v0, 2, 2
    v_lshrrev_b32 v3, 5, v0
    v_lshl_add_u32 v3, v3, 2, v2
    v_lshlrev_b32 v3, 7, v3
    v_lshrrev_b32 v2, 1, v2
    v_lshl_add_u32 v3, v2, 6, v3
    v_bfe_u32 v2, v0, 4, 1
    v_lshl_add_u32 v3, v2, 5, v3
    v_and_b32 v2, 3, v0
    v_lshl_add_u32 v3, v2, 3, v3
    v_xor_b32 v3, s61, v3
    v_add_u32 v8, s71, v3
    v_xor_b32 v9, 64, v8
    s_lshr_b32 s60, s57, 1
    s_mul_i32 s61, s60, 114688
    v_add_u32 v22, s61, v12
    s_sub_u32 s61, 114688, s61
    v_add_u32 v17, s61, v12
    s_lshl_b32 s61, s60, 15
    v_add_u32 v23, s61, v12
    s_sub_u32 s61, 32768, s61
    v_add_u32 v18, s61, v12
    s_mul_i32 s98, s64, 114688
    s_add_u32 s98, s98, 1048576
    s_mul_i32 s60, s57, 6144
    s_add_u32 s3, s98, s60
    s_mul_i32 s60, s57, 8192
    s_add_u32 s98, s98, s60
    s_lshl_b32 s77, s64, 15
    s_mul_i32 s60, s57, 2048
    s_add_u32 s77, s77, s60
    s_add_u32 s77, s77, 9437184
L_pl_50:
    ds_read_b32 v13, v30 offset:0
    s_waitcnt lgkmcnt(0)
    v_cmp_le_u32 vcc, 132, v13
    s_cbranch_vccnz L_pld_51
    s_sub_u32 s70, s70, 1
    s_cbranch_scc1 L_pld_51_x
    s_sleep 1
    s_branch L_pl_50
L_pld_51_x:
    s_mov_b32 s70, 0
L_pld_51:
    v_cmp_eq_u32 vcc, s72, v14
    v_cmp_eq_u32 s[78:79], s73, v15
    s_and_b64 vcc, vcc, s[78:79]
    s_cmp_eq_u64 vcc, -1
    s_cbranch_scc1 L_fh_52
    s_mov_b32 s87, 159744
L_pf_53:
    buffer_load_dwordx2 v[14:15], v24, s[32:35], s87 offen sc1
    s_waitcnt vmcnt(0)
    v_cmp_eq_u32 vcc, s72, v14
    v_cmp_eq_u32 s[78:79], s73, v15
    s_and_b64 vcc, vcc, s[78:79]
    s_cmp_eq_u64 vcc, -1
    s_cbranch_scc1 L_pfd_54
    s_sub_u32 s70, s70, 1
    s_cbranch_scc1 L_pfd_54_x
    s_sleep 2
    s_branch L_pf_53
L_pfd_54_x:
    s_mov_b32 s70, 0
L_pfd_54:
L_fh_52:
    s_add_u32 m0, s71, 0
    s_add_u32 s60, s74, 0
    buffer_load_dwordx4 v20, s[40:43], s60 offen lds
    buffer_load_dwordx4 v21, s[40:43], s60 offen offset:1024 lds
    s_add_u32 s62, s98, 0
    buffer_load_dwordx4 v[128:131], v22, s[32:35], s62 offen offset:0 sc1
    buffer_load_dwordx4 v[132:135], v17, s[32:35], s62 offen offset:0 sc1
    s_add_u32 m0, s71, 2048
    s_add_u32 s60, s74, 16384
    buffer_load_dwordx4 v20, s[40:43], s60 offen lds
    buffer_load_dwordx4 v21, s[40:43], s60 offen offset:1024 lds
    buffer_load_dwordx4 v[136:139], v22, s[32:35], s62 offen offset:1024 sc1
    buffer_load_dwordx4 v[140:143], v17, s[32:35], s62 offen offset:1024 sc1
    buffer_load_dwordx4 v[144:147], v22, s[32:35], s62 offen offset:2048 sc1
    buffer_load_dwordx4 v[148:151], v17, s[32:35], s62 offen offset:2048 sc1
    buffer_load_dwordx4 v[152:155], v22, s[32:35], s62 offen offset:3072 sc1
    buffer_load_dwordx4 v[156:159], v17, s[32:35], s62 offen offset:3072 sc1
    buffer_load_dwordx4 v[48:51], v16, s[28:31], s65 offen offset:0
    buffer_load_dwordx4 v[52:55], v16, s[28:31], s65 offen offset:32
    v_pk_mul_f32 v[2:3], v[64:65], v[26:27] op_sel_hi:[1,0]
    v_pk_mul_f32 v[4:5], v[66:67], v[26:27] op_sel_hi:[1,0]
    v_pk_mul_f32 v[6:7], v[68:69], v[26:27] op_sel_hi:[1,0]
    v_pk_mul_f32 v[14:15], v[70:71], v[26:27] op_sel_hi:[1,0]
    v_exp_f32 v2, v2
    v_exp_f32 v3, v3
    v_exp_f32 v4, v4
    v_exp_f32 v5, v5
    v_exp_f32 v6, v6
    v_exp_f32 v7, v7
    v_exp_f32 v14, v14
    v_exp_f32 v15, v15
    v_pk_mul_f32 v[64:65], v[64:65], v[72:73]
    v_pk_mul_f32 v[66:67], v[66:67], v[74:75]
    v_pk_mul_f32 v[68:69], v[68:69], v[76:77]
    v_pk_mul_f32 v[70:71], v[70:71], v[78:79]
    v_pk_fma_f32 v[2:3], v[2:3], v[26:27], v[26:27] op_sel:[0,1,1] op_sel_hi:[1,1,1]
    v_pk_fma_f32 v[4:5], v[4:5], v[26:27], v[26:27] op_sel:[0,1,1] op_sel_hi:[1,1,1]
    v_pk_fma_f32 v[6:7], v[6:7], v[26:27], v[26:27] op_sel:[0,1,1] op_sel_hi:[1,1,1]
    v_pk_fma_f32 v[14:15], v[14:15], v[26:27], v[26:27] op_sel:[0,1,1] op_sel_hi:[1,1,1]
    v_rcp_f32 v2, v2
    v_rcp_f32 v3, v3
    v_rcp_f32 v4, v4
    v_rcp_f32 v5, v5
    v_rcp_f32 v6, v6
    v_rcp_f32 v7, v7
    v_rcp_f32 v14, v14
    v_rcp_f32 v15, v15
    s_nop 0
    v_pk_mul_f32 v[64:65], v[64:65], v[2:3]
    v_pk_mul_f32 v[66:67], v[66:67], v[4:5]
    v_pk_mul_f32 v[68:69], v[68:69], v[6:7]
    v_pk_mul_f32 v[70:71], v[70:71], v[14:15]
    v_cvt_pk_bf16_f32 v72, v64, v65
    v_cvt_pk_bf16_f32 v73, v66, v67
    v_cvt_pk_bf16_f32 v74, v68, v69
    v_cvt_pk_bf16_f32 v75, v70, v71
    s_add_u32 s76, s76, 4096
    buffer_store_dwordx4 v[72:75], v12, s[32:35], s76 offen offset:0 sc1
    v_pk_mul_f32 v[2:3], v[80:81], v[26:27] op_sel_hi:[1,0]
    v_pk_mul_f32 v[4:5], v[82:83], v[26:27] op_sel_hi:[1,0]
    v_pk_mul_f32 v[6:7], v[84:85], v[26:27] op_sel_hi:[1,0]
    v_pk_mul_f32 v[14:15], v[86:87], v[26:27] op_sel_hi:[1,0]
    v_exp_f32 v2, v2
    v_exp_f32 v3, v3
    v_exp_f32 v4, v4
    v_exp_f32 v5, v5
    v_exp_f32 v6, v6
    v_exp_f32 v7, v7
    v_exp_f32 v14, v14
    v_exp_f32 v15, v15
    v_pk_mul_f32 v[80:81], v[80:81], v[88:89]
    v_pk_mul_f32 v[82:83], v[82:83], v[90:91]
    v_pk_mul_f32 v[84:85], v[84:85], v[92:93]
    v_pk_mul_f32 v[86:87], v[86:87], v[94:95]
    v_pk_fma_f32 v[2:3], v[2:3], v[26:27], v[26:27] op_sel:[0,1,1] op_sel_hi:[1,1,1]
    v_pk_fma_f32 v[4:5], v[4:5], v[26:27], v[26:27] op_sel:[0,1,1] op_sel_hi:[1,1,1]
    v_pk_fma_f32 v[6:7], v[6:7], v[26:27], v[26:27] op_sel:[0,1,1] op_sel_hi:[1,1,1]
    v_pk_fma_f32 v[14:15], v[14:15], v[26:27], v[26:27] op_sel:[0,1,1] op_sel_hi:[1,1,1]
    v_rcp_f32 v2, v2
    v_rcp_f32 v3, v3
    v_rcp_f32 v4, v4
    v_rcp_f32 v5, v5
    v_rcp_f32 v6, v6
    v_rcp_f32 v7, v7
    v_rcp_f32 v14, v14
    v_rcp_f32 v15, v15
    s_nop 0
    v_pk_mul_f32 v[80:81], v[80:81], v[2:3]
    v_pk_mul_f32 v[82:83], v[82:83], v[4:5]
    v_pk_mul_f32 v[84:85], v[84:85], v[6:7]
    v_pk_mul_f32 v[86:87], v[86:87], v[14:15]
    v_cvt_pk_bf16_f32 v88, v80, v81
    v_cvt_pk_bf16_f32 v89, v82, v83
    v_cvt_pk_bf16_f32 v90, v84, v85
    v_cvt_pk_bf16_f32 v91, v86, v87
    buffer_store_dwordx4 v[88:91], v12, s[32:35], s76 offen offset:1024 sc1
    v_pk_mul_f32 v[2:3], v[96:97], v[26:27] op_sel_hi:[1,0]
    v_pk_mul_f32 v[4:5], v[98:99], v[26:27] op_sel_hi:[1,0]
    v_pk_mul_f32 v[6:7], v[100:101], v[26:27] op_sel_hi:[1,0]
    v_pk_mul_f32 v[14:15], v[102:103], v[26:27] op_sel_hi:[1,0]
    v_exp_f32 v2, v2
    v_exp_f32 v3, v3
    v_exp_f32 v4, v4
    v_exp_f32 v5, v5
    v_exp_f32 v6, v6
    v_exp_f32 v7, v7
    v_exp_f32 v14, v14
    v_exp_f32 v15, v15
    v_pk_mul_f32 v[96:97], v[96:97], v[104:105]
    v_pk_mul_f32 v[98:99], v[98:99], v[106:107]
    v_pk_mul_f32 v[100:101], v[100:101], v[108:109]
    v_pk_mul_f32 v[102:103], v[102:103], v[110:111]
    v_pk_fma_f32 v[2:3], v[2:3], v[26:27], v[26:27] op_sel:[0,1,1] op_sel_hi:[1,1,1]
    v_pk_fma_f32 v[4:5], v[4:5], v[26:27], v[26:27] op_sel:[0,1,1] op_sel_hi:[1,1,1]
    v_pk_fma_f32 v[6:7], v[6:7], v[26:27], v[26:27] op_sel:[0,1,1] op_sel_hi:[1,1,1]
    v_pk_fma_f32 v[14:15], v[14:15], v[26:27], v[26:27] op_sel:[0,1,1] op_sel_hi:[1,1,1]
    v_rcp_f32 v2, v2
    v_rcp_f32 v3, v3
    v_rcp_f32 v4, v4
    v_rcp_f32 v5, v5
    v_rcp_f32 v6, v6
    v_rcp_f32 v7, v7
    v_rcp_f32 v14, v14
    v_rcp_f32 v15, v15
    s_nop 0
    v_pk_mul_f32 v[96:97], v[96:97], v[2:3]
    v_pk_mul_f32 v[98:99], v[98:99], v[4:5]
    v_pk_mul_f32 v[100:101], v[100:101], v[6:7]
    v_pk_mul_f32 v[102:103], v[102:103], v[14:15]
    v_cvt_pk_bf16_f32 v104, v96, v97
    v_cvt_pk_bf16_f32 v105, v98, v99
    v_cvt_pk_bf16_f32 v106, v100, v101
    v_cvt_pk_bf16_f32 v107, v102, v103
    buffer_store_dwordx4 v[104:107], v12, s[32:35], s76 offen offset:2048 sc1
    v_pk_mul_f32 v[2:3], v[112:113], v[26:27] op_sel_hi:[1,0]
    v_pk_mul_f32 v[4:5], v[114:115], v[26:27] op_sel_hi:[1,0]
    v_pk_mul_f32 v[6:7], v[116:117], v[26:27] op_sel_hi:[1,0]
    v_pk_mul_f32 v[14:15], v[118:119], v[26:27] op_sel_hi:[1,0]
    v_exp_f32 v2, v2
    v_exp_f32 v3, v3
    v_exp_f32 v4, v4
    v_exp_f32 v5, v5
    v_exp_f32 v6, v6
    v_exp_f32 v7, v7
    v_exp_f32 v14, v14
    v_exp_f32 v15, v15
    v_pk_mul_f32 v[112:113], v[112:113], v[120:121]
    v_pk_mul_f32 v[114:115], v[114:115], v[122:123]
    v_pk_mul_f32 v[116:117], v[116:117], v[124:125]
    v_pk_mul_f32 v[118:119], v[118:119], v[126:127]
    v_pk_fma_f32 v[2:3], v[2:3], v[26:27], v[26:27] op_sel:[0,1,1] op_sel_hi:[1,1,1]
    v_pk_fma_f32 v[4:5], v[4:5], v[26:27], v[26:27] op_sel:[0,1,1] op_sel_hi:[1,1,1]
    v_pk_fma_f32 v[6:7], v[6:7], v[26:27], v[26:27] op_sel:[0,1,1] op_sel_hi:[1,1,1]
    v_pk_fma_f32 v[14:15], v[14:15], v[26:27], v[26:27] op_sel:[0,1,1] op_sel_hi:[1,1,1]
    v_rcp_f32 v2, v2
    v_rcp_f32 v3, v3
    v_rcp_f32 v4, v4
    v_rcp_f32 v5, v5
    v_rcp_f32 v6, v6
    v_rcp_f32 v7, v7
    v_rcp_f32 v14, v14
    v_rcp_f32 v15, v15
    s_nop 0
    v_pk_mul_f32 v[112:113], v[112:113], v[2:3]
    v_pk_mul_f32 v[114:115], v[114:115], v[4:5]
    v_pk_mul_f32 v[116:117], v[116:117], v[6:7]
    v_pk_mul_f32 v[118:119], v[118:119], v[14:15]
    v_cvt_pk_bf16_f32 v120, v112, v113
    v_cvt_pk_bf16_f32 v121, v114, v115
    v_cvt_pk_bf16_f32 v122, v116, v117
    v_cvt_pk_bf16_f32 v123, v118, v119
    buffer_store_dwordx4 v[120:123], v12, s[32:35], s76 offen offset:3072 sc1
    s_add_u32 m0, s71, 4096
    s_add_u32 s60, s74, 32768
    buffer_load_dwordx4 v20, s[40:43], s60 offen lds
    buffer_load_dwordx4 v21, s[40:43], s60 offen offset:1024 lds
    s_add_u32 m0, s71, 6144
    s_add_u32 s60, s74, 49152
    buffer_load_dwordx4 v20, s[40:43], s60 offen lds
    buffer_load_dwordx4 v21, s[40:43], s60 offen offset:1024 lds
    s_add_u32 m0, s71, 8192
    s_add_u32 s60, s74, 262144
    buffer_load_dwordx4 v20, s[40:43], s60 offen lds
    buffer_load_dwordx4 v21, s[40:43], s60 offen offset:1024 lds
    s_add_u32 m0, s71, 10240
    s_add_u32 s60, s74, 278528
    buffer_load_dwordx4 v20, s[40:43], s60 offen lds
    buffer_load_dwordx4 v21, s[40:43], s60 offen offset:1024 lds
    s_add_u32 m0, s71, 12288
    s_add_u32 s60, s74, 294912
    buffer_load_dwordx4 v20, s[40:43], s60 offen lds
    buffer_load_dwordx4 v21, s[40:43], s60 offen offset:1024 lds
    s_add_u32 m0, s71, 14336
    s_add_u32 s60, s74, 311296
    buffer_load_dwordx4 v20, s[40:43], s60 offen lds
    buffer_load_dwordx4 v21, s[40:43], s60 offen offset:1024 lds
    v_and_b32 v2, 31, v0
    v_lshrrev_b32 v3, 5, v0
    v_lshlrev_b32 v3, 3, v3
    v_sub_u32 v2, v2, v3
    v_and_b32 v3, 1, v2
    v_lshlrev_b32 v3, 4, v3
    v_lshrrev_b32 v2, 1, v2
    v_mov_b32 v56, 0x3f80
    v_lshlrev_b32 v3, v3, v56
    v_cmp_eq_u32 vcc, 0, v2
    s_nop 1
    v_cndmask_b32 v56, 0, v3, vcc
    v_cmp_eq_u32 vcc, 1, v2
    s_nop 1
    v_cndmask_b32 v57, 0, v3, vcc
    v_cmp_eq_u32 vcc, 2, v2
    s_nop 1
    v_cndmask_b32 v58, 0, v3, vcc
    v_cmp_eq_u32 vcc, 3, v2
    s_nop 1
    v_cndmask_b32 v59, 0, v3, vcc
    v_cmp_eq_u32 vcc, 8, v2
    s_nop 1
    v_cndmask_b32 v60, 0, v3, vcc
    v_cmp_eq_u32 vcc, 9, v2
    s_nop 1
    v_cndmask_b32 v61, 0, v3, vcc
    v_cmp_eq_u32 vcc, 10, v2
    s_nop 1
    v_cndmask_b32 v62, 0, v3, vcc
    v_cmp_eq_u32 vcc, 11, v2
    s_nop 1
    v_cndmask_b32 v63, 0, v3, vcc
    s_waitcnt vmcnt(16)
    v_mfma_f32_32x32x16_bf16 v[64:79], v[56:59], v[48:51], 0
    v_mfma_f32_32x32x16_bf16 v[64:79], v[60:63], v[52:55], v[64:79]
    s_setprio 0
    ds_read_b64_tr_b16 v[32:33], v8 offset:0
    ds_read_b64_tr_b16 v[34:35], v8 offset:1024
    ds_read_b64_tr_b16 v[36:37], v9 offset:0
    ds_read_b64_tr_b16 v[38:39], v9 offset:1024
    ds_read_b64_tr_b16 v[40:41], v8 offset:2048
    ds_read_b64_tr_b16 v[42:43], v8 offset:3072
    ds_read_b64_tr_b16 v[44:45], v9 offset:2048
    ds_read_b64_tr_b16 v[46:47], v9 offset:3072
    s_waitcnt lgkmcnt(4)
    v_mfma_f32_32x32x16_bf16 v[64:79], v[32:35], v[128:131], v[64:79]
    s_waitcnt vmcnt(10)
    ds_read_b64_tr_b16 v[48:49], v8 offset:4096
    ds_read_b64_tr_b16 v[50:51], v8 offset:5120
    ds_read_b64_tr_b16 v[52:53], v9 offset:4096
    ds_read_b64_tr_b16 v[54:55], v9 offset:5120
    v_mfma_f32_32x32x16_bf16 v[80:95], v[36:39], v[128:131], 0
    s_add_u32 m0, s71, 0
    s_add_u32 s60, s74, 524288
    buffer_load_dwordx4 v20, s[40:43], s60 offen lds
    buffer_load_dwordx4 v21, s[40:43], s60 offen offset:1024 lds
    v_mfma_f32_32x32x16_bf16 v[96:111], v[32:35], v[132:135], 0
    v_mfma_f32_32x32x16_bf16 v[112:127], v[36:39], v[132:135], 0
    s_add_u32 s62, s98, 32768
    buffer_load_dwordx4 v[128:131], v22, s[32:35], s62 offen offset:0 sc1
    buffer_load_dwordx4 v[132:135], v17, s[32:35], s62 offen offset:0 sc1
    s_waitcnt lgkmcnt(4)
    v_mfma_f32_32x32x16_bf16 v[64:79], v[40:43], v[136:139], v[64:79]
    s_waitcnt vmcnt(12)
    ds_read_b64_tr_b16 v[56:57], v8 offset:6144
    ds_read_b64_tr_b16 v[58:59], v8 offset:7168
    ds_read_b64_tr_b16 v[60:61], v9 offset:6144
    ds_read_b64_tr_b16 v[62:63], v9 offset:7168
    v_mfma_f32_32x32x16_bf16 v[80:95], v[44:47], v[136:139], v[80:95]
    s_add_u32 m0, s71, 2048
    s_add_u32 s60, s74, 540672
    buffer_load_dwordx4 v20, s[40:43], s60 offen lds
    buffer_load_dwordx4 v21, s[40:43], s60 offen offset:1024 lds
    v_mfma_f32_32x32x16_bf16 v[96:111], v[40:43], v[140:143], v[96:111]
    v_mfma_f32_32x32x16_bf16 v[112:127], v[44:47], v[140:143], v[112:127]
    buffer_load_dwordx4 v[136:139], v22, s[32:35], s62 offen offset:1024 sc1
    buffer_load_dwordx4 v[140:143], v17, s[32:35], s62 offen offset:1024 sc1
    s_waitcnt lgkmcnt(4)
    v_mfma_f32_32x32x16_bf16 v[64:79], v[48:51], v[144:147], v[64:79]
    s_waitcnt vmcnt(14)
    ds_read_b64_tr_b16 v[32:33], v8 offset:8192
    ds_read_b64_tr_b16 v[34:35], v8 offset:9216
    ds_read_b64_tr_b16 v[36:37], v9 offset:8192
    ds_read_b64_tr_b16 v[38:39], v9 offset:9216
    v_mfma_f32_32x32x16_bf16 v[80:95], v[52:55], v[144:147], v[80:95]
    s_add_u32 m0, s71, 4096
    s_add_u32 s60, s74, 557056
    buffer_load_dwordx4 v20, s[40:43], s60 offen lds
    buffer_load_dwordx4 v21, s[40:43], s60 offen offset:1024 lds
    v_mfma_f32_32x32x16_bf16 v[96:111], v[48:51], v[148:151], v[96:111]
    s_setprio 2
    s_lshl_b32 s60, s80, 2
    s_add_u32 s60, s60, s57
    s_lshl_b32 s60, s60, 3
    v_mov_b32 v6, s60
    v_mov_b32 v4, s72
    v_mov_b32 v5, s73
    s_mov_b32 s87, 151552
    s_mov_b64 exec, 1
    buffer_store_dwordx2 v[4:5], v6, s[32:35], s87 offen sc1
    s_mov_b64 exec, -1
    s_setprio 0
    v_mfma_f32_32x32x16_bf16 v[112:127], v[52:55], v[148:151], v[112:127]
    buffer_load_dwordx4 v[144:147], v22, s[32:35], s62 offen offset:2048 sc1
    buffer_load_dwordx4 v[148:151], v17, s[32:35], s62 offen offset:2048 sc1
    s_waitcnt lgkmcnt(4)
    v_mfma_f32_32x32x16_bf16 v[64:79], v[56:59], v[152:155], v[64:79]
    s_waitcnt vmcnt(17)
    ds_read_b64_tr_b16 v[40:41], v8 offset:10240
    ds_read_b64_tr_b16 v[42:43], v8 offset:11264
    ds_read_b64_tr_b16 v[44:45], v9 offset:10240
    ds_read_b64_tr_b16 v[46:47], v9 offset:11264
    v_mfma_f32_32x32x16_bf16 v[80:95], v[60:63], v[152:155], v[80:95]
    s_add_u32 m0, s71, 6144
    s_add_u32 s60, s74, 573440
    buffer_load_dwordx4 v20, s[40:43], s60 offen lds
    buffer_load_dwordx4 v21, s[40:43], s60 offen offset:1024 lds
    v_mfma_f32_32x32x16_bf16 v[96:111], v[56:59], v[156:159], v[96:111]
    v_mfma_f32_32x32x16_bf16 v[112:127], v[60:63], v[156:159], v[112:127]
    buffer_load_dwordx4 v[152:155], v22, s[32:35], s62 offen offset:3072 sc1
    buffer_load_dwordx4 v[156:159], v17, s[32:35], s62 offen offset:3072 sc1
    s_waitcnt vmcnt(13) lgkmcnt(4)
    v_mfma_f32_32x32x16_bf16 v[64:79], v[32:35], v[128:131], v[64:79]
    ds_read_b64_tr_b16 v[48:49], v8 offset:12288
    ds_read_b64_tr_b16 v[50:51], v8 offset:13312
    ds_read_b64_tr_b16 v[52:53], v9 offset:12288
    ds_read_b64_tr_b16 v[54:55], v9 offset:13312
    v_mfma_f32_32x32x16_bf16 v[80:95], v[36:39], v[128:131], v[80:95]
    s_add_u32 m0, s71, 8192
    s_add_u32 s60, s74, 786432
    buffer_load_dwordx4 v20, s[40:43], s60 offen lds
    buffer_load_dwordx4 v21, s[40:43], s60 offen offset:1024 lds
    v_mfma_f32_32x32x16_bf16 v[96:111], v[32:35], v[132:135], v[96:111]
    v_mfma_f32_32x32x16_bf16 v[112:127], v[36:39], v[132:135], v[112:127]
    s_add_u32 s62, s3, 65536
    buffer_load_dwordx4 v[128:131], v22, s[32:35], s62 offen offset:0 sc1
    buffer_load_dwordx4 v[132:135], v17, s[32:35], s62 offen offset:0 sc1
    s_waitcnt vmcnt(13) lgkmcnt(4)
    v_mfma_f32_32x32x16_bf16 v[64:79], v[40:43], v[136:139], v[64:79]
    ds_read_b64_tr_b16 v[56:57], v8 offset:14336
    ds_read_b64_tr_b16 v[58:59], v8 offset:15360
    ds_read_b64_tr_b16 v[60:61], v9 offset:14336
    ds_read_b64_tr_b16 v[62:63], v9 offset:15360
    v_mfma_f32_32x32x16_bf16 v[80:95], v[44:47], v[136:139], v[80:95]
    s_add_u32 m0, s71, 10240
    s_add_u32 s60, s74, 802816
    buffer_load_dwordx4 v20, s[40:43], s60 offen lds
    buffer_load_dwordx4 v21, s[40:43], s60 offen offset:1024 lds
    v_mfma_f32_32x32x16_bf16 v[96:111], v[40:43], v[140:143], v[96:111]
    v_mfma_f32_32x32x16_bf16 v[112:127], v[44:47], v[140:143], v[112:127]
    buffer_load_dwordx4 v[136:139], v22, s[32:35], s62 offen offset:1024 sc1
    buffer_load_dwordx4 v[140:143], v17, s[32:35], s62 offen offset:1024 sc1
    s_waitcnt vmcnt(12) lgkmcnt(4)
    v_mfma_f32_32x32x16_bf16 v[64:79], v[48:51], v[144:147], v[64:79]
    ds_read_b64_tr_b16 v[32:33], v8 offset:0
    ds_read_b64_tr_b16 v[34:35], v8 offset:1024
    ds_read_b64_tr_b16 v[36:37], v9 offset:0
    ds_read_b64_tr_b16 v[38:39], v9 offset:1024
    v_mfma_f32_32x32x16_bf16 v[80:95], v[52:55], v[144:147], v[80:95]
    s_add_u32 m0, s71, 12288
    s_add_u32 s60, s74, 819200
    buffer_load_dwordx4 v20, s[40:43], s60 offen lds
    buffer_load_dwordx4 v21, s[40:43], s60 offen offset:1024 lds
    v_mfma_f32_32x32x16_bf16 v[96:111], v[48:51], v[148:151], v[96:111]
    v_mfma_f32_32x32x16_bf16 v[112:127], v[52:55], v[148:151], v[112:127]
    buffer_load_dwordx4 v[144:147], v22, s[32:35], s62 offen offset:2048 sc1
    buffer_load_dwordx4 v[148:151], v17, s[32:35], s62 offen offset:2048 sc1
    s_waitcnt vmcnt(12) lgkmcnt(4)
    v_mfma_f32_32x32x16_bf16 v[64:79], v[56:59], v[152:155], v[64:79]
    ds_read_b64_tr_b16 v[40:41], v8 offset:2048
    ds_read_b64_tr_b16 v[42:43], v8 offset:3072
    ds_read_b64_tr_b16 v[44:45], v9 offset:2048
    ds_read_b64_tr_b16 v[46:47], v9 offset:3072
    v_mfma_f32_32x32x16_bf16 v[80:95], v[60:63], v[152:155], v[80:95]
    s_add_u32 m0, s71, 14336
    s_add_u32 s60, s74, 835584
    buffer_load_dwordx4 v20, s[40:43], s60 offen lds
    buffer_load_dwordx4 v21, s[40:43], s60 offen offset:1024 lds
    v_mfma_f32_32x32x16_bf16 v[96:111], v[56:59], v[156:159], v[96:111]
    v_mfma_f32_32x32x16_bf16 v[112:127], v[60:63], v[156:159], v[112:127]
    buffer_load_dwordx4 v[152:155], v22, s[32:35], s62 offen offset:3072 sc1
    buffer_load_dwordx4 v[156:159], v17, s[32:35], s62 offen offset:3072 sc1
    s_waitcnt vmcnt(12) lgkmcnt(4)
    v_mfma_f32_32x32x16_bf16 v[64:79], v[32:35], v[128:131], v[64:79]
    ds_read_b64_tr_b16 v[48:49], v8 offset:4096
    ds_read_b64_tr_b16 v[50:51], v8 offset:5120
    ds_read_b64_tr_b16 v[52:53], v9 offset:4096
    ds_read_b64_tr_b16 v[54:55], v9 offset:5120
    v_mfma_f32_32x32x16_bf16 v[80:95], v[36:39], v[128:131], v[80:95]
    s_add_u32 m0, s71, 0
    s_add_u32 s60, s99, 1572864
    buffer_load_dwordx4 v20, s[40:43], s60 offen lds
    buffer_load_dwordx4 v21, s[40:43], s60 offen offset:1024 lds
    v_mfma_f32_32x32x16_bf16 v[96:111], v[32:35], v[132:135], v[96:111]
    v_mfma_f32_32x32x16_bf16 v[112:127], v[36:39], v[132:135], v[112:127]
    s_add_u32 s62, s3, 90112
    buffer_load_dwordx4 v[128:131], v22, s[32:35], s62 offen offset:0 sc1
    buffer_load_dwordx4 v[132:135], v17, s[32:35], s62 offen offset:0 sc1
    s_waitcnt vmcnt(12) lgkmcnt(4)
    v_mfma_f32_32x32x16_bf16 v[64:79], v[40:43], v[136:139], v[64:79]
    ds_read_b64_tr_b16 v[56:57], v8 offset:6144
    ds_read_b64_tr_b16 v[58:59], v8 offset:7168
    ds_read_b64_tr_b16 v[60:61], v9 offset:6144
    ds_read_b64_tr_b16 v[62:63], v9 offset:7168
    v_mfma_f32_32x32x16_bf16 v[80:95], v[44:47], v[136:139], v[80:95]
    s_add_u32 m0, s71, 2048
    s_add_u32 s60, s99, 1589248
    buffer_load_dwordx4 v20, s[40:43], s60 offen lds
    buffer_load_dwordx4 v21, s[40:43], s60 offen offset:1024 lds
    v_mfma_f32_32x32x16_bf16 v[96:111], v[40:43], v[140:143], v[96:111]
    v_mfma_f32_32x32x16_bf16 v[112:127], v[44:47], v[140:143], v[112:127]
    buffer_load_dwordx4 v[136:139], v22, s[32:35], s62 offen offset:1024 sc1
    buffer_load_dwordx4 v[140:143], v17, s[32:35], s62 offen offset:1024 sc1
    s_waitcnt vmcnt(12) lgkmcnt(4)
    v_mfma_f32_32x32x16_bf16 v[64:79], v[48:51], v[144:147], v[64:79]
    ds_read_b64_tr_b16 v[32:33], v8 offset:8192
    ds_read_b64_tr_b16 v[34:35], v8 offset:9216
    ds_read_b64_tr_b16 v[36:37], v9 offset:8192
    ds_read_b64_tr_b16 v[38:39], v9 offset:9216
    v_mfma_f32_32x32x16_bf16 v[80:95], v[52:55], v[144:147], v[80:95]
    s_add_u32 m0, s71, 4096
    s_add_u32 s60, s99, 1703936
    buffer_load_dwordx4 v20, s[40:43], s60 offen lds
    buffer_load_dwordx4 v21, s[40:43], s60 offen offset:1024 lds
    v_mfma_f32_32x32x16_bf16 v[96:111], v[48:51], v[148:151], v[96:111]
    v_mfma_f32_32x32x16_bf16 v[112:127], v[52:55], v[148:151], v[112:127]
    s_mov_b32 s87, 151552
    buffer_load_dwordx2 v[2:3], v24, s[32:35], s87 offen sc1
    buffer_load_dwordx4 v[144:147], v22, s[32:35], s62 offen offset:2048 sc1
    buffer_load_dwordx4 v[148:151], v17, s[32:35], s62 offen offset:2048 sc1
    s_waitcnt vmcnt(13) lgkmcnt(4)
    v_mfma_f32_32x32x16_bf16 v[64:79], v[56:59], v[152:155], v[64:79]
    ds_read_b64_tr_b16 v[40:41], v8 offset:10240
    ds_read_b64_tr_b16 v[42:43], v8 offset:11264
    ds_read_b64_tr_b16 v[44:45], v9 offset:10240
    ds_read_b64_tr_b16 v[46:47], v9 offset:11264
    v_mfma_f32_32x32x16_bf16 v[80:95], v[60:63], v[152:155], v[80:95]
    s_add_u32 m0, s71, 6144
    s_add_u32 s60, s99, 1720320
    buffer_load_dwordx4 v20, s[40:43], s60 offen lds
    buffer_load_dwordx4 v21, s[40:43], s60 offen offset:1024 lds
    v_mfma_f32_32x32x16_bf16 v[96:111], v[56:59], v[156:159], v[96:111]
    v_mfma_f32_32x32x16_bf16 v[112:127], v[60:63], v[156:159], v[112:127]
    buffer_load_dwordx4 v[152:155], v22, s[32:35], s62 offen offset:3072 sc1
    buffer_load_dwordx4 v[156:159], v17, s[32:35], s62 offen offset:3072 sc1
    s_waitcnt vmcnt(13) lgkmcnt(4)
    v_mfma_f32_32x32x16_bf16 v[64:79], v[32:35], v[128:131], v[64:79]
    ds_read_b64_tr_b16 v[48:49], v8 offset:12288
    ds_read_b64_tr_b16 v[50:51], v8 offset:13312
    ds_read_b64_tr_b16 v[52:53], v9 offset:12288
    ds_read_b64_tr_b16 v[54:55], v9 offset:13312
    v_mfma_f32_32x32x16_bf16 v[80:95], v[36:39], v[128:131], v[80:95]
    s_add_u32 m0, s71, 8192
    s_add_u32 s60, s68, 1048576
    buffer_load_dwordx4 v20, s[40:43], s60 offen lds
    buffer_load_dwordx4 v21, s[40:43], s60 offen offset:1024 lds
    v_mfma_f32_32x32x16_bf16 v[96:111], v[32:35], v[132:135], v[96:111]
    v_mfma_f32_32x32x16_bf16 v[112:127], v[36:39], v[132:135], v[112:127]
    s_setprio 2
    s_waitcnt vmcnt(8)
    v_cmp_eq_u32 vcc, s72, v2
    v_cmp_eq_u32 s[78:79], s73, v3
    s_and_b64 vcc, vcc, s[78:79]
    s_or_b32 vcc_lo, vcc_lo, 0xf0f0f0f
    s_or_b32 vcc_hi, vcc_hi, 0xf0f0f0f
    s_cmp_eq_u64 vcc, -1
    s_cbranch_scc1 L_fh_55
    s_mov_b32 s87, 151552
L_pf_56:
    buffer_load_dwordx2 v[2:3], v24, s[32:35], s87 offen sc1
    s_waitcnt vmcnt(0)
    v_cmp_eq_u32 vcc, s72, v2
    v_cmp_eq_u32 s[78:79], s73, v3
    s_and_b64 vcc, vcc, s[78:79]
    s_or_b32 vcc_lo, vcc_lo, 0xf0f0f0f
    s_or_b32 vcc_hi, vcc_hi, 0xf0f0f0f
    s_cmp_eq_u64 vcc, -1
    s_cbranch_scc1 L_pfd_57
    s_sub_u32 s70, s70, 1
    s_cbranch_scc1 L_pfd_57_x
    s_sleep 2
    s_branch L_pf_56
L_pfd_57_x:
    s_mov_b32 s70, 0
L_pfd_57:
L_fh_55:
    s_setprio 0
    s_add_u32 s62, s3, 69632
    buffer_load_dwordx4 v[128:131], v22, s[32:35], s62 offen offset:0 sc1
    buffer_load_dwordx4 v[132:135], v17, s[32:35], s62 offen offset:0 sc1
    s_waitcnt lgkmcnt(4)
    v_mfma_f32_32x32x16_bf16 v[64:79], v[40:43], v[136:139], v[64:79]
    ds_read_b64_tr_b16 v[56:57], v8 offset:14336
    ds_read_b64_tr_b16 v[58:59], v8 offset:15360
    ds_read_b64_tr_b16 v[60:61], v9 offset:14336
    ds_read_b64_tr_b16 v[62:63], v9 offset:15360
    v_mfma_f32_32x32x16_bf16 v[80:95], v[44:47], v[136:139], v[80:95]
    s_add_u32 m0, s71, 10240
    s_add_u32 s60, s68, 1064960
    buffer_load_dwordx4 v20, s[40:43], s60 offen lds
    buffer_load_dwordx4 v21, s[40:43], s60 offen offset:1024 lds
    v_mfma_f32_32x32x16_bf16 v[96:111], v[40:43], v[140:143], v[96:111]
    v_mfma_f32_32x32x16_bf16 v[112:127], v[44:47], v[140:143], v[112:127]
    buffer_load_dwordx4 v[136:139], v22, s[32:35], s62 offen offset:1024 sc1
    buffer_load_dwordx4 v[140:143], v17, s[32:35], s62 offen offset:1024 sc1
    s_waitcnt vmcnt(12) lgkmcnt(4)
    v_mfma_f32_32x32x16_bf16 v[64:79], v[48:51], v[144:147], v[64:79]
    ds_read_b64_tr_b16 v[32:33], v8 offset:0
    ds_read_b64_tr_b16 v[34:35], v8 offset:1024
    ds_read_b64_tr_b16 v[36:37], v9 offset:0
    ds_read_b64_tr_b16 v[38:39], v9 offset:1024
    v_mfma_f32_32x32x16_bf16 v[80:95], v[52:55], v[144:147], v[80:95]
    s_add_u32 m0, s71, 12288
    s_add_u32 s60, s68, 1081344
    buffer_load_dwordx4 v20, s[40:43], s60 offen lds
    buffer_load_dwordx4 v21, s[40:43], s60 offen offset:1024 lds
    v_mfma_f32_32x32x16_bf16 v[96:111], v[48:51], v[148:151], v[96:111]
    v_mfma_f32_32x32x16_bf16 v[112:127], v[52:55], v[148:151], v[112:127]
    s_mov_b32 s87, 151552
    buffer_load_dwordx2 v[4:5], v24, s[32:35], s87 offen sc1
    s_add_u32 s62, s3, 94208
    buffer_load_dwordx4 v[144:147], v22, s[32:35], s62 offen offset:0 sc1
    buffer_load_dwordx4 v[148:151], v17, s[32:35], s62 offen offset:0 sc1
    s_waitcnt vmcnt(13) lgkmcnt(4)
    v_mfma_f32_32x32x16_bf16 v[64:79], v[56:59], v[152:155], v[64:79]
    ds_read_b64_tr_b16 v[40:41], v8 offset:2048
    ds_read_b64_tr_b16 v[42:43], v8 offset:3072
    ds_read_b64_tr_b16 v[44:45], v9 offset:2048
    ds_read_b64_tr_b16 v[46:47], v9 offset:3072
    v_mfma_f32_32x32x16_bf16 v[80:95], v[60:63], v[152:155], v[80:95]
    s_add_u32 m0, s71, 14336
    s_add_u32 s60, s68, 1097728
    buffer_load_dwordx4 v20, s[40:43], s60 offen lds
    buffer_load_dwordx4 v21, s[40:43], s60 offen offset:1024 lds
    v_mfma_f32_32x32x16_bf16 v[96:111], v[56:59], v[156:159], v[96:111]
    v_mfma_f32_32x32x16_bf16 v[112:127], v[60:63], v[156:159], v[112:127]
    buffer_load_dwordx4 v[152:155], v22, s[32:35], s62 offen offset:1024 sc1
    buffer_load_dwordx4 v[156:159], v17, s[32:35], s62 offen offset:1024 sc1
    s_waitcnt vmcnt(13) lgkmcnt(4)
    v_mfma_f32_32x32x16_bf16 v[64:79], v[32:35], v[128:131], v[64:79]
    ds_read_b64_tr_b16 v[48:49], v8 offset:4096
    ds_read_b64_tr_b16 v[50:51], v8 offset:5120
    ds_read_b64_tr_b16 v[52:53], v9 offset:4096
    ds_read_b64_tr_b16 v[54:55], v9 offset:5120
    v_mfma_f32_32x32x16_bf16 v[80:95], v[36:39], v[128:131], v[80:95]
    s_add_u32 m0, s71, 0
    s_add_u32 s60, s68, 1310720
    buffer_load_dwordx4 v20, s[40:43], s60 offen lds
    buffer_load_dwordx4 v21, s[40:43], s60 offen offset:1024 lds
    v_mfma_f32_32x32x16_bf16 v[96:111], v[32:35], v[132:135], v[96:111]
    v_mfma_f32_32x32x16_bf16 v[112:127], v[36:39], v[132:135], v[112:127]
    s_setprio 2
    s_waitcnt vmcnt(8)
    v_cmp_eq_u32 vcc, s72, v4
    v_cmp_eq_u32 s[78:79], s73, v5
    s_and_b64 vcc, vcc, s[78:79]
    s_cmp_eq_u64 vcc, -1
    s_cbranch_scc1 L_fh_58
    s_mov_b32 s87, 151552
L_pf_59:
    buffer_load_dwordx2 v[4:5], v24, s[32:35], s87 offen sc1
    s_waitcnt vmcnt(0)
    v_cmp_eq_u32 vcc, s72, v4
    v_cmp_eq_u32 s[78:79], s73, v5
    s_and_b64 vcc, vcc, s[78:79]
    s_cmp_eq_u64 vcc, -1
    s_cbranch_scc1 L_pfd_60
    s_sub_u32 s70, s70, 1
    s_cbranch_scc1 L_pfd_60_x
    s_sleep 2
    s_branch L_pf_59
L_pfd_60_x:
    s_mov_b32 s70, 0
L_pfd_60:
L_fh_58:
    s_setprio 0
    s_add_u32 s62, s98, 4096
    buffer_load_dwordx4 v[128:131], v22, s[32:35], s62 offen offset:0 sc1
    buffer_load_dwordx4 v[132:135], v17, s[32:35], s62 offen offset:0 sc1
    s_waitcnt lgkmcnt(4)
    v_mfma_f32_32x32x16_bf16 v[64:79], v[40:43], v[136:139], v[64:79]
    ds_read_b64_tr_b16 v[56:57], v8 offset:6144
    ds_read_b64_tr_b16 v[58:59], v8 offset:7168
    ds_read_b64_tr_b16 v[60:61], v9 offset:6144
    ds_read_b64_tr_b16 v[62:63], v9 offset:7168
    v_mfma_f32_32x32x16_bf16 v[80:95], v[44:47], v[136:139], v[80:95]
    s_add_u32 m0, s71, 2048
    s_add_u32 s60, s68, 1327104
    buffer_load_dwordx4 v20, s[40:43], s60 offen lds
    buffer_load_dwordx4 v21, s[40:43], s60 offen offset:1024 lds
    v_mfma_f32_32x32x16_bf16 v[96:111], v[40:43], v[140:143], v[96:111]
    v_mfma_f32_32x32x16_bf16 v[112:127], v[44:47], v[140:143], v[112:127]
    buffer_load_dwordx4 v[136:139], v22, s[32:35], s62 offen offset:1024 sc1
    buffer_load_dwordx4 v[140:143], v17, s[32:35], s62 offen offset:1024 sc1
    s_waitcnt vmcnt(12) lgkmcnt(4)
    v_mfma_f32_32x32x16_bf16 v[64:79], v[48:51], v[144:147], v[64:79]
    ds_read_b64_tr_b16 v[32:33], v8 offset:8192
    ds_read_b64_tr_b16 v[34:35], v8 offset:9216
    ds_read_b64_tr_b16 v[36:37], v9 offset:8192
    ds_read_b64_tr_b16 v[38:39], v9 offset:9216
    v_mfma_f32_32x32x16_bf16 v[80:95], v[52:55], v[144:147], v[80:95]
    s_add_u32 m0, s71, 4096
    s_add_u32 s60, s68, 1343488
    buffer_load_dwordx4 v20, s[40:43], s60 offen lds
    buffer_load_dwordx4 v21, s[40:43], s60 offen offset:1024 lds
    v_mfma_f32_32x32x16_bf16 v[96:111], v[48:51], v[148:151], v[96:111]
    v_mfma_f32_32x32x16_bf16 v[112:127], v[52:55], v[148:151], v[112:127]
    buffer_load_dwordx4 v[144:147], v22, s[32:35], s62 offen offset:2048 sc1
    buffer_load_dwordx4 v[148:151], v17, s[32:35], s62 offen offset:2048 sc1
    s_waitcnt vmcnt(12) lgkmcnt(4)
    v_mfma_f32_32x32x16_bf16 v[64:79], v[56:59], v[152:155], v[64:79]
    ds_read_b64_tr_b16 v[40:41], v8 offset:10240
    ds_read_b64_tr_b16 v[42:43], v8 offset:11264
    ds_read_b64_tr_b16 v[44:45], v9 offset:10240
    ds_read_b64_tr_b16 v[46:47], v9 offset:11264
    v_mfma_f32_32x32x16_bf16 v[80:95], v[60:63], v[152:155], v[80:95]
    s_add_u32 m0, s71, 6144
    s_add_u32 s60, s68, 1359872
    buffer_load_dwordx4 v20, s[40:43], s60 offen lds
    buffer_load_dwordx4 v21, s[40:43], s60 offen offset:1024 lds
    v_mfma_f32_32x32x16_bf16 v[96:111], v[56:59], v[156:159], v[96:111]
    v_mfma_f32_32x32x16_bf16 v[112:127], v[60:63], v[156:159], v[112:127]
    buffer_load_dwordx4 v[152:155], v22, s[32:35], s62 offen offset:3072 sc1
    buffer_load_dwordx4 v[156:159], v17, s[32:35], s62 offen offset:3072 sc1
    s_waitcnt vmcnt(12) lgkmcnt(4)
    v_mfma_f32_32x32x16_bf16 v[64:79], v[32:35], v[128:131], v[64:79]
    ds_read_b64_tr_b16 v[48:49], v8 offset:12288
    ds_read_b64_tr_b16 v[50:51], v8 offset:13312
    ds_read_b64_tr_b16 v[52:53], v9 offset:12288
    ds_read_b64_tr_b16 v[54:55], v9 offset:13312
    v_mfma_f32_32x32x16_bf16 v[80:95], v[36:39], v[128:131], v[80:95]
    s_add_u32 m0, s71, 8192
    s_add_u32 s60, s75, 0
    buffer_load_dwordx4 v20, s[44:47], s60 offen lds
    buffer_load_dwordx4 v21, s[44:47], s60 offen offset:1024 lds
    v_mfma_f32_32x32x16_bf16 v[96:111], v[32:35], v[132:135], v[96:111]
    v_mfma_f32_32x32x16_bf16 v[112:127], v[36:39], v[132:135], v[112:127]
    s_add_u32 s62, s98, 36864
    buffer_load_dwordx4 v[128:131], v22, s[32:35], s62 offen offset:0 sc1
    buffer_load_dwordx4 v[132:135], v17, s[32:35], s62 offen offset:0 sc1
    s_waitcnt vmcnt(12) lgkmcnt(4)
    v_mfma_f32_32x32x16_bf16 v[64:79], v[40:43], v[136:139], v[64:79]
    ds_read_b64_tr_b16 v[56:57], v8 offset:14336
    ds_read_b64_tr_b16 v[58:59], v8 offset:15360
    ds_read_b64_tr_b16 v[60:61], v9 offset:14336
    ds_read_b64_tr_b16 v[62:63], v9 offset:15360
    v_mfma_f32_32x32x16_bf16 v[80:95], v[44:47], v[136:139], v[80:95]
    s_add_u32 m0, s71, 10240
    s_add_u32 s60, s75, 16384
    buffer_load_dwordx4 v20, s[44:47], s60 offen lds
    buffer_load_dwordx4 v21, s[44:47], s60 offen offset:1024 lds
    v_mfma_f32_32x32x16_bf16 v[96:111], v[40:43], v[140:143], v[96:111]
    v_mfma_f32_32x32x16_bf16 v[112:127], v[44:47], v[140:143], v[112:127]
    buffer_load_dwordx4 v[136:139], v22, s[32:35], s62 offen offset:1024 sc1
    buffer_load_dwordx4 v[140:143], v17, s[32:35], s62 offen offset:1024 sc1
    s_waitcnt vmcnt(12) lgkmcnt(4)
    v_mfma_f32_32x32x16_bf16 v[64:79], v[48:51], v[144:147], v[64:79]
    ds_read_b64_tr_b16 v[32:33], v8 offset:0
    ds_read_b64_tr_b16 v[34:35], v8 offset:1024
    ds_read_b64_tr_b16 v[36:37], v9 offset:0
    ds_read_b64_tr_b16 v[38:39], v9 offset:1024
    v_mfma_f32_32x32x16_bf16 v[80:95], v[52:55], v[144:147], v[80:95]
    s_add_u32 m0, s71, 12288
    s_add_u32 s60, s75, 131072
    buffer_load_dwordx4 v20, s[44:47], s60 offen lds
    buffer_load_dwordx4 v21, s[44:47], s60 offen offset:1024 lds
    v_mfma_f32_32x32x16_bf16 v[96:111], v[48:51], v[148:151], v[96:111]
    v_mfma_f32_32x32x16_bf16 v[112:127], v[52:55], v[148:151], v[112:127]
    buffer_load_dwordx4 v[144:147], v22, s[32:35], s62 offen offset:2048 sc1
    buffer_load_dwordx4 v[148:151], v17, s[32:35], s62 offen offset:2048 sc1
    s_waitcnt vmcnt(12) lgkmcnt(4)
    v_mfma_f32_32x32x16_bf16 v[64:79], v[56:59], v[152:155], v[64:79]
    ds_read_b64_tr_b16 v[40:41], v8 offset:2048
    ds_read_b64_tr_b16 v[42:43], v8 offset:3072
    ds_read_b64_tr_b16 v[44:45], v9 offset:2048
    ds_read_b64_tr_b16 v[46:47], v9 offset:3072
    v_mfma_f32_32x32x16_bf16 v[80:95], v[60:63], v[152:155], v[80:95]
    s_add_u32 m0, s71, 14336
    s_add_u32 s60, s75, 147456
    buffer_load_dwordx4 v20, s[44:47], s60 offen lds
    buffer_load_dwordx4 v21, s[44:47], s60 offen offset:1024 lds
    v_mfma_f32_32x32x16_bf16 v[96:111], v[56:59], v[156:159], v[96:111]
    v_mfma_f32_32x32x16_bf16 v[112:127], v[60:63], v[156:159], v[112:127]
    buffer_load_dwordx4 v[152:155], v22, s[32:35], s62 offen offset:3072 sc1
    buffer_load_dwordx4 v[156:159], v17, s[32:35], s62 offen offset:3072 sc1
    s_waitcnt vmcnt(12) lgkmcnt(4)
    v_mfma_f32_32x32x16_bf16 v[64:79], v[32:35], v[128:131], v[64:79]
    ds_read_b64_tr_b16 v[48:49], v8 offset:4096
    ds_read_b64_tr_b16 v[50:51], v8 offset:5120
    ds_read_b64_tr_b16 v[52:53], v9 offset:4096
    ds_read_b64_tr_b16 v[54:55], v9 offset:5120
    v_mfma_f32_32x32x16_bf16 v[80:95], v[36:39], v[128:131], v[80:95]
    s_add_u32 m0, s71, 0
    s_add_u32 s60, s75, 262144
    buffer_load_dwordx4 v20, s[44:47], s60 offen lds
    buffer_load_dwordx4 v21, s[44:47], s60 offen offset:1024 lds
    v_mfma_f32_32x32x16_bf16 v[96:111], v[32:35], v[132:135], v[96:111]
    v_mfma_f32_32x32x16_bf16 v[112:127], v[36:39], v[132:135], v[112:127]
    s_waitcnt vmcnt(10) lgkmcnt(4)
    v_mfma_f32_32x32x16_bf16 v[64:79], v[40:43], v[136:139], v[64:79]
    ds_read_b64_tr_b16 v[56:57], v8 offset:6144
    ds_read_b64_tr_b16 v[58:59], v8 offset:7168
    ds_read_b64_tr_b16 v[60:61], v9 offset:6144
    ds_read_b64_tr_b16 v[62:63], v9 offset:7168
    v_mfma_f32_32x32x16_bf16 v[80:95], v[44:47], v[136:139], v[80:95]
    s_add_u32 m0, s71, 2048
    s_add_u32 s60, s75, 278528
    buffer_load_dwordx4 v20, s[44:47], s60 offen lds
    buffer_load_dwordx4 v21, s[44:47], s60 offen offset:1024 lds
    v_mfma_f32_32x32x16_bf16 v[96:111], v[40:43], v[140:143], v[96:111]
    v_mfma_f32_32x32x16_bf16 v[112:127], v[44:47], v[140:143], v[112:127]
    s_waitcnt vmcnt(8) lgkmcnt(4)
    v_mfma_f32_32x32x16_bf16 v[64:79], v[48:51], v[144:147], v[64:79]
    v_mfma_f32_32x32x16_bf16 v[80:95], v[52:55], v[144:147], v[80:95]
    s_add_u32 m0, s71, 4096
    s_add_u32 s60, s75, 393216
    buffer_load_dwordx4 v20, s[44:47], s60 offen lds
    buffer_load_dwordx4 v21, s[44:47], s60 offen offset:1024 lds
    v_mfma_f32_32x32x16_bf16 v[96:111], v[48:51], v[148:151], v[96:111]
    v_mfma_f32_32x32x16_bf16 v[112:127], v[52:55], v[148:151], v[112:127]
    s_waitcnt vmcnt(6) lgkmcnt(0)
    ds_read_b32 v13, v30 offset:48
    v_mfma_f32_32x32x16_bf16 v[64:79], v[56:59], v[152:155], v[64:79]
    v_mfma_f32_32x32x16_bf16 v[80:95], v[60:63], v[152:155], v[80:95]
    s_add_u32 m0, s71, 6144
    s_add_u32 s60, s75, 409600
    buffer_load_dwordx4 v20, s[44:47], s60 offen lds
    buffer_load_dwordx4 v21, s[44:47], s60 offen offset:1024 lds
    v_mfma_f32_32x32x16_bf16 v[96:111], v[56:59], v[156:159], v[96:111]
    v_mfma_f32_32x32x16_bf16 v[112:127], v[60:63], v[156:159], v[112:127]
    s_add_u32 s76, s77, 8192
    s_add_u32 s74, s77, 16384
    s_add_u32 s75, s77, 24576
    s_setprio 2
    s_waitcnt vmcnt(0) lgkmcnt(0)
    v_cmp_le_u32 vcc, 4, v13
    s_cbranch_vccz L_G_olate
    buffer_load_dwordx4 v[192:195], v23, s[32:35], s77 offen offset:0 sc1
    buffer_load_dwordx4 v[196:199], v18, s[32:35], s77 offen offset:0 sc1
    buffer_load_dwordx4 v[200:203], v23, s[32:35], s77 offen offset:1024 sc1
    buffer_load_dwordx4 v[204:207], v18, s[32:35], s77 offen offset:1024 sc1
    buffer_load_dwordx4 v[208:211], v23, s[32:35], s76 offen offset:0 sc1
    buffer_load_dwordx4 v[212:215], v18, s[32:35], s76 offen offset:0 sc1
    buffer_load_dwordx4 v[216:219], v23, s[32:35], s76 offen offset:1024 sc1
    buffer_load_dwordx4 v[220:223], v18, s[32:35], s76 offen offset:1024 sc1
    buffer_load_dwordx4 v[224:227], v23, s[32:35], s74 offen offset:0 sc1
    buffer_load_dwordx4 v[228:231], v18, s[32:35], s74 offen offset:0 sc1
    buffer_load_dwordx4 v[232:235], v23, s[32:35], s74 offen offset:1024 sc1
    buffer_load_dwordx4 v[236:239], v18, s[32:35], s74 offen offset:1024 sc1
    buffer_load_dwordx4 v[240:243], v23, s[32:35], s75 offen offset:0 sc1
    buffer_load_dwordx4 v[244:247], v18, s[32:35], s75 offen offset:0 sc1
    buffer_load_dwordx4 v[248:251], v23, s[32:35], s75 offen offset:1024 sc1
    buffer_load_dwordx4 v[252:255], v18, s[32:35], s75 offen offset:1024 sc1
L_G_olate:
    s_mov_b32 s61, vcc_lo
    ds_read_b64_tr_b16 v[128:129], v8 offset:8192
    ds_read_b64_tr_b16 v[130:131], v8 offset:9216
    ds_read_b64_tr_b16 v[132:133], v9 offset:8192
    ds_read_b64_tr_b16 v[134:135], v9 offset:9216
    ds_read_b64_tr_b16 v[136:137], v8 offset:10240
    ds_read_b64_tr_b16 v[138:139], v8 offset:11264
    ds_read_b64_tr_b16 v[140:141], v9 offset:10240
    ds_read_b64_tr_b16 v[142:143], v9 offset:11264
    ds_read_b64_tr_b16 v[144:145], v8 offset:12288
    ds_read_b64_tr_b16 v[146:147], v8 offset:13312
    ds_read_b64_tr_b16 v[148:149], v9 offset:12288
    ds_read_b64_tr_b16 v[150:151], v9 offset:13312
    ds_read_b64_tr_b16 v[152:153], v8 offset:14336
    ds_read_b64_tr_b16 v[154:155], v8 offset:15360
    ds_read_b64_tr_b16 v[156:157], v9 offset:14336
    ds_read_b64_tr_b16 v[158:159], v9 offset:15360
    ds_read_b64_tr_b16 v[160:161], v8 offset:0
    ds_read_b64_tr_b16 v[162:163], v8 offset:1024
    ds_read_b64_tr_b16 v[164:165], v9 offset:0
    ds_read_b64_tr_b16 v[166:167], v9 offset:1024
    ds_read_b64_tr_b16 v[168:169], v8 offset:2048
    ds_read_b64_tr_b16 v[170:171], v8 offset:3072
    ds_read_b64_tr_b16 v[172:173], v9 offset:2048
    ds_read_b64_tr_b16 v[174:175], v9 offset:3072
    ds_read_b64_tr_b16 v[176:177], v8 offset:4096
    ds_read_b64_tr_b16 v[178:179], v8 offset:5120
    ds_read_b64_tr_b16 v[180:181], v9 offset:4096
    ds_read_b64_tr_b16 v[182:183], v9 offset:5120
    ds_read_b64_tr_b16 v[184:185], v8 offset:6144
    ds_read_b64_tr_b16 v[186:187], v8 offset:7168
    ds_read_b64_tr_b16 v[188:189], v9 offset:6144
    ds_read_b64_tr_b16 v[190:191], v9 offset:7168
    ds_add_u32 v28, v29
    s_cmp_lg_u32 s61, 0
    s_cbranch_scc1 L_G_oreq
L_pl_61:
    ds_read_b32 v13, v30 offset:48
    s_waitcnt lgkmcnt(0)
    v_cmp_le_u32 vcc, 4, v13
    s_cbranch_vccnz L_pld_62
    s_sub_u32 s70, s70, 1
    s_cbranch_scc1 L_pld_62_x
    s_sleep 1
    s_branch L_pl_61
L_pld_62_x:
    s_mov_b32 s70, 0
L_pld_62:
    buffer_load_dwordx4 v[192:195], v23, s[32:35], s77 offen offset:0 sc1
    buffer_load_dwordx4 v[196:199], v18, s[32:35], s77 offen offset:0 sc1
    buffer_load_dwordx4 v[200:203], v23, s[32:35], s77 offen offset:1024 sc1
    buffer_load_dwordx4 v[204:207], v18, s[32:35], s77 offen offset:1024 sc1
    buffer_load_dwordx4 v[208:211], v23, s[32:35], s76 offen offset:0 sc1
    buffer_load_dwordx4 v[212:215], v18, s[32:35], s76 offen offset:0 sc1
    buffer_load_dwordx4 v[216:219], v23, s[32:35], s76 offen offset:1024 sc1
    buffer_load_dwordx4 v[220:223], v18, s[32:35], s76 offen offset:1024 sc1
    buffer_load_dwordx4 v[224:227], v23, s[32:35], s74 offen offset:0 sc1
    buffer_load_dwordx4 v[228:231], v18, s[32:35], s74 offen offset:0 sc1
    buffer_load_dwordx4 v[232:235], v23, s[32:35], s74 offen offset:1024 sc1
    buffer_load_dwordx4 v[236:239], v18, s[32:35], s74 offen offset:1024 sc1
    buffer_load_dwordx4 v[240:243], v23, s[32:35], s75 offen offset:0 sc1
    buffer_load_dwordx4 v[244:247], v18, s[32:35], s75 offen offset:0 sc1
    buffer_load_dwordx4 v[248:251], v23, s[32:35], s75 offen offset:1024 sc1
    buffer_load_dwordx4 v[252:255], v18, s[32:35], s75 offen offset:1024 sc1
L_G_oreq:
    s_xor_b32 s60, s57, 1
    s_mul_i32 s60, s60, 12288
    s_add_u32 s60, s60, 69632
    v_add_u32 v2, s60, v12
    s_xor_b32 s60, s57, 2
    s_mul_i32 s60, s60, 12288
    s_add_u32 s60, s60, 73728
    v_add_u32 v3, s60, v12
    s_xor_b32 s60, s57, 3
    s_mul_i32 s60, s60, 12288
    s_add_u32 s60, s60, 77824
    v_add_u32 v4, s60, v12
    s_mul_i32 s60, s57, 12288
    s_add_u32 s60, s60, 69632
    v_add_u32 v5, s60, v12
    s_waitcnt lgkmcnt(0)
    s_waitcnt vmcnt(12)
    v_max3_u32 v6, v192, v193, v194
    v_max3_u32 v7, v195, v196, v197
    v_max3_u32 v6, v198, v199, v6
    v_max3_u32 v7, v200, v201, v7
    v_max3_u32 v6, v202, v203, v6
    v_max3_u32 v7, v204, v205, v7
    v_max3_u32 v6, v206, v207, v6
    v_max_u32 v6, v6, v7
    v_cmp_eq_u32 vcc, -1, v6
    s_cbranch_vccz L_op_63_x
    s_waitcnt vmcnt(0)
L_op_63_l:
    s_sub_u32 s70, s70, 1
    s_cbranch_scc0 L_op_63_g
    s_mov_b32 s70, 0
    s_branch L_op_63_d
L_op_63_g:
    s_sleep 1
    buffer_load_dwordx4 v[192:195], v23, s[32:35], s77 offen offset:0 sc1
    buffer_load_dwordx4 v[196:199], v18, s[32:35], s77 offen offset:0 sc1
    buffer_load_dwordx4 v[200:203], v23, s[32:35], s77 offen offset:1024 sc1
    buffer_load_dwordx4 v[204:207], v18, s[32:35], s77 offen offset:1024 sc1
    buffer_load_dwordx4 v[208:211], v23, s[32:35], s76 offen offset:0 sc1
    buffer_load_dwordx4 v[212:215], v18, s[32:35], s76 offen offset:0 sc1
    buffer_load_dwordx4 v[216:219], v23, s[32:35], s76 offen offset:1024 sc1
    buffer_load_dwordx4 v[220:223], v18, s[32:35], s76 offen offset:1024 sc1
    s_waitcnt vmcnt(4)
    v_max3_u32 v6, v192, v193, v194
    v_max3_u32 v7, v195, v196, v197
    v_max3_u32 v6, v198, v199, v6
    v_max3_u32 v7, v200, v201, v7
    v_max3_u32 v6, v202, v203, v6
    v_max3_u32 v7, v204, v205, v7
    v_max3_u32 v6, v206, v207, v6
    v_max_u32 v6, v6, v7
    v_cmp_eq_u32 vcc, -1, v6
    s_cbranch_vccz L_op_63_e
    s_waitcnt vmcnt(0)
    s_branch L_op_63_l
L_op_63_d:
    s_waitcnt vmcnt(0)
    buffer_load_dwordx4 v[208:211], v23, s[32:35], s76 offen offset:0 sc1
    buffer_load_dwordx4 v[212:215], v18, s[32:35], s76 offen offset:0 sc1
    buffer_load_dwordx4 v[216:219], v23, s[32:35], s76 offen offset:1024 sc1
    buffer_load_dwordx4 v[220:223], v18, s[32:35], s76 offen offset:1024 sc1
L_op_63_e:
    buffer_load_dwordx4 v[224:227], v23, s[32:35], s74 offen offset:0 sc1
    buffer_load_dwordx4 v[228:231], v18, s[32:35], s74 offen offset:0 sc1
    buffer_load_dwordx4 v[232:235], v23, s[32:35], s74 offen offset:1024 sc1
    buffer_load_dwordx4 v[236:239], v18, s[32:35], s74 offen offset:1024 sc1
    buffer_load_dwordx4 v[240:243], v23, s[32:35], s75 offen offset:0 sc1
    buffer_load_dwordx4 v[244:247], v18, s[32:35], s75 offen offset:0 sc1
    buffer_load_dwordx4 v[248:251], v23, s[32:35], s75 offen offset:1024 sc1
    buffer_load_dwordx4 v[252:255], v18, s[32:35], s75 offen offset:1024 sc1
L_op_63_x:
    v_mfma_f32_32x32x16_bf16 v[64:79], v[128:131], v[192:195], v[64:79]
    v_mfma_f32_32x32x16_bf16 v[80:95], v[132:135], v[192:195], v[80:95]
    v_mfma_f32_32x32x16_bf16 v[96:111], v[128:131], v[196:199], v[96:111]
    v_mfma_f32_32x32x16_bf16 v[112:127], v[132:135], v[196:199], v[112:127]
    v_mfma_f32_32x32x16_bf16 v[64:79], v[136:139], v[200:203], v[64:79]
    v_mfma_f32_32x32x16_bf16 v[80:95], v[140:143], v[200:203], v[80:95]
    v_mfma_f32_32x32x16_bf16 v[96:111], v[136:139], v[204:207], v[96:111]
    v_mfma_f32_32x32x16_bf16 v[112:127], v[140:143], v[204:207], v[112:127]
    s_waitcnt vmcnt(8)
    v_max3_u32 v6, v208, v209, v210
    v_max3_u32 v7, v211, v212, v213
    v_max3_u32 v6, v214, v215, v6
    v_max3_u32 v7, v216, v217, v7
    v_max3_u32 v6, v218, v219, v6
    v_max3_u32 v7, v220, v221, v7
    v_max3_u32 v6, v222, v223, v6
    v_max_u32 v6, v6, v7
    v_cmp_eq_u32 vcc, -1, v6
    s_cbranch_vccz L_op_64_x
    s_waitcnt vmcnt(0)
L_op_64_l:
    s_sub_u32 s70, s70, 1
    s_cbranch_scc0 L_op_64_g
    s_mov_b32 s70, 0
    s_branch L_op_64_d
L_op_64_g:
    s_sleep 1
    buffer_load_dwordx4 v[208:211], v23, s[32:35], s76 offen offset:0 sc1
    buffer_load_dwordx4 v[212:215], v18, s[32:35], s76 offen offset:0 sc1
    buffer_load_dwordx4 v[216:219], v23, s[32:35], s76 offen offset:1024 sc1
    buffer_load_dwordx4 v[220:223], v18, s[32:35], s76 offen offset:1024 sc1
    buffer_load_dwordx4 v[224:227], v23, s[32:35], s74 offen offset:0 sc1
    buffer_load_dwordx4 v[228:231], v18, s[32:35], s74 offen offset:0 sc1
    buffer_load_dwordx4 v[232:235], v23, s[32:35], s74 offen offset:1024 sc1
    buffer_load_dwordx4 v[236:239], v18, s[32:35], s74 offen offset:1024 sc1
    s_waitcnt vmcnt(4)
    v_max3_u32 v6, v208, v209, v210
    v_max3_u32 v7, v211, v212, v213
    v_max3_u32 v6, v214, v215, v6
    v_max3_u32 v7, v216, v217, v7
    v_max3_u32 v6, v218, v219, v6
    v_max3_u32 v7, v220, v221, v7
    v_max3_u32 v6, v222, v223, v6
    v_max_u32 v6, v6, v7
    v_cmp_eq_u32 vcc, -1, v6
    s_cbranch_vccz L_op_64_e
    s_waitcnt vmcnt(0)
    s_branch L_op_64_l
L_op_64_d:
    s_waitcnt vmcnt(0)
    buffer_load_dwordx4 v[224:227], v23, s[32:35], s74 offen offset:0 sc1
    buffer_load_dwordx4 v[228:231], v18, s[32:35], s74 offen offset:0 sc1
    buffer_load_dwordx4 v[232:235], v23, s[32:35], s74 offen offset:1024 sc1
    buffer_load_dwordx4 v[236:239], v18, s[32:35], s74 offen offset:1024 sc1
L_op_64_e:
    buffer_load_dwordx4 v[240:243], v23, s[32:35], s75 offen offset:0 sc1
    buffer_load_dwordx4 v[244:247], v18, s[32:35], s75 offen offset:0 sc1
    buffer_load_dwordx4 v[248:251], v23, s[32:35], s75 offen offset:1024 sc1
    buffer_load_dwordx4 v[252:255], v18, s[32:35], s75 offen offset:1024 sc1
L_op_64_x:
    v_mfma_f32_32x32x16_bf16 v[64:79], v[144:147], v[208:211], v[64:79]
    v_mfma_f32_32x32x16_bf16 v[80:95], v[148:151], v[208:211], v[80:95]
    v_mfma_f32_32x32x16_bf16 v[96:111], v[144:147], v[212:215], v[96:111]
    v_mfma_f32_32x32x16_bf16 v[112:127], v[148:151], v[212:215], v[112:127]
    v_mfma_f32_32x32x16_bf16 v[64:79], v[152:155], v[216:219], v[64:79]
    v_mfma_f32_32x32x16_bf16 v[80:95], v[156:159], v[216:219], v[80:95]
    v_mfma_f32_32x32x16_bf16 v[96:111], v[152:155], v[220:223], v[96:111]
    v_mfma_f32_32x32x16_bf16 v[112:127], v[156:159], v[220:223], v[112:127]
    s_waitcnt vmcnt(4)
    v_max3_u32 v6, v224, v225, v226
    v_max3_u32 v7, v227, v228, v229
    v_max3_u32 v6, v230, v231, v6
    v_max3_u32 v7, v232, v233, v7
    v_max3_u32 v6, v234, v235, v6
    v_max3_u32 v7, v236, v237, v7
    v_max3_u32 v6, v238, v239, v6
    v_max_u32 v6, v6, v7
    v_cmp_eq_u32 vcc, -1, v6
    s_cbranch_vccz L_op_65_x
    s_waitcnt vmcnt(0)
L_op_65_l:
    s_sub_u32 s70, s70, 1
    s_cbranch_scc0 L_op_65_g
    s_mov_b32 s70, 0
    s_branch L_op_65_d
L_op_65_g:
    s_sleep 1
    buffer_load_dwordx4 v[224:227], v23, s[32:35], s74 offen offset:0 sc1
    buffer_load_dwordx4 v[228:231], v18, s[32:35], s74 offen offset:0 sc1
    buffer_load_dwordx4 v[232:235], v23, s[32:35], s74 offen offset:1024 sc1
    buffer_load_dwordx4 v[236:239], v18, s[32:35], s74 offen offset:1024 sc1
    buffer_load_dwordx4 v[240:243], v23, s[32:35], s75 offen offset:0 sc1
    buffer_load_dwordx4 v[244:247], v18, s[32:35], s75 offen offset:0 sc1
    buffer_load_dwordx4 v[248:251], v23, s[32:35], s75 offen offset:1024 sc1
    buffer_load_dwordx4 v[252:255], v18, s[32:35], s75 offen offset:1024 sc1
    s_waitcnt vmcnt(4)
    v_max3_u32 v6, v224, v225, v226
    v_max3_u32 v7, v227, v228, v229
    v_max3_u32 v6, v230, v231, v6
    v_max3_u32 v7, v232, v233, v7
    v_max3_u32 v6, v234, v235, v6
    v_max3_u32 v7, v236, v237, v7
    v_max3_u32 v6, v238, v239, v6
    v_max_u32 v6, v6, v7
    v_cmp_eq_u32 vcc, -1, v6
    s_cbranch_vccz L_op_65_e
    s_waitcnt vmcnt(0)
    s_branch L_op_65_l
L_op_65_d:
    s_waitcnt vmcnt(0)
    buffer_load_dwordx4 v[240:243], v23, s[32:35], s75 offen offset:0 sc1
    buffer_load_dwordx4 v[244:247], v18, s[32:35], s75 offen offset:0 sc1
    buffer_load_dwordx4 v[248:251], v23, s[32:35], s75 offen offset:1024 sc1
    buffer_load_dwordx4 v[252:255], v18, s[32:35], s75 offen offset:1024 sc1
L_op_65_e:
L_op_65_x:
    v_mfma_f32_32x32x16_bf16 v[64:79], v[160:163], v[224:227], v[64:79]
    v_mfma_f32_32x32x16_bf16 v[80:95], v[164:167], v[224:227], v[80:95]
    v_mfma_f32_32x32x16_bf16 v[96:111], v[160:163], v[228:231], v[96:111]
    v_mfma_f32_32x32x16_bf16 v[112:127], v[164:167], v[228:231], v[112:127]
    v_mfma_f32_32x32x16_bf16 v[64:79], v[168:171], v[232:235], v[64:79]
    v_mfma_f32_32x32x16_bf16 v[80:95], v[172:175], v[232:235], v[80:95]
    v_mfma_f32_32x32x16_bf16 v[96:111], v[168:171], v[236:239], v[96:111]
    v_mfma_f32_32x32x16_bf16 v[112:127], v[172:175], v[236:239], v[112:127]
    s_waitcnt vmcnt(0)
    v_max3_u32 v6, v240, v241, v242
    v_max3_u32 v7, v243, v244, v245
    v_max3_u32 v6, v246, v247, v6
    v_max3_u32 v7, v248, v249, v7
    v_max3_u32 v6, v250, v251, v6
    v_max3_u32 v7, v252, v253, v7
    v_max3_u32 v6, v254, v255, v6
    v_max_u32 v6, v6, v7
    v_cmp_eq_u32 vcc, -1, v6
    s_cbranch_vccz L_op_66_x
    s_waitcnt vmcnt(0)
L_op_66_l:
    s_sub_u32 s70, s70, 1
    s_cbranch_scc0 L_op_66_g
    s_mov_b32 s70, 0
    s_branch L_op_66_d
L_op_66_g:
    s_sleep 1
    buffer_load_dwordx4 v[240:243], v23, s[32:35], s75 offen offset:0 sc1
    buffer_load_dwordx4 v[244:247], v18, s[32:35], s75 offen offset:0 sc1
    buffer_load_dwordx4 v[248:251], v23, s[32:35], s75 offen offset:1024 sc1
    buffer_load_dwordx4 v[252:255], v18, s[32:35], s75 offen offset:1024 sc1
    s_waitcnt vmcnt(0)
    v_max3_u32 v6, v240, v241, v242
    v_max3_u32 v7, v243, v244, v245
    v_max3_u32 v6, v246, v247, v6
    v_max3_u32 v7, v248, v249, v7
    v_max3_u32 v6, v250, v251, v6
    v_max3_u32 v7, v252, v253, v7
    v_max3_u32 v6, v254, v255, v6
    v_max_u32 v6, v6, v7
    v_cmp_eq_u32 vcc, -1, v6
    s_cbranch_vccz L_op_66_e
    s_waitcnt vmcnt(0)
    s_branch L_op_66_l
L_op_66_d:
    s_waitcnt vmcnt(0)
L_op_66_e:
L_op_66_x:
    v_mfma_f32_32x32x16_bf16 v[64:79], v[176:179], v[240:243], v[64:79]
    v_mfma_f32_32x32x16_bf16 v[80:95], v[180:183], v[240:243], v[80:95]
    v_mfma_f32_32x32x16_bf16 v[96:111], v[176:179], v[244:247], v[96:111]
    v_mfma_f32_32x32x16_bf16 v[112:127], v[180:183], v[244:247], v[112:127]
    v_mfma_f32_32x32x16_bf16 v[64:79], v[184:187], v[248:251], v[64:79]
    v_mfma_f32_32x32x16_bf16 v[80:95], v[188:191], v[248:251], v[80:95]
    v_mfma_f32_32x32x16_bf16 v[96:111], v[184:187], v[252:255], v[96:111]
    v_mfma_f32_32x32x16_bf16 v[112:127], v[188:191], v[252:255], v[112:127]
L_pl_67:
    ds_read_b32 v13, v30 offset:0
    s_waitcnt lgkmcnt(0)
    v_cmp_le_u32 vcc, 136, v13
    s_cbranch_vccnz L_pld_68
    s_sub_u32 s70, s70, 1
    s_cbranch_scc1 L_pld_68_x
    s_sleep 1
    s_branch L_pl_67
L_pld_68_x:
    s_mov_b32 s70, 0
L_pld_68:
    s_nop 5
    ds_write_b128 v2, v[80:83] offset:0
    ds_write_b128 v2, v[84:87] offset:1024
    ds_write_b128 v2, v[88:91] offset:2048
    ds_write_b128 v2, v[92:95] offset:3072
    ds_write_b128 v3, v[96:99] offset:0
    ds_write_b128 v3, v[100:103] offset:1024
    ds_write_b128 v3, v[104:107] offset:2048
    ds_write_b128 v3, v[108:111] offset:3072
    ds_write_b128 v4, v[112:115] offset:0
    ds_write_b128 v4, v[116:119] offset:1024
    ds_write_b128 v4, v[120:123] offset:2048
    ds_write_b128 v4, v[124:127] offset:3072
    s_waitcnt lgkmcnt(0)
    s_barrier
    ds_read_b128 v[128:131], v5 offset:0
    ds_read_b128 v[132:135], v5 offset:1024
    ds_read_b128 v[136:139], v5 offset:2048
    ds_read_b128 v[140:143], v5 offset:3072
    ds_read_b128 v[144:147], v5 offset:4096
    ds_read_b128 v[148:151], v5 offset:5120
    ds_read_b128 v[152:155], v5 offset:6144
    ds_read_b128 v[156:159], v5 offset:7168
    ds_read_b128 v[160:163], v5 offset:8192
    ds_read_b128 v[164:167], v5 offset:9216
    ds_read_b128 v[168:171], v5 offset:10240
    ds_read_b128 v[172:175], v5 offset:11264
    s_waitcnt lgkmcnt(8)
    v_pk_add_f32 v[64:65], v[64:65], v[128:129]
    v_pk_add_f32 v[66:67], v[66:67], v[130:131]
    v_pk_add_f32 v[68:69], v[68:69], v[132:133]
    v_pk_add_f32 v[70:71], v[70:71], v[134:135]
    v_pk_add_f32 v[72:73], v[72:73], v[136:137]
    v_pk_add_f32 v[74:75], v[74:75], v[138:139]
    v_pk_add_f32 v[76:77], v[76:77], v[140:141]
    v_pk_add_f32 v[78:79], v[78:79], v[142:143]
    s_waitcnt lgkmcnt(0)
    v_pk_add_f32 v[144:145], v[144:145], v[160:161]
    v_pk_add_f32 v[146:147], v[146:147], v[162:163]
    v_pk_add_f32 v[148:149], v[148:149], v[164:165]
    v_pk_add_f32 v[150:151], v[150:151], v[166:167]
    v_pk_add_f32 v[152:153], v[152:153], v[168:169]
    v_pk_add_f32 v[154:155], v[154:155], v[170:171]
    v_pk_add_f32 v[156:157], v[156:157], v[172:173]
    v_pk_add_f32 v[158:159], v[158:159], v[174:175]
    v_pk_add_f32 v[128:129], v[64:65], v[144:145]
    v_pk_add_f32 v[130:131], v[66:67], v[146:147]
    v_pk_add_f32 v[132:133], v[68:69], v[148:149]
    v_pk_add_f32 v[134:135], v[70:71], v[150:151]
    v_pk_add_f32 v[136:137], v[72:73], v[152:153]
    v_pk_add_f32 v[138:139], v[74:75], v[154:155]
    v_pk_add_f32 v[140:141], v[76:77], v[156:157]
    v_pk_add_f32 v[142:143], v[78:79], v[158:159]
    v_cvt_pk_bf16_f32 v64, v128, v129
    v_cvt_pk_bf16_f32 v65, v130, v131
    v_cvt_pk_bf16_f32 v66, v132, v133
    v_cvt_pk_bf16_f32 v67, v134, v135
    v_cvt_pk_bf16_f32 v68, v136, v137
    v_cvt_pk_bf16_f32 v69, v138, v139
    v_cvt_pk_bf16_f32 v70, v140, v141
    v_cvt_pk_bf16_f32 v71, v142, v143
    s_nop 1
    v_permlane32_swap_b32 v64, v66
    v_permlane32_swap_b32 v65, v67
    v_permlane32_swap_b32 v68, v70
    v_permlane32_swap_b32 v69, v71
    buffer_store_dwordx4 v[64:67], v16, s[48:51], s65 offen
    buffer_store_dwordx4 v[68:71], v16, s[48:51], s65 offen offset:32
    s_endpgm
L_gs_11:
L_pl_69:
    ds_read_b32 v13, v30 offset:0
    s_waitcnt lgkmcnt(0)
    v_cmp_le_u32 vcc, 8, v13
    s_cbranch_vccnz L_pld_70
    s_sub_u32 s70, s70, 1
    s_cbranch_scc1 L_pld_70_x
    s_sleep 1
    s_branch L_pl_69
L_pld_70_x:
    s_mov_b32 s70, 0
L_pld_70:
    s_branch L_gs_11_r
L_gs_14:
L_pl_71:
    ds_read_b32 v13, v30 offset:0
    s_waitcnt lgkmcnt(0)
    v_cmp_le_u32 vcc, 12, v13
    s_cbranch_vccnz L_pld_72
    s_sub_u32 s70, s70, 1
    s_cbranch_scc1 L_pld_72_x
    s_sleep 1
    s_branch L_pl_71
L_pld_72_x:
    s_mov_b32 s70, 0
L_pld_72:
    s_branch L_gs_14_r
L_gs_17:
L_pl_73:
    ds_read_b32 v13, v30 offset:0
    s_waitcnt lgkmcnt(0)
    v_cmp_le_u32 vcc, 16, v13
    s_cbranch_vccnz L_pld_74
    s_sub_u32 s70, s70, 1
    s_cbranch_scc1 L_pld_74_x
    s_sleep 1
    s_branch L_pl_73
L_pld_74_x:
    s_mov_b32 s70, 0
L_pld_74:
    s_branch L_gs_17_r
L_gs_18:
L_pl_75:
    ds_read_b32 v13, v30 offset:0
    s_waitcnt lgkmcnt(0)
    v_cmp_le_u32 vcc, 20, v13
    s_cbranch_vccnz L_pld_76
    s_sub_u32 s70, s70, 1
    s_cbranch_scc1 L_pld_76_x
    s_sleep 1
    s_branch L_pl_75
L_pld_76_x:
    s_mov_b32 s70, 0
L_pld_76:
    s_branch L_gs_18_r
L_gs_19:
L_pl_77:
    ds_read_b32 v13, v30 offset:0
    s_waitcnt lgkmcnt(0)
    v_cmp_le_u32 vcc, 24, v13
    s_cbranch_vccnz L_pld_78
    s_sub_u32 s70, s70, 1
    s_cbranch_scc1 L_pld_78_x
    s_sleep 1
    s_branch L_pl_77
L_pld_78_x:
    s_mov_b32 s70, 0
L_pld_78:
    s_branch L_gs_19_r
L_gs_20:
L_pl_79:
    ds_read_b32 v13, v30 offset:0
    s_waitcnt lgkmcnt(0)
    v_cmp_le_u32 vcc, 28, v13
    s_cbranch_vccnz L_pld_80
    s_sub_u32 s70, s70, 1
    s_cbranch_scc1 L_pld_80_x
    s_sleep 1
    s_branch L_pl_79
L_pld_80_x:
    s_mov_b32 s70, 0
L_pld_80:
    s_branch L_gs_20_r
L_gs_21:
L_pl_81:
    ds_read_b32 v13, v30 offset:0
    s_waitcnt lgkmcnt(0)
    v_cmp_le_u32 vcc, 32, v13
    s_cbranch_vccnz L_pld_82
    s_sub_u32 s70, s70, 1
    s_cbranch_scc1 L_pld_82_x
    s_sleep 1
    s_branch L_pl_81
L_pld_82_x:
    s_mov_b32 s70, 0
L_pld_82:
    s_branch L_gs_21_r
L_gs_22:
L_pl_83:
    ds_read_b32 v13, v30 offset:0
    s_waitcnt lgkmcnt(0)
    v_cmp_le_u32 vcc, 36, v13
    s_cbranch_vccnz L_pld_84
    s_sub_u32 s70, s70, 1
    s_cbranch_scc1 L_pld_84_x
    s_sleep 1
    s_branch L_pl_83
L_pld_84_x:
    s_mov_b32 s70, 0
L_pld_84:
    s_branch L_gs_22_r
L_gs_23:
L_pl_85:
    ds_read_b32 v13, v30 offset:0
    s_waitcnt lgkmcnt(0)
    v_cmp_le_u32 vcc, 40, v13
    s_cbranch_vccnz L_pld_86
    s_sub_u32 s70, s70, 1
    s_cbranch_scc1 L_pld_86_x
    s_sleep 1
    s_branch L_pl_85
L_pld_86_x:
    s_mov_b32 s70, 0
L_pld_86:
    s_branch L_gs_23_r
L_gs_24:
L_pl_87:
    ds_read_b32 v13, v30 offset:0
    s_waitcnt lgkmcnt(0)
    v_cmp_le_u32 vcc, 44, v13
    s_cbranch_vccnz L_pld_88
    s_sub_u32 s70, s70, 1
    s_cbranch_scc1 L_pld_88_x
    s_sleep 1
    s_branch L_pl_87
L_pld_88_x:
    s_mov_b32 s70, 0
L_pld_88:
    s_branch L_gs_24_r
L_gs_25:
L_pl_89:
    ds_read_b32 v13, v30 offset:0
    s_waitcnt lgkmcnt(0)
    v_cmp_le_u32 vcc, 48, v13
    s_cbranch_vccnz L_pld_90
    s_sub_u32 s70, s70, 1
    s_cbranch_scc1 L_pld_90_x
    s_sleep 1
    s_branch L_pl_89
L_pld_90_x:
    s_mov_b32 s70, 0
L_pld_90:
    s_branch L_gs_25_r
L_gs_26:
L_pl_91:
    ds_read_b32 v13, v30 offset:0
    s_waitcnt lgkmcnt(0)
    v_cmp_le_u32 vcc, 52, v13
    s_cbranch_vccnz L_pld_92
    s_sub_u32 s70, s70, 1
    s_cbranch_scc1 L_pld_92_x
    s_sleep 1
    s_branch L_pl_91
L_pld_92_x:
    s_mov_b32 s70, 0
L_pld_92:
    s_branch L_gs_26_r
L_gs_27:
L_pl_93:
    ds_read_b32 v13, v30 offset:0
    s_waitcnt lgkmcnt(0)
    v_cmp_le_u32 vcc, 56, v13
    s_cbranch_vccnz L_pld_94
    s_sub_u32 s70, s70, 1
    s_cbranch_scc1 L_pld_94_x
    s_sleep 1
    s_branch L_pl_93
L_pld_94_x:
    s_mov_b32 s70, 0
L_pld_94:
    s_branch L_gs_27_r
L_gs_28:
L_pl_95:
    ds_read_b32 v13, v30 offset:0
    s_waitcnt lgkmcnt(0)
    v_cmp_le_u32 vcc, 60, v13
    s_cbranch_vccnz L_pld_96
    s_sub_u32 s70, s70, 1
    s_cbranch_scc1 L_pld_96_x
    s_sleep 1
    s_branch L_pl_95
L_pld_96_x:
    s_mov_b32 s70, 0
L_pld_96:
    s_branch L_gs_28_r
L_gs_31:
L_pl_97:
    ds_read_b32 v13, v30 offset:0
    s_waitcnt lgkmcnt(0)
    v_cmp_le_u32 vcc, 64, v13
    s_cbranch_vccnz L_pld_98
    s_sub_u32 s70, s70, 1
    s_cbranch_scc1 L_pld_98_x
    s_sleep 1
    s_branch L_pl_97
L_pld_98_x:
    s_mov_b32 s70, 0
L_pld_98:
    s_branch L_gs_31_r
L_gs_32:
L_pl_99:
    ds_read_b32 v13, v30 offset:0
    s_waitcnt lgkmcnt(0)
    v_cmp_le_u32 vcc, 68, v13
    s_cbranch_vccnz L_pld_100
    s_sub_u32 s70, s70, 1
    s_cbranch_scc1 L_pld_100_x
    s_sleep 1
    s_branch L_pl_99
L_pld_100_x:
    s_mov_b32 s70, 0
L_pld_100:
    s_branch L_gs_32_r
L_gs_33:
L_pl_101:
    ds_read_b32 v13, v30 offset:0
    s_waitcnt lgkmcnt(0)
    v_cmp_le_u32 vcc, 72, v13
    s_cbranch_vccnz L_pld_102
    s_sub_u32 s70, s70, 1
    s_cbranch_scc1 L_pld_102_x
    s_sleep 1
    s_branch L_pl_101
L_pld_102_x:
    s_mov_b32 s70, 0
L_pld_102:
    s_branch L_gs_33_r
L_gs_34:
L_pl_103:
    ds_read_b32 v13, v30 offset:0
    s_waitcnt lgkmcnt(0)
    v_cmp_le_u32 vcc, 76, v13
    s_cbranch_vccnz L_pld_104
    s_sub_u32 s70, s70, 1
    s_cbranch_scc1 L_pld_104_x
    s_sleep 1
    s_branch L_pl_103
L_pld_104_x:
    s_mov_b32 s70, 0
L_pld_104:
    s_branch L_gs_34_r
L_gs_35:
L_pl_105:
    ds_read_b32 v13, v30 offset:0
    s_waitcnt lgkmcnt(0)
    v_cmp_le_u32 vcc, 80, v13
    s_cbranch_vccnz L_pld_106
    s_sub_u32 s70, s70, 1
    s_cbranch_scc1 L_pld_106_x
    s_sleep 1
    s_branch L_pl_105
L_pld_106_x:
    s_mov_b32 s70, 0
L_pld_106:
    s_branch L_gs_35_r
L_gs_36:
L_pl_107:
    ds_read_b32 v13, v30 offset:0
    s_waitcnt lgkmcnt(0)
    v_cmp_le_u32 vcc, 84, v13
    s_cbranch_vccnz L_pld_108
    s_sub_u32 s70, s70, 1
    s_cbranch_scc1 L_pld_108_x
    s_sleep 1
    s_branch L_pl_107
L_pld_108_x:
    s_mov_b32 s70, 0
L_pld_108:
    s_branch L_gs_36_r
L_gs_37:
L_pl_109:
    ds_read_b32 v13, v30 offset:0
    s_waitcnt lgkmcnt(0)
    v_cmp_le_u32 vcc, 88, v13
    s_cbranch_vccnz L_pld_110
    s_sub_u32 s70, s70, 1
    s_cbranch_scc1 L_pld_110_x
    s_sleep 1
    s_branch L_pl_109
L_pld_110_x:
    s_mov_b32 s70, 0
L_pld_110:
    s_branch L_gs_37_r
L_gs_38:
L_pl_111:
    ds_read_b32 v13, v30 offset:0
    s_waitcnt lgkmcnt(0)
    v_cmp_le_u32 vcc, 92, v13
    s_cbranch_vccnz L_pld_112
    s_sub_u32 s70, s70, 1
    s_cbranch_scc1 L_pld_112_x
    s_sleep 1
    s_branch L_pl_111
L_pld_112_x:
    s_mov_b32 s70, 0
L_pld_112:
    s_branch L_gs_38_r
L_gs_39:
L_pl_113:
    ds_read_b32 v13, v30 offset:0
    s_waitcnt lgkmcnt(0)
    v_cmp_le_u32 vcc, 96, v13
    s_cbranch_vccnz L_pld_114
    s_sub_u32 s70, s70, 1
    s_cbranch_scc1 L_pld_114_x
    s_sleep 1
    s_branch L_pl_113
L_pld_114_x:
    s_mov_b32 s70, 0
L_pld_114:
    s_branch L_gs_39_r
L_gs_40:
L_pl_115:
    ds_read_b32 v13, v30 offset:0
    s_waitcnt lgkmcnt(0)
    v_cmp_le_u32 vcc, 100, v13
    s_cbranch_vccnz L_pld_116
    s_sub_u32 s70, s70, 1
    s_cbranch_scc1 L_pld_116_x
    s_sleep 1
    s_branch L_pl_115
L_pld_116_x:
    s_mov_b32 s70, 0
L_pld_116:
    s_branch L_gs_40_r
L_gs_41:
L_pl_117:
    ds_read_b32 v13, v30 offset:0
    s_waitcnt lgkmcnt(0)
    v_cmp_le_u32 vcc, 104, v13
    s_cbranch_vccnz L_pld_118
    s_sub_u32 s70, s70, 1
    s_cbranch_scc1 L_pld_118_x
    s_sleep 1
    s_branch L_pl_117
L_pld_118_x:
    s_mov_b32 s70, 0
L_pld_118:
    s_branch L_gs_41_r
L_gs_42:
L_pl_119:
    ds_read_b32 v13, v30 offset:0
    s_waitcnt lgkmcnt(0)
    v_cmp_le_u32 vcc, 108, v13
    s_cbranch_vccnz L_pld_120
    s_sub_u32 s70, s70, 1
    s_cbranch_scc1 L_pld_120_x
    s_sleep 1
    s_branch L_pl_119
L_pld_120_x:
    s_mov_b32 s70, 0
L_pld_120:
    s_branch L_gs_42_r
L_gs_43:
L_pl_121:
    ds_read_b32 v13, v30 offset:0
    s_waitcnt lgkmcnt(0)
    v_cmp_le_u32 vcc, 112, v13
    s_cbranch_vccnz L_pld_122
    s_sub_u32 s70, s70, 1
    s_cbranch_scc1 L_pld_122_x
    s_sleep 1
    s_branch L_pl_121
L_pld_122_x:
    s_mov_b32 s70, 0
L_pld_122:
    s_branch L_gs_43_r
L_gs_44:
L_pl_123:
    ds_read_b32 v13, v30 offset:0
    s_waitcnt lgkmcnt(0)
    v_cmp_le_u32 vcc, 116, v13
    s_cbranch_vccnz L_pld_124
    s_sub_u32 s70, s70, 1
    s_cbranch_scc1 L_pld_124_x
    s_sleep 1
    s_branch L_pl_123
L_pld_124_x:
    s_mov_b32 s70, 0
L_pld_124:
    s_branch L_gs_44_r
L_gs_47:
L_pl_125:
    ds_read_b32 v13, v30 offset:0
    s_waitcnt lgkmcnt(0)
    v_cmp_le_u32 vcc, 120, v13
    s_cbranch_vccnz L_pld_126
    s_sub_u32 s70, s70, 1
    s_cbranch_scc1 L_pld_126_x
    s_sleep 1
    s_branch L_pl_125
L_pld_126_x:
    s_mov_b32 s70, 0
L_pld_126:
    s_branch L_gs_47_r
L_gs_48:
L_pl_127:
    ds_read_b32 v13, v30 offset:0
    s_waitcnt lgkmcnt(0)
    v_cmp_le_u32 vcc, 124, v13
    s_cbranch_vccnz L_pld_128
    s_sub_u32 s70, s70, 1
    s_cbranch_scc1 L_pld_128_x
    s_sleep 1
    s_branch L_pl_127
L_pld_128_x:
    s_mov_b32 s70, 0
L_pld_128:
    s_branch L_gs_48_r
L_gs_49:
L_pl_129:
    ds_read_b32 v13, v30 offset:0
    s_waitcnt lgkmcnt(0)
    v_cmp_le_u32 vcc, 128, v13
    s_cbranch_vccnz L_pld_130
    s_sub_u32 s70, s70, 1
    s_cbranch_scc1 L_pld_130_x
    s_sleep 1
    s_branch L_pl_129
L_pld_130_x:
    s_mov_b32 s70, 0
L_pld_130:
    s_branch L_gs_49_r
L_G_o:
    s_and_b32 s60, s2, 7
    s_lshr_b32 s61, s2, 3
    s_lshr_b32 s62, s60, 1
    s_lshl_b32 s62, s62, 2
    s_lshr_b32 s63, s61, 3
    s_or_b32 s58, s62, s63
    s_and_b32 s62, s60, 1
    s_lshl_b32 s62, s62, 3
    s_and_b32 s63, s61, 7
    s_or_b32 s59, s62, s63
    s_and_b32 s57, s56, 3
    s_lshl_b32 s80, s58, 4
    s_or_b32 s80, s80, s59
    s_mov_b32 s70, 100000
    s_mov_b32 s84, 0
    s_mov_b32 s85, -1
    s_mov_b32 s88, 0xffff
    s_mov_b32 s89, 0xffff
    s_add_u32 s90, s59, 0
    s_and_b32 s90, s90, 3
    s_add_u32 s91, s59, 1
    s_and_b32 s91, s91, 3
    s_add_u32 s92, s59, 2
    s_and_b32 s92, s92, 3
    s_add_u32 s93, s59, 3
    s_and_b32 s93, s93, 3
    s_waitcnt lgkmcnt(0)
    s_mov_b32 s28, s4
    s_and_b32 s29, s5, 0xffff
    s_mov_b32 s30, 0x200000
    s_mov_b32 s31, 0x20000
    s_mov_b32 s32, s26
    s_and_b32 s33, s27, 0xffff
    s_mov_b32 s34, 0xb00000
    s_mov_b32 s35, 0x20000
    s_and_b32 s60, s57, 1
    s_cmp_eq_u32 s60, 0
    s_cselect_b32 s62, s16, s18
    s_cselect_b32 s63, s17, s19
    s_mov_b32 s36, s62
    s_and_b32 s37, s63, 0xffff
    s_mov_b32 s38, 0x1c0000
    s_mov_b32 s39, 0x20000
    s_mov_b32 s40, s20
    s_and_b32 s41, s21, 0xffff
    s_mov_b32 s42, 0x1c0000
    s_mov_b32 s43, 0x20000
    s_mov_b32 s44, s12
    s_and_b32 s45, s13, 0xffff
    s_mov_b32 s46, 0x80000
    s_mov_b32 s47, 0x20000
    s_mov_b32 s48, s22
    s_and_b32 s49, s23, 0xffff
    s_mov_b32 s50, 0x200000
    s_mov_b32 s51, 0x20000
    v_lshrrev_b32 v6, 4, v0
    v_and_b32 v7, 15, v0
    v_xor_b32 v7, v7, v6
    v_lshlrev_b32 v7, 4, v7
    v_lshl_add_u32 v2, v6, 10, v7
    v_xor_b32 v3, 0x40, v2
    v_xor_b32 v4, 0x80, v2
    v_xor_b32 v5, 0xc0, v2
    s_lshl_b32 s60, s58, 2
    s_add_u32 s60, s60, s57
    s_lshl_b32 s76, s60, 15
    s_lshl_b32 s77, s57, 15
    s_lshl_b32 s52, s90, 8
    s_add_u32 s52, s52, s76
    s_lshl_b32 s53, s91, 8
    s_add_u32 s53, s53, s76
    s_lshl_b32 s54, s92, 8
    s_add_u32 s54, s54, s76
    s_lshl_b32 s55, s93, 8
    s_add_u32 s55, s55, s76
    v_and_b32 v6, 31, v0
    v_lshrrev_b32 v7, 5, v0
    v_and_b32 v8, 15, v0
    v_xor_b32 v8, v8, v7
    v_lshlrev_b32 v8, 4, v8
    v_lshl_add_u32 v8, v6, 8, v8
    s_lshl_b32 s60, s57, 15
    v_add_u32 v8, s60, v8
    v_xor_b32 v9, 0x20, v8
    v_xor_b32 v10, 0x40, v8
    v_xor_b32 v11, 0x60, v8
    v_xor_b32 v23, 0x80, v8
    v_xor_b32 v13, 0xa0, v8
    v_xor_b32 v14, 0xc0, v8
    v_xor_b32 v15, 0xe0, v8
    s_add_u32 m0, s77, 0
    s_add_u32 s60, s52, 0
    buffer_load_dwordx4 v2, s[28:31], s60 offen lds
    s_add_u32 m0, s77, 1024
    s_add_u32 s60, s52, 4096
    buffer_load_dwordx4 v3, s[28:31], s60 offen lds
    s_add_u32 m0, s77, 2048
    s_add_u32 s60, s52, 8192
    buffer_load_dwordx4 v4, s[28:31], s60 offen lds
    s_add_u32 m0, s77, 3072
    s_add_u32 s60, s52, 12288
    buffer_load_dwordx4 v5, s[28:31], s60 offen lds
    s_add_u32 m0, s77, 4096
    s_add_u32 s60, s52, 16384
    buffer_load_dwordx4 v2, s[28:31], s60 offen lds
    s_add_u32 m0, s77, 5120
    s_add_u32 s60, s52, 20480
    buffer_load_dwordx4 v3, s[28:31], s60 offen lds
    s_add_u32 m0, s77, 6144
    s_add_u32 s60, s52, 24576
    buffer_load_dwordx4 v4, s[28:31], s60 offen lds
    s_add_u32 m0, s77, 7168
    s_add_u32 s60, s52, 28672
    buffer_load_dwordx4 v5, s[28:31], s60 offen lds
    s_add_u32 m0, s77, 8192
    s_add_u32 s60, s53, 0
    buffer_load_dwordx4 v2, s[28:31], s60 offen lds
    s_add_u32 m0, s77, 9216
    s_add_u32 s60, s53, 4096
    buffer_load_dwordx4 v3, s[28:31], s60 offen lds
    s_add_u32 m0, s77, 10240
    s_add_u32 s60, s53, 8192
    buffer_load_dwordx4 v4, s[28:31], s60 offen lds
    s_add_u32 m0, s77, 11264
    s_add_u32 s60, s53, 12288
    buffer_load_dwordx4 v5, s[28:31], s60 offen lds
    s_add_u32 m0, s77, 12288
    s_add_u32 s60, s53, 16384
    buffer_load_dwordx4 v2, s[28:31], s60 offen lds
    s_add_u32 m0, s77, 13312
    s_add_u32 s60, s53, 20480
    buffer_load_dwordx4 v3, s[28:31], s60 offen lds
    s_add_u32 m0, s77, 14336
    s_add_u32 s60, s53, 24576
    buffer_load_dwordx4 v4, s[28:31], s60 offen lds
    s_add_u32 m0, s77, 15360
    s_add_u32 s60, s53, 28672
    buffer_load_dwordx4 v5, s[28:31], s60 offen lds
    v_mov_b32 v16, 0
    v_mov_b32 v17, 0
    v_mov_b32 v18, 0
    v_mov_b32 v19, 0
    s_mov_b32 s86, 0x3f803f80
    v_and_b32 v6, 31, v0
    v_lshrrev_b32 v7, 5, v0
    v_lshlrev_b32 v7, 3, v7
    v_sub_u32 v6, v6, v7
    v_and_b32 v7, 1, v6
    v_lshlrev_b32 v7, 4, v7
    v_lshrrev_b32 v6, 1, v6
    v_mov_b32 v32, 0x3f80
    v_lshlrev_b32 v7, v7, v32
    v_cmp_eq_u32 vcc, 0, v6
    s_nop 1
    v_cndmask_b32 v32, 0, v7, vcc
    v_cmp_eq_u32 vcc, 1, v6
    s_nop 1
    v_cndmask_b32 v33, 0, v7, vcc
    v_cmp_eq_u32 vcc, 2, v6
    s_nop 1
    v_cndmask_b32 v34, 0, v7, vcc
    v_cmp_eq_u32 vcc, 3, v6
    s_nop 1
    v_cndmask_b32 v35, 0, v7, vcc
    v_cmp_eq_u32 vcc, 8, v6
    s_nop 1
    v_cndmask_b32 v36, 0, v7, vcc
    v_cmp_eq_u32 vcc, 9, v6
    s_nop 1
    v_cndmask_b32 v37, 0, v7, vcc
    v_cmp_eq_u32 vcc, 10, v6
    s_nop 1
    v_cndmask_b32 v38, 0, v7, vcc
    v_cmp_eq_u32 vcc, 11, v6
    s_nop 1
    v_cndmask_b32 v39, 0, v7, vcc
    v_lshrrev_b32 v22, 3, v0
    v_bfe_u32 v1, v0, 4, 1
    s_and_b32 s60, s57, 1
    s_lshl_b32 s60, s60, 1
    v_or_b32 v1, s60, v1
    v_bfe_u32 v24, v0, 1, 2
    v_xor_b32 v24, v24, v1
    s_lshr_b32 s61, s57, 1
    s_lshl_b32 s61, s61, 3
    v_add_u32 v22, s61, v22
    v_mul_u32_u24 v22, 3584, v22
    v_lshl_add_u32 v22, v24, 5, v22
    v_and_b32 v25, 1, v0
    v_lshl_add_u32 v22, v25, 4, v22
    s_lshl_b32 s61, s59, 7
    v_add_u32 v20, s61, v22
    s_mul_i32 s61, s59, 128
    s_mul_i32 s62, s59, 64
    s_add_u32 s62, s62, 512
    s_cmp_ge_u32 s59, 8
    s_cselect_b32 s61, s62, s61
    s_add_u32 s61, s61, 2048
    v_add_u32 v21, s61, v22
    v_cmp_le_u32 vcc, 2, v24
    v_mov_b32 v25, 0x80000000
    s_nop 0
    v_cndmask_b32 v21, v21, v25, vcc
    s_and_b32 s60, s57, 1
    s_lshl_b32 s60, s60, 11
    s_lshr_b32 s61, s57, 1
    s_lshl_b32 s61, s61, 10
    s_add_u32 s99, s60, s61
    v_cmp_eq_u32 vcc, 0, v0
    v_lshlrev_b32 v22, 2, v0
    v_add_u32 v22, 65792, v22
    v_mov_b32 v30, 65536
    v_cndmask_b32 v28, v22, v30, vcc
    v_mov_b32 v29, 1
    v_lshrrev_b32 v24, 5, v0
    v_lshlrev_b32 v24, 8, v24
    v_bfe_u32 v25, v0, 2, 2
    v_lshl_add_u32 v24, v25, 6, v24
    v_bfe_u32 v25, v0, 4, 1
    v_lshl_add_u32 v24, v25, 5, v24
    v_and_b32 v25, 3, v0
    v_lshl_add_u32 v24, v25, 3, v24
    v_add_u32 v24, 131072, v24
    s_lshl_b32 s60, s57, 11
    s_add_u32 s60, s60, 118784
    v_lshlrev_b32 v12, 4, v0
    v_add_u32 v25, s60, v12
    s_waitcnt vmcnt(8)
    ds_read_b128 v[128:131], v8 offset:0
    ds_read_b128 v[132:135], v9 offset:0
    ds_read_b128 v[136:139], v10 offset:0
    ds_read_b128 v[140:143], v11 offset:0
    ds_read_b128 v[144:147], v23 offset:0
    ds_read_b128 v[148:151], v13 offset:0
    ds_read_b128 v[152:155], v14 offset:0
    ds_read_b128 v[156:159], v15 offset:0
    s_add_u32 m0, s77, 16384
    s_add_u32 s60, s54, 0
    buffer_load_dwordx4 v2, s[28:31], s60 offen lds
    s_add_u32 m0, s77, 17408
    s_add_u32 s60, s54, 4096
    buffer_load_dwordx4 v3, s[28:31], s60 offen lds
    s_add_u32 m0, s77, 18432
    s_add_u32 s60, s54, 8192
    buffer_load_dwordx4 v4, s[28:31], s60 offen lds
    s_add_u32 m0, s77, 19456
    s_add_u32 s60, s54, 12288
    buffer_load_dwordx4 v5, s[28:31], s60 offen lds
    s_add_u32 m0, s77, 20480
    s_add_u32 s60, s54, 16384
    buffer_load_dwordx4 v2, s[28:31], s60 offen lds
    s_add_u32 m0, s77, 21504
    s_add_u32 s60, s54, 20480
    buffer_load_dwordx4 v3, s[28:31], s60 offen lds
    s_add_u32 m0, s77, 22528
    s_add_u32 s60, s54, 24576
    buffer_load_dwordx4 v4, s[28:31], s60 offen lds
    s_add_u32 m0, s77, 23552
    s_add_u32 s60, s54, 28672
    buffer_load_dwordx4 v5, s[28:31], s60 offen lds
    s_waitcnt lgkmcnt(7)
    v_dot2c_f32_bf16 v16, s86, v128
    v_dot2c_f32_bf16 v17, s86, v129
    v_dot2c_f32_bf16 v16, s86, v130
    v_dot2c_f32_bf16 v17, s86, v131
    v_dot2c_f32_bf16 v18, v128, v128
    v_dot2c_f32_bf16 v19, v129, v129
    v_dot2c_f32_bf16 v18, v130, v130
    v_dot2c_f32_bf16 v19, v131, v131
    s_waitcnt lgkmcnt(6)
    v_dot2c_f32_bf16 v16, s86, v132
    v_dot2c_f32_bf16 v17, s86, v133
    v_dot2c_f32_bf16 v16, s86, v134
    v_dot2c_f32_bf16 v17, s86, v135
    v_dot2c_f32_bf16 v18, v132, v132
    v_dot2c_f32_bf16 v19, v133, v133
    v_dot2c_f32_bf16 v18, v134, v134
    v_dot2c_f32_bf16 v19, v135, v135
    s_waitcnt lgkmcnt(5)
    v_dot2c_f32_bf16 v16, s86, v136
    v_dot2c_f32_bf16 v17, s86, v137
    v_dot2c_f32_bf16 v16, s86, v138
    v_dot2c_f32_bf16 v17, s86, v139
    v_dot2c_f32_bf16 v18, v136, v136
    v_dot2c_f32_bf16 v19, v137, v137
    v_dot2c_f32_bf16 v18, v138, v138
    v_dot2c_f32_bf16 v19, v139, v139
    s_waitcnt lgkmcnt(4)
    v_dot2c_f32_bf16 v16, s86, v140
    v_dot2c_f32_bf16 v17, s86, v141
    v_dot2c_f32_bf16 v16, s86, v142
    v_dot2c_f32_bf16 v17, s86, v143
    v_dot2c_f32_bf16 v18, v140, v140
    v_dot2c_f32_bf16 v19, v141, v141
    v_dot2c_f32_bf16 v18, v142, v142
    v_dot2c_f32_bf16 v19, v143, v143
    s_waitcnt lgkmcnt(3)
    v_dot2c_f32_bf16 v16, s86, v144
    v_dot2c_f32_bf16 v17, s86, v145
    v_dot2c_f32_bf16 v16, s86, v146
    v_dot2c_f32_bf16 v17, s86, v147
    v_dot2c_f32_bf16 v18, v144, v144
    v_dot2c_f32_bf16 v19, v145, v145
    v_dot2c_f32_bf16 v18, v146, v146
    v_dot2c_f32_bf16 v19, v147, v147
    s_waitcnt lgkmcnt(2)
    v_dot2c_f32_bf16 v16, s86, v148
    v_dot2c_f32_bf16 v17, s86, v149
    v_dot2c_f32_bf16 v16, s86, v150
    v_dot2c_f32_bf16 v17, s86, v151
    v_dot2c_f32_bf16 v18, v148, v148
    v_dot2c_f32_bf16 v19, v149, v149
    v_dot2c_f32_bf16 v18, v150, v150
    v_dot2c_f32_bf16 v19, v151, v151
    s_waitcnt lgkmcnt(1)
    v_dot2c_f32_bf16 v16, s86, v152
    v_dot2c_f32_bf16 v17, s86, v153
    v_dot2c_f32_bf16 v16, s86, v154
    v_dot2c_f32_bf16 v17, s86, v155
    v_dot2c_f32_bf16 v18, v152, v152
    v_dot2c_f32_bf16 v19, v153, v153
    v_dot2c_f32_bf16 v18, v154, v154
    v_dot2c_f32_bf16 v19, v155, v155
    s_waitcnt lgkmcnt(0)
    v_dot2c_f32_bf16 v16, s86, v156
    v_dot2c_f32_bf16 v17, s86, v157
    v_dot2c_f32_bf16 v16, s86, v158
    v_dot2c_f32_bf16 v17, s86, v159
    v_dot2c_f32_bf16 v18, v156, v156
    v_dot2c_f32_bf16 v19, v157, v157
    v_dot2c_f32_bf16 v18, v158, v158
    v_dot2c_f32_bf16 v19, v159, v159
    s_waitcnt vmcnt(8)
    ds_read_b128 v[160:163], v8 offset:8192
    ds_read_b128 v[164:167], v9 offset:8192
    ds_read_b128 v[168:171], v10 offset:8192
    ds_read_b128 v[172:175], v11 offset:8192
    ds_read_b128 v[176:179], v23 offset:8192
    ds_read_b128 v[180:183], v13 offset:8192
    ds_read_b128 v[184:187], v14 offset:8192
    ds_read_b128 v[188:191], v15 offset:8192
    s_add_u32 m0, s77, 24576
    s_add_u32 s60, s55, 0
    buffer_load_dwordx4 v2, s[28:31], s60 offen lds
    s_add_u32 m0, s77, 25600
    s_add_u32 s60, s55, 4096
    buffer_load_dwordx4 v3, s[28:31], s60 offen lds
    s_add_u32 m0, s77, 26624
    s_add_u32 s60, s55, 8192
    buffer_load_dwordx4 v4, s[28:31], s60 offen lds
    s_add_u32 m0, s77, 27648
    s_add_u32 s60, s55, 12288
    buffer_load_dwordx4 v5, s[28:31], s60 offen lds
    s_add_u32 m0, s77, 28672
    s_add_u32 s60, s55, 16384
    buffer_load_dwordx4 v2, s[28:31], s60 offen lds
    s_add_u32 m0, s77, 29696
    s_add_u32 s60, s55, 20480
    buffer_load_dwordx4 v3, s[28:31], s60 offen lds
    s_add_u32 m0, s77, 30720
    s_add_u32 s60, s55, 24576
    buffer_load_dwordx4 v4, s[28:31], s60 offen lds
    s_add_u32 m0, s77, 31744
    s_add_u32 s60, s55, 28672
    buffer_load_dwordx4 v5, s[28:31], s60 offen lds
    s_mul_i32 s52, s90, 458752
    s_mul_i32 s53, s91, 458752
    s_mul_i32 s54, s92, 458752
    s_mul_i32 s55, s93, 458752
    s_waitcnt lgkmcnt(7)
    v_dot2c_f32_bf16 v16, s86, v160
    v_dot2c_f32_bf16 v17, s86, v161
    v_dot2c_f32_bf16 v16, s86, v162
    v_dot2c_f32_bf16 v17, s86, v163
    v_dot2c_f32_bf16 v18, v160, v160
    v_dot2c_f32_bf16 v19, v161, v161
    v_dot2c_f32_bf16 v18, v162, v162
    v_dot2c_f32_bf16 v19, v163, v163
    s_waitcnt lgkmcnt(6)
    v_dot2c_f32_bf16 v16, s86, v164
    v_dot2c_f32_bf16 v17, s86, v165
    v_dot2c_f32_bf16 v16, s86, v166
    v_dot2c_f32_bf16 v17, s86, v167
    v_dot2c_f32_bf16 v18, v164, v164
    v_dot2c_f32_bf16 v19, v165, v165
    v_dot2c_f32_bf16 v18, v166, v166
    v_dot2c_f32_bf16 v19, v167, v167
    s_waitcnt lgkmcnt(5)
    v_dot2c_f32_bf16 v16, s86, v168
    v_dot2c_f32_bf16 v17, s86, v169
    v_dot2c_f32_bf16 v16, s86, v170
    v_dot2c_f32_bf16 v17, s86, v171
    v_dot2c_f32_bf16 v18, v168, v168
    v_dot2c_f32_bf16 v19, v169, v169
    v_dot2c_f32_bf16 v18, v170, v170
    v_dot2c_f32_bf16 v19, v171, v171
    s_waitcnt lgkmcnt(4)
    v_dot2c_f32_bf16 v16, s86, v172
    v_dot2c_f32_bf16 v17, s86, v173
    v_dot2c_f32_bf16 v16, s86, v174
    v_dot2c_f32_bf16 v17, s86, v175
    v_dot2c_f32_bf16 v18, v172, v172
    v_dot2c_f32_bf16 v19, v173, v173
    v_dot2c_f32_bf16 v18, v174, v174
    v_dot2c_f32_bf16 v19, v175, v175
    s_waitcnt lgkmcnt(3)
    v_dot2c_f32_bf16 v16, s86, v176
    v_dot2c_f32_bf16 v17, s86, v177
    v_dot2c_f32_bf16 v16, s86, v178
    v_dot2c_f32_bf16 v17, s86, v179
    v_dot2c_f32_bf16 v18, v176, v176
    v_dot2c_f32_bf16 v19, v177, v177
    v_dot2c_f32_bf16 v18, v178, v178
    v_dot2c_f32_bf16 v19, v179, v179
    s_waitcnt lgkmcnt(2)
    v_dot2c_f32_bf16 v16, s86, v180
    v_dot2c_f32_bf16 v17, s86, v181
    v_dot2c_f32_bf16 v16, s86, v182
    v_dot2c_f32_bf16 v17, s86, v183
    v_dot2c_f32_bf16 v18, v180, v180
    v_dot2c_f32_bf16 v19, v181, v181
    v_dot2c_f32_bf16 v18, v182, v182
    v_dot2c_f32_bf16 v19, v183, v183
    s_waitcnt lgkmcnt(1)
    v_dot2c_f32_bf16 v16, s86, v184
    v_dot2c_f32_bf16 v17, s86, v185
    v_dot2c_f32_bf16 v16, s86, v186
    v_dot2c_f32_bf16 v17, s86, v187
    v_dot2c_f32_bf16 v18, v184, v184
    v_dot2c_f32_bf16 v19, v185, v185
    v_dot2c_f32_bf16 v18, v186, v186
    v_dot2c_f32_bf16 v19, v187, v187
    s_waitcnt lgkmcnt(0)
    v_dot2c_f32_bf16 v16, s86, v188
    v_dot2c_f32_bf16 v17, s86, v189
    v_dot2c_f32_bf16 v16, s86, v190
    v_dot2c_f32_bf16 v17, s86, v191
    v_dot2c_f32_bf16 v18, v188, v188
    v_dot2c_f32_bf16 v19, v189, v189
    v_dot2c_f32_bf16 v18, v190, v190
    v_dot2c_f32_bf16 v19, v191, v191
    s_waitcnt vmcnt(8)
    ds_read_b128 v[192:195], v8 offset:16384
    ds_read_b128 v[196:199], v9 offset:16384
    ds_read_b128 v[200:203], v10 offset:16384
    ds_read_b128 v[204:207], v11 offset:16384
    ds_read_b128 v[208:211], v23 offset:16384
    ds_read_b128 v[212:215], v13 offset:16384
    ds_read_b128 v[216:219], v14 offset:16384
    ds_read_b128 v[220:223], v15 offset:16384
    s_waitcnt lgkmcnt(7)
    v_dot2c_f32_bf16 v16, s86, v192
    v_dot2c_f32_bf16 v17, s86, v193
    v_dot2c_f32_bf16 v16, s86, v194
    v_dot2c_f32_bf16 v17, s86, v195
    v_dot2c_f32_bf16 v18, v192, v192
    v_dot2c_f32_bf16 v19, v193, v193
    v_dot2c_f32_bf16 v18, v194, v194
    v_dot2c_f32_bf16 v19, v195, v195
    s_waitcnt lgkmcnt(6)
    v_dot2c_f32_bf16 v16, s86, v196
    v_dot2c_f32_bf16 v17, s86, v197
    v_dot2c_f32_bf16 v16, s86, v198
    v_dot2c_f32_bf16 v17, s86, v199
    v_dot2c_f32_bf16 v18, v196, v196
    v_dot2c_f32_bf16 v19, v197, v197
    v_dot2c_f32_bf16 v18, v198, v198
    v_dot2c_f32_bf16 v19, v199, v199
    s_waitcnt lgkmcnt(5)
    v_dot2c_f32_bf16 v16, s86, v200
    v_dot2c_f32_bf16 v17, s86, v201
    v_dot2c_f32_bf16 v16, s86, v202
    v_dot2c_f32_bf16 v17, s86, v203
    v_dot2c_f32_bf16 v18, v200, v200
    v_dot2c_f32_bf16 v19, v201, v201
    v_dot2c_f32_bf16 v18, v202, v202
    v_dot2c_f32_bf16 v19, v203, v203
    s_waitcnt lgkmcnt(4)
    v_dot2c_f32_bf16 v16, s86, v204
    v_dot2c_f32_bf16 v17, s86, v205
    v_dot2c_f32_bf16 v16, s86, v206
    v_dot2c_f32_bf16 v17, s86, v207
    v_dot2c_f32_bf16 v18, v204, v204
    v_dot2c_f32_bf16 v19, v205, v205
    v_dot2c_f32_bf16 v18, v206, v206
    v_dot2c_f32_bf16 v19, v207, v207
    s_waitcnt lgkmcnt(3)
    v_dot2c_f32_bf16 v16, s86, v208
    v_dot2c_f32_bf16 v17, s86, v209
    v_dot2c_f32_bf16 v16, s86, v210
    v_dot2c_f32_bf16 v17, s86, v211
    v_dot2c_f32_bf16 v18, v208, v208
    v_dot2c_f32_bf16 v19, v209, v209
    v_dot2c_f32_bf16 v18, v210, v210
    v_dot2c_f32_bf16 v19, v211, v211
    s_waitcnt lgkmcnt(2)
    v_dot2c_f32_bf16 v16, s86, v212
    v_dot2c_f32_bf16 v17, s86, v213
    v_dot2c_f32_bf16 v16, s86, v214
    v_dot2c_f32_bf16 v17, s86, v215
    v_dot2c_f32_bf16 v18, v212, v212
    v_dot2c_f32_bf16 v19, v213, v213
    v_dot2c_f32_bf16 v18, v214, v214
    v_dot2c_f32_bf16 v19, v215, v215
    s_waitcnt lgkmcnt(1)
    v_dot2c_f32_bf16 v16, s86, v216
    v_dot2c_f32_bf16 v17, s86, v217
    v_dot2c_f32_bf16 v16, s86, v218
    v_dot2c_f32_bf16 v17, s86, v219
    v_dot2c_f32_bf16 v18, v216, v216
    v_dot2c_f32_bf16 v19, v217, v217
    v_dot2c_f32_bf16 v18, v218, v218
    v_dot2c_f32_bf16 v19, v219, v219
    s_waitcnt lgkmcnt(0)
    v_dot2c_f32_bf16 v16, s86, v220
    v_dot2c_f32_bf16 v17, s86, v221
    v_dot2c_f32_bf16 v16, s86, v222
    v_dot2c_f32_bf16 v17, s86, v223
    v_dot2c_f32_bf16 v18, v220, v220
    v_dot2c_f32_bf16 v19, v221, v221
    v_dot2c_f32_bf16 v18, v222, v222
    v_dot2c_f32_bf16 v19, v223, v223
    s_waitcnt vmcnt(0)
    ds_read_b128 v[224:227], v8 offset:24576
    ds_read_b128 v[228:231], v9 offset:24576
    ds_read_b128 v[232:235], v10 offset:24576
    ds_read_b128 v[236:239], v11 offset:24576
    ds_read_b128 v[240:243], v23 offset:24576
    ds_read_b128 v[244:247], v13 offset:24576
    ds_read_b128 v[248:251], v14 offset:24576
    ds_read_b128 v[252:255], v15 offset:24576
    s_waitcnt lgkmcnt(7)
    v_dot2c_f32_bf16 v16, s86, v224
    v_dot2c_f32_bf16 v17, s86, v225
    v_dot2c_f32_bf16 v16, s86, v226
    v_dot2c_f32_bf16 v17, s86, v227
    s_waitcnt lgkmcnt(6)
    v_dot2c_f32_bf16 v16, s86, v228
    v_dot2c_f32_bf16 v17, s86, v229
    v_dot2c_f32_bf16 v16, s86, v230
    v_dot2c_f32_bf16 v17, s86, v231
    s_waitcnt lgkmcnt(5)
    v_dot2c_f32_bf16 v16, s86, v232
    v_dot2c_f32_bf16 v17, s86, v233
    v_dot2c_f32_bf16 v16, s86, v234
    v_dot2c_f32_bf16 v17, s86, v235
    s_waitcnt lgkmcnt(4)
    v_dot2c_f32_bf16 v16, s86, v236
    v_dot2c_f32_bf16 v17, s86, v237
    v_dot2c_f32_bf16 v16, s86, v238
    v_dot2c_f32_bf16 v17, s86, v239
    s_waitcnt lgkmcnt(3)
    v_dot2c_f32_bf16 v16, s86, v240
    v_dot2c_f32_bf16 v17, s86, v241
    v_dot2c_f32_bf16 v16, s86, v242
    v_dot2c_f32_bf16 v17, s86, v243
    s_waitcnt lgkmcnt(2)
    v_dot2c_f32_bf16 v16, s86, v244
    v_dot2c_f32_bf16 v17, s86, v245
    v_dot2c_f32_bf16 v16, s86, v246
    v_dot2c_f32_bf16 v17, s86, v247
    s_waitcnt lgkmcnt(1)
    v_dot2c_f32_bf16 v16, s86, v248
    v_dot2c_f32_bf16 v17, s86, v249
    v_dot2c_f32_bf16 v16, s86, v250
    v_dot2c_f32_bf16 v17, s86, v251
    s_waitcnt lgkmcnt(0)
    v_dot2c_f32_bf16 v16, s86, v252
    v_dot2c_f32_bf16 v17, s86, v253
    v_dot2c_f32_bf16 v16, s86, v254
    v_dot2c_f32_bf16 v17, s86, v255
    s_barrier
    ds_read_b64_tr_b16 v[40:41], v24 offset:0
    ds_read_b64_tr_b16 v[42:43], v24 offset:512
    ds_read_b64_tr_b16 v[44:45], v24 offset:1024
    ds_read_b64_tr_b16 v[46:47], v24 offset:1536
    ds_read_b64_tr_b16 v[48:49], v24 offset:2048
    ds_read_b64_tr_b16 v[50:51], v24 offset:2560
    ds_read_b64_tr_b16 v[52:53], v24 offset:3072
    ds_read_b64_tr_b16 v[54:55], v24 offset:3584
    v_add_f32 v16, v16, v17
    v_mov_b32 v17, v16
    s_nop 1
    v_permlane32_swap_b32 v16, v17
    v_add_f32 v16, v16, v17
    v_mul_f32 v16, 0xbb000000, v16
    v_mov_b32 v64, v16
    v_mov_b32 v65, v16
    v_mov_b32 v66, v16
    v_mov_b32 v67, v16
    v_mov_b32 v68, v16
    v_mov_b32 v69, v16
    v_mov_b32 v70, v16
    v_mov_b32 v71, v16
    v_mov_b32 v72, v16
    v_mov_b32 v73, v16
    v_mov_b32 v74, v16
    v_mov_b32 v75, v16
    v_mov_b32 v76, v16
    v_mov_b32 v77, v16
    v_mov_b32 v78, v16
    v_mov_b32 v79, v16
    v_dot2c_f32_bf16 v18, v224, v224
    v_dot2c_f32_bf16 v19, v225, v225
    v_dot2c_f32_bf16 v18, v226, v226
    v_dot2c_f32_bf16 v19, v227, v227
    v_dot2c_f32_bf16 v18, v228, v228
    v_dot2c_f32_bf16 v19, v229, v229
    v_dot2c_f32_bf16 v18, v230, v230
    v_dot2c_f32_bf16 v19, v231, v231
    v_dot2c_f32_bf16 v18, v232, v232
    v_dot2c_f32_bf16 v19, v233, v233
    v_dot2c_f32_bf16 v18, v234, v234
    v_dot2c_f32_bf16 v19, v235, v235
    v_dot2c_f32_bf16 v18, v236, v236
    v_dot2c_f32_bf16 v19, v237, v237
    v_dot2c_f32_bf16 v18, v238, v238
    v_dot2c_f32_bf16 v19, v239, v239
    v_dot2c_f32_bf16 v18, v240, v240
    v_dot2c_f32_bf16 v19, v241, v241
    v_dot2c_f32_bf16 v18, v242, v242
    v_dot2c_f32_bf16 v19, v243, v243
    v_dot2c_f32_bf16 v18, v244, v244
    v_dot2c_f32_bf16 v19, v245, v245
    v_dot2c_f32_bf16 v18, v246, v246
    v_dot2c_f32_bf16 v19, v247, v247
    v_dot2c_f32_bf16 v18, v248, v248
    v_dot2c_f32_bf16 v19, v249, v249
    v_dot2c_f32_bf16 v18, v250, v250
    v_dot2c_f32_bf16 v19, v251, v251
    v_dot2c_f32_bf16 v18, v252, v252
    v_dot2c_f32_bf16 v19, v253, v253
    v_dot2c_f32_bf16 v18, v254, v254
    v_dot2c_f32_bf16 v19, v255, v255
    v_mfma_f32_32x32x16_bf16 v[80:95], v[32:35], v[128:131], v[64:79]
    v_mfma_f32_32x32x16_bf16 v[80:95], v[36:39], v[132:135], v[80:95]
    v_mfma_f32_32x32x16_bf16 v[96:111], v[32:35], v[136:139], v[64:79]
    v_mfma_f32_32x32x16_bf16 v[96:111], v[36:39], v[140:143], v[96:111]
    s_nop 9
    v_cvt_pk_bf16_f32 v128, v80, v81
    v_cvt_pk_bf16_f32 v129, v82, v83
    v_cvt_pk_bf16_f32 v130, v84, v85
    v_cvt_pk_bf16_f32 v131, v86, v87
    v_cvt_pk_bf16_f32 v132, v88, v89
    v_cvt_pk_bf16_f32 v133, v90, v91
    v_cvt_pk_bf16_f32 v134, v92, v93
    v_cvt_pk_bf16_f32 v135, v94, v95
    v_mfma_f32_32x32x16_bf16 v[80:95], v[32:35], v[144:147], v[64:79]
    v_mfma_f32_32x32x16_bf16 v[80:95], v[36:39], v[148:151], v[80:95]
    v_cvt_pk_bf16_f32 v136, v96, v97
    v_cvt_pk_bf16_f32 v137, v98, v99
    v_cvt_pk_bf16_f32 v138, v100, v101
    v_cvt_pk_bf16_f32 v139, v102, v103
    v_cvt_pk_bf16_f32 v140, v104, v105
    v_cvt_pk_bf16_f32 v141, v106, v107
    v_cvt_pk_bf16_f32 v142, v108, v109
    v_cvt_pk_bf16_f32 v143, v110, v111
    s_waitcnt lgkmcnt(4)
    v_mfma_f32_32x32x16_bf16 v[112:127], v[40:43], v[128:131], 0
    ds_read_b64_tr_b16 v[56:57], v24 offset:4096
    ds_read_b64_tr_b16 v[58:59], v24 offset:4608
    v_mfma_f32_32x32x16_bf16 v[112:127], v[44:47], v[132:135], v[112:127]
    ds_read_b64_tr_b16 v[60:61], v24 offset:5120
    ds_read_b64_tr_b16 v[62:63], v24 offset:5632
    v_mfma_f32_32x32x16_bf16 v[96:111], v[32:35], v[152:155], v[64:79]
    v_mfma_f32_32x32x16_bf16 v[96:111], v[36:39], v[156:159], v[96:111]
    v_add_f32 v18, v18, v19
    v_mov_b32 v19, v18
    v_cvt_pk_bf16_f32 v144, v80, v81
    v_cvt_pk_bf16_f32 v145, v82, v83
    v_cvt_pk_bf16_f32 v146, v84, v85
    v_cvt_pk_bf16_f32 v147, v86, v87
    v_cvt_pk_bf16_f32 v148, v88, v89
    v_cvt_pk_bf16_f32 v149, v90, v91
    v_cvt_pk_bf16_f32 v150, v92, v93
    v_cvt_pk_bf16_f32 v151, v94, v95
    s_waitcnt lgkmcnt(4)
    v_mfma_f32_32x32x16_bf16 v[112:127], v[48:51], v[136:139], v[112:127]
    ds_read_b64_tr_b16 v[40:41], v24 offset:6144
    ds_read_b64_tr_b16 v[42:43], v24 offset:6656
    v_mfma_f32_32x32x16_bf16 v[112:127], v[52:55], v[140:143], v[112:127]
    ds_read_b64_tr_b16 v[44:45], v24 offset:7168
    ds_read_b64_tr_b16 v[46:47], v24 offset:7680
    v_mfma_f32_32x32x16_bf16 v[80:95], v[32:35], v[160:163], v[64:79]
    v_mfma_f32_32x32x16_bf16 v[80:95], v[36:39], v[164:167], v[80:95]
    v_permlane32_swap_b32 v18, v19
    v_add_f32 v18, v18, v19
    v_cvt_pk_bf16_f32 v152, v96, v97
    v_cvt_pk_bf16_f32 v153, v98, v99
    v_cvt_pk_bf16_f32 v154, v100, v101
    v_cvt_pk_bf16_f32 v155, v102, v103
    v_cvt_pk_bf16_f32 v156, v104, v105
    v_cvt_pk_bf16_f32 v157, v106, v107
    v_cvt_pk_bf16_f32 v158, v108, v109
    v_cvt_pk_bf16_f32 v159, v110, v111
    s_waitcnt lgkmcnt(4)
    v_mfma_f32_32x32x16_bf16 v[112:127], v[56:59], v[144:147], v[112:127]
    ds_read_b64_tr_b16 v[48:49], v24 offset:8192
    ds_read_b64_tr_b16 v[50:51], v24 offset:8704
    v_mfma_f32_32x32x16_bf16 v[112:127], v[60:63], v[148:151], v[112:127]
    ds_read_b64_tr_b16 v[52:53], v24 offset:9216
    ds_read_b64_tr_b16 v[54:55], v24 offset:9728
    v_mfma_f32_32x32x16_bf16 v[96:111], v[32:35], v[168:171], v[64:79]
    v_mfma_f32_32x32x16_bf16 v[96:111], v[36:39], v[172:175], v[96:111]
    v_mul_f32 v18, 0x3b000000, v18
    v_fma_f32 v18, -v16, v16, v18
    v_cvt_pk_bf16_f32 v160, v80, v81
    v_cvt_pk_bf16_f32 v161, v82, v83
    v_cvt_pk_bf16_f32 v162, v84, v85
    v_cvt_pk_bf16_f32 v163, v86, v87
    v_cvt_pk_bf16_f32 v164, v88, v89
    v_cvt_pk_bf16_f32 v165, v90, v91
    v_cvt_pk_bf16_f32 v166, v92, v93
    v_cvt_pk_bf16_f32 v167, v94, v95
    s_waitcnt lgkmcnt(4)
    v_mfma_f32_32x32x16_bf16 v[112:127], v[40:43], v[152:155], v[112:127]
    ds_read_b64_tr_b16 v[56:57], v24 offset:10240
    ds_read_b64_tr_b16 v[58:59], v24 offset:10752
    v_mfma_f32_32x32x16_bf16 v[112:127], v[44:47], v[156:159], v[112:127]
    ds_read_b64_tr_b16 v[60:61], v24 offset:11264
    ds_read_b64_tr_b16 v[62:63], v24 offset:11776
    v_mfma_f32_32x32x16_bf16 v[80:95], v[32:35], v[176:179], v[64:79]
    v_mfma_f32_32x32x16_bf16 v[80:95], v[36:39], v[180:183], v[80:95]
    v_max_f32 v18, 0, v18
    v_add_f32 v27, 0x3727c5ac, v18
    v_rsq_f32 v17, v27
    v_cvt_pk_bf16_f32 v168, v96, v97
    v_cvt_pk_bf16_f32 v169, v98, v99
    v_cvt_pk_bf16_f32 v170, v100, v101
    v_cvt_pk_bf16_f32 v171, v102, v103
    v_cvt_pk_bf16_f32 v172, v104, v105
    v_cvt_pk_bf16_f32 v173, v106, v107
    v_cvt_pk_bf16_f32 v174, v108, v109
    v_cvt_pk_bf16_f32 v175, v110, v111
    s_waitcnt lgkmcnt(4)
    v_mfma_f32_32x32x16_bf16 v[112:127], v[48:51], v[160:163], v[112:127]
    ds_read_b64_tr_b16 v[40:41], v24 offset:12288
    ds_read_b64_tr_b16 v[42:43], v24 offset:12800
    v_mfma_f32_32x32x16_bf16 v[112:127], v[52:55], v[164:167], v[112:127]
    ds_read_b64_tr_b16 v[44:45], v24 offset:13312
    ds_read_b64_tr_b16 v[46:47], v24 offset:13824
    v_mfma_f32_32x32x16_bf16 v[96:111], v[32:35], v[184:187], v[64:79]
    v_mfma_f32_32x32x16_bf16 v[96:111], v[36:39], v[188:191], v[96:111]
    s_barrier
    v_cvt_pk_bf16_f32 v176, v80, v81
    v_cvt_pk_bf16_f32 v177, v82, v83
    v_cvt_pk_bf16_f32 v178, v84, v85
    v_cvt_pk_bf16_f32 v179, v86, v87
    v_cvt_pk_bf16_f32 v180, v88, v89
    v_cvt_pk_bf16_f32 v181, v90, v91
    v_cvt_pk_bf16_f32 v182, v92, v93
    v_cvt_pk_bf16_f32 v183, v94, v95
    s_waitcnt lgkmcnt(4)
    v_mfma_f32_32x32x16_bf16 v[112:127], v[56:59], v[168:171], v[112:127]
    ds_read_b64_tr_b16 v[48:49], v24 offset:14336
    ds_read_b64_tr_b16 v[50:51], v24 offset:14848
    v_mfma_f32_32x32x16_bf16 v[112:127], v[60:63], v[172:175], v[112:127]
    ds_read_b64_tr_b16 v[52:53], v24 offset:15360
    ds_read_b64_tr_b16 v[54:55], v24 offset:15872
    v_mfma_f32_32x32x16_bf16 v[80:95], v[32:35], v[192:195], v[64:79]
    v_mfma_f32_32x32x16_bf16 v[80:95], v[36:39], v[196:199], v[80:95]
    v_cvt_pk_bf16_f32 v184, v96, v97
    v_cvt_pk_bf16_f32 v185, v98, v99
    v_cvt_pk_bf16_f32 v186, v100, v101
    v_cvt_pk_bf16_f32 v187, v102, v103
    v_cvt_pk_bf16_f32 v188, v104, v105
    v_cvt_pk_bf16_f32 v189, v106, v107
    v_cvt_pk_bf16_f32 v190, v108, v109
    v_cvt_pk_bf16_f32 v191, v110, v111
    s_waitcnt lgkmcnt(4)
    v_mfma_f32_32x32x16_bf16 v[112:127], v[40:43], v[176:179], v[112:127]
    ds_read_b64_tr_b16 v[56:57], v24 offset:16384
    ds_read_b64_tr_b16 v[58:59], v24 offset:16896
    v_mfma_f32_32x32x16_bf16 v[112:127], v[44:47], v[180:183], v[112:127]
    ds_read_b64_tr_b16 v[60:61], v24 offset:17408
    ds_read_b64_tr_b16 v[62:63], v24 offset:17920
    v_mfma_f32_32x32x16_bf16 v[96:111], v[32:35], v[200:203], v[64:79]
    v_mfma_f32_32x32x16_bf16 v[96:111], v[36:39], v[204:207], v[96:111]
    v_mov_b32 v2, 65600
    ds_read_b64 v[4:5], v2
    v_cvt_pk_bf16_f32 v192, v80, v81
    v_cvt_pk_bf16_f32 v193, v82, v83
    v_cvt_pk_bf16_f32 v194, v84, v85
    v_cvt_pk_bf16_f32 v195, v86, v87
    v_cvt_pk_bf16_f32 v196, v88, v89
    v_cvt_pk_bf16_f32 v197, v90, v91
    v_cvt_pk_bf16_f32 v198, v92, v93
    v_cvt_pk_bf16_f32 v199, v94, v95
    s_waitcnt lgkmcnt(5)
    v_mfma_f32_32x32x16_bf16 v[112:127], v[48:51], v[184:187], v[112:127]
    ds_read_b64_tr_b16 v[40:41], v24 offset:18432
    ds_read_b64_tr_b16 v[42:43], v24 offset:18944
    v_mfma_f32_32x32x16_bf16 v[112:127], v[52:55], v[188:191], v[112:127]
    ds_read_b64_tr_b16 v[44:45], v24 offset:19456
    ds_read_b64_tr_b16 v[46:47], v24 offset:19968
    v_mfma_f32_32x32x16_bf16 v[80:95], v[32:35], v[208:211], v[64:79]
    v_mfma_f32_32x32x16_bf16 v[80:95], v[36:39], v[212:215], v[80:95]
    v_mul_f32 v26, 0xbfb8aa3b, v17
    v_mul_f32 v10, 0x3eb8aa3b, v17
    v_cvt_pk_bf16_f32 v200, v96, v97
    v_cvt_pk_bf16_f32 v201, v98, v99
    v_cvt_pk_bf16_f32 v202, v100, v101
    v_cvt_pk_bf16_f32 v203, v102, v103
    v_cvt_pk_bf16_f32 v204, v104, v105
    v_cvt_pk_bf16_f32 v205, v106, v107
    v_cvt_pk_bf16_f32 v206, v108, v109
    v_cvt_pk_bf16_f32 v207, v110, v111
    s_waitcnt lgkmcnt(5)
    v_mfma_f32_32x32x16_bf16 v[112:127], v[56:59], v[192:195], v[112:127]
    ds_read_b64_tr_b16 v[48:49], v24 offset:20480
    ds_read_b64_tr_b16 v[50:51], v24 offset:20992
    v_mfma_f32_32x32x16_bf16 v[112:127], v[60:63], v[196:199], v[112:127]
    ds_read_b64_tr_b16 v[52:53], v24 offset:21504
    ds_read_b64_tr_b16 v[54:55], v24 offset:22016
    v_mfma_f32_32x32x16_bf16 v[96:111], v[32:35], v[216:219], v[64:79]
    v_mfma_f32_32x32x16_bf16 v[96:111], v[36:39], v[220:223], v[96:111]
    v_cvt_pk_bf16_f32 v208, v80, v81
    v_cvt_pk_bf16_f32 v209, v82, v83
    v_cvt_pk_bf16_f32 v210, v84, v85
    v_cvt_pk_bf16_f32 v211, v86, v87
    v_cvt_pk_bf16_f32 v212, v88, v89
    v_cvt_pk_bf16_f32 v213, v90, v91
    v_cvt_pk_bf16_f32 v214, v92, v93
    v_cvt_pk_bf16_f32 v215, v94, v95
    s_waitcnt lgkmcnt(4)
    v_mfma_f32_32x32x16_bf16 v[112:127], v[40:43], v[200:203], v[112:127]
    ds_read_b64_tr_b16 v[56:57], v24 offset:22528
    ds_read_b64_tr_b16 v[58:59], v24 offset:23040
    v_mfma_f32_32x32x16_bf16 v[112:127], v[44:47], v[204:207], v[112:127]
    ds_read_b64_tr_b16 v[60:61], v24 offset:23552
    ds_read_b64_tr_b16 v[62:63], v24 offset:24064
    v_mfma_f32_32x32x16_bf16 v[80:95], v[32:35], v[224:227], v[64:79]
    v_mfma_f32_32x32x16_bf16 v[80:95], v[36:39], v[228:231], v[80:95]
    v_cvt_pk_bf16_f32 v216, v96, v97
    v_cvt_pk_bf16_f32 v217, v98, v99
    v_cvt_pk_bf16_f32 v218, v100, v101
    v_cvt_pk_bf16_f32 v219, v102, v103
    v_cvt_pk_bf16_f32 v220, v104, v105
    v_cvt_pk_bf16_f32 v221, v106, v107
    v_cvt_pk_bf16_f32 v222, v108, v109
    v_cvt_pk_bf16_f32 v223, v110, v111
    s_waitcnt lgkmcnt(4)
    v_mfma_f32_32x32x16_bf16 v[112:127], v[48:51], v[208:211], v[112:127]
    ds_read_b64_tr_b16 v[40:41], v24 offset:24576
    ds_read_b64_tr_b16 v[42:43], v24 offset:25088
    v_mfma_f32_32x32x16_bf16 v[112:127], v[52:55], v[212:215], v[112:127]
    ds_read_b64_tr_b16 v[44:45], v24 offset:25600
    ds_read_b64_tr_b16 v[46:47], v24 offset:26112
    v_mfma_f32_32x32x16_bf16 v[96:111], v[32:35], v[232:235], v[64:79]
    v_mfma_f32_32x32x16_bf16 v[96:111], v[36:39], v[236:239], v[96:111]
    v_cvt_pk_bf16_f32 v224, v80, v81
    v_cvt_pk_bf16_f32 v225, v82, v83
    v_cvt_pk_bf16_f32 v226, v84, v85
    v_cvt_pk_bf16_f32 v227, v86, v87
    v_cvt_pk_bf16_f32 v228, v88, v89
    v_cvt_pk_bf16_f32 v229, v90, v91
    v_cvt_pk_bf16_f32 v230, v92, v93
    v_cvt_pk_bf16_f32 v231, v94, v95
    s_waitcnt lgkmcnt(4)
    v_mfma_f32_32x32x16_bf16 v[112:127], v[56:59], v[216:219], v[112:127]
    ds_read_b64_tr_b16 v[48:49], v24 offset:26624
    ds_read_b64_tr_b16 v[50:51], v24 offset:27136
    v_mfma_f32_32x32x16_bf16 v[112:127], v[60:63], v[220:223], v[112:127]
    ds_read_b64_tr_b16 v[52:53], v24 offset:27648
    ds_read_b64_tr_b16 v[54:55], v24 offset:28160
    v_mfma_f32_32x32x16_bf16 v[80:95], v[32:35], v[240:243], v[64:79]
    v_mfma_f32_32x32x16_bf16 v[80:95], v[36:39], v[244:247], v[80:95]
    v_cvt_pk_bf16_f32 v232, v96, v97
    v_cvt_pk_bf16_f32 v233, v98, v99
    v_cvt_pk_bf16_f32 v234, v100, v101
    v_cvt_pk_bf16_f32 v235, v102, v103
    v_cvt_pk_bf16_f32 v236, v104, v105
    v_cvt_pk_bf16_f32 v237, v106, v107
    v_cvt_pk_bf16_f32 v238, v108, v109
    v_cvt_pk_bf16_f32 v239, v110, v111
    s_waitcnt lgkmcnt(4)
    v_mfma_f32_32x32x16_bf16 v[112:127], v[40:43], v[224:227], v[112:127]
    ds_read_b64_tr_b16 v[56:57], v24 offset:28672
    ds_read_b64_tr_b16 v[58:59], v24 offset:29184
    v_mfma_f32_32x32x16_bf16 v[112:127], v[44:47], v[228:231], v[112:127]
    ds_read_b64_tr_b16 v[60:61], v24 offset:29696
    ds_read_b64_tr_b16 v[62:63], v24 offset:30208
    v_mfma_f32_32x32x16_bf16 v[96:111], v[32:35], v[248:251], v[64:79]
    v_mfma_f32_32x32x16_bf16 v[96:111], v[36:39], v[252:255], v[96:111]
    s_nop 3
    v_cvt_pk_bf16_f32 v240, v80, v81
    v_cvt_pk_bf16_f32 v241, v82, v83
    v_cvt_pk_bf16_f32 v242, v84, v85
    v_cvt_pk_bf16_f32 v243, v86, v87
    v_cvt_pk_bf16_f32 v244, v88, v89
    v_cvt_pk_bf16_f32 v245, v90, v91
    v_cvt_pk_bf16_f32 v246, v92, v93
    v_cvt_pk_bf16_f32 v247, v94, v95
    s_waitcnt lgkmcnt(4)
    v_mfma_f32_32x32x16_bf16 v[112:127], v[48:51], v[232:235], v[112:127]
    ds_read_b64_tr_b16 v[40:41], v24 offset:30720
    ds_read_b64_tr_b16 v[42:43], v24 offset:31232
    v_mfma_f32_32x32x16_bf16 v[112:127], v[52:55], v[236:239], v[112:127]
    ds_read_b64_tr_b16 v[44:45], v24 offset:31744
    ds_read_b64_tr_b16 v[46:47], v24 offset:32256
    s_nop 3
    v_cvt_pk_bf16_f32 v248, v96, v97
    v_cvt_pk_bf16_f32 v249, v98, v99
    v_cvt_pk_bf16_f32 v250, v100, v101
    v_cvt_pk_bf16_f32 v251, v102, v103
    v_cvt_pk_bf16_f32 v252, v104, v105
    v_cvt_pk_bf16_f32 v253, v106, v107
    v_cvt_pk_bf16_f32 v254, v108, v109
    v_cvt_pk_bf16_f32 v255, v110, v111
    s_waitcnt lgkmcnt(4)
    v_mfma_f32_32x32x16_bf16 v[112:127], v[56:59], v[240:243], v[112:127]
    v_mfma_f32_32x32x16_bf16 v[112:127], v[60:63], v[244:247], v[112:127]
    s_nop 3
    s_waitcnt lgkmcnt(0)
    v_mfma_f32_32x32x16_bf16 v[112:127], v[40:43], v[248:251], v[112:127]
    v_mfma_f32_32x32x16_bf16 v[112:127], v[44:47], v[252:255], v[112:127]
    s_nop 3
    v_readfirstlane_b32 s72, v4
    v_readfirstlane_b32 s73, v5
    s_nop 7
    v_pk_mul_f32 v[112:113], v[112:113], v[10:11] op_sel_hi:[1,0]
    v_pk_mul_f32 v[114:115], v[114:115], v[10:11] op_sel_hi:[1,0]
    v_pk_mul_f32 v[116:117], v[116:117], v[10:11] op_sel_hi:[1,0]
    v_pk_mul_f32 v[118:119], v[118:119], v[10:11] op_sel_hi:[1,0]
    v_pk_mul_f32 v[120:121], v[120:121], v[10:11] op_sel_hi:[1,0]
    v_pk_mul_f32 v[122:123], v[122:123], v[10:11] op_sel_hi:[1,0]
    v_pk_mul_f32 v[124:125], v[124:125], v[10:11] op_sel_hi:[1,0]
    v_pk_mul_f32 v[126:127], v[126:127], v[10:11] op_sel_hi:[1,0]
    v_cvt_pk_bf16_f32 v80, v112, v113
    v_cvt_pk_bf16_f32 v81, v114, v115
    v_cvt_pk_bf16_f32 v82, v116, v117
    v_cvt_pk_bf16_f32 v83, v118, v119
    v_cvt_pk_bf16_f32 v84, v120, v121
    v_cvt_pk_bf16_f32 v85, v122, v123
    v_cvt_pk_bf16_f32 v86, v124, v125
    v_cvt_pk_bf16_f32 v87, v126, v127
    ds_write_b128 v25, v[80:83]
    ds_write_b128 v25, v[84:87] offset:1024
    s_mov_b64 exec, 1
    ds_add_u32 v30, v29 offset:4
    s_mov_b64 exec, -1
    s_setprio 2
    s_add_u32 m0, s99, 69632
    s_add_u32 s60, s52, 0
    buffer_load_dwordx4 v20, s[36:39], s60 offen lds
    s_add_u32 m0, s99, 73728
    s_add_u32 s60, s52, 57344
    buffer_load_dwordx4 v20, s[36:39], s60 offen lds
    s_add_u32 m0, s99, 77824
    s_add_u32 s60, s52, 114688
    buffer_load_dwordx4 v20, s[36:39], s60 offen lds
    s_add_u32 m0, s99, 81920
    s_add_u32 s60, s52, 172032
    buffer_load_dwordx4 v20, s[36:39], s60 offen lds
    s_add_u32 m0, s99, 86016
    s_add_u32 s60, s52, 229376
    buffer_load_dwordx4 v20, s[36:39], s60 offen lds
    s_add_u32 m0, s99, 90112
    s_add_u32 s60, s52, 286720
    buffer_load_dwordx4 v20, s[36:39], s60 offen lds
    s_add_u32 m0, s99, 94208
    s_add_u32 s60, s52, 344064
    buffer_load_dwordx4 v20, s[36:39], s60 offen lds
    s_add_u32 m0, s99, 98304
    s_add_u32 s60, s52, 401408
    buffer_load_dwordx4 v20, s[36:39], s60 offen lds
    v_bfe_u32 v2, v0, 4, 1
    v_bfe_u32 v3, v0, 2, 2
    v_lshrrev_b32 v4, 5, v0
    v_lshlrev_b32 v5, 11, v2
    v_lshl_add_u32 v5, v4, 9, v5
    v_lshl_add_u32 v5, v3, 7, v5
    v_and_b32 v6, 3, v0
    v_lshl_add_u32 v5, v6, 3, v5
    v_lshrrev_b32 v3, 1, v3
    v_lshl_or_b32 v3, v2, 1, v3
    v_lshl_add_u32 v8, v3, 5, v5
    v_add_u32 v8, 69632, v8
    v_xor_b32 v9, 0x20, v8
    v_xor_b32 v10, 0x40, v8
    v_xor_b32 v11, 0x60, v8
    v_add_u32 v16, 0x10000, v8
    v_add_u32 v17, 0x10000, v9
    v_add_u32 v18, 0x10000, v10
    v_add_u32 v19, 0x10000, v11
    s_lshl_b32 s60, s58, 2
    s_add_u32 s60, s60, s57
    s_mul_i32 s60, s60, 112
    s_mul_i32 s61, s59, 8
    s_mul_i32 s62, s59, 6
    s_add_u32 s62, s62, 16
    s_cmp_ge_u32 s59, 8
    s_cselect_b32 s61, s62, s61
    s_add_u32 s60, s60, s61
    s_lshl_b32 s60, s60, 10
    s_add_u32 s76, s60, 1048576
    s_waitcnt vmcnt(6)
    ds_add_u32 v28, v29
L_pl_131:
    ds_read_b32 v13, v30 offset:0
    s_waitcnt lgkmcnt(0)
    v_cmp_le_u32 vcc, 4, v13
    s_cbranch_vccnz L_pld_132
    s_sub_u32 s70, s70, 1
    s_cbranch_scc1 L_pld_132_x
    s_sleep 1
    s_branch L_pl_131
L_pld_132_x:
    s_mov_b32 s70, 0
L_pld_132:
    s_waitcnt vmcnt(4)
    ds_add_u32 v28, v29
    s_setprio 0
    ds_read_b64_tr_b16 v[32:33], v8 offset:0
    ds_read_b64_tr_b16 v[34:35], v8 offset:1024
    ds_read_b64_tr_b16 v[36:37], v9 offset:0
    ds_read_b64_tr_b16 v[38:39], v9 offset:1024
    ds_read_b64_tr_b16 v[40:41], v10 offset:0
    ds_read_b64_tr_b16 v[42:43], v10 offset:1024
    ds_read_b64_tr_b16 v[44:45], v11 offset:0
    ds_read_b64_tr_b16 v[46:47], v11 offset:1024
    ds_read_b64_tr_b16 v[48:49], v8 offset:4096
    ds_read_b64_tr_b16 v[50:51], v8 offset:5120
    ds_read_b64_tr_b16 v[52:53], v9 offset:4096
    ds_read_b64_tr_b16 v[54:55], v9 offset:5120
    ds_read_b32 v13, v30
    ds_read_b64_tr_b16 v[56:57], v10 offset:4096
    ds_read_b64_tr_b16 v[58:59], v10 offset:5120
    ds_read_b64_tr_b16 v[60:61], v11 offset:4096
    ds_read_b64_tr_b16 v[62:63], v11 offset:5120
    s_waitcnt lgkmcnt(13)
    v_mfma_f32_32x32x16_bf16 v[64:79], v[32:35], v[128:131], 0
    s_setprio 2
    s_waitcnt lgkmcnt(4)
    v_cmp_le_u32 vcc, 8, v13
    s_cbranch_vccz L_gs_133
L_gs_133_r:
L_pl_134:
    ds_read_b32 v13, v30 offset:8
    s_waitcnt lgkmcnt(0)
    v_cmp_le_u32 vcc, 4, v13
    s_cbranch_vccnz L_pld_135
    s_sub_u32 s70, s70, 1
    s_cbranch_scc1 L_pld_135_x
    s_sleep 1
    s_branch L_pl_134
L_pld_135_x:
    s_mov_b32 s70, 0
L_pld_135:
    s_setprio 0
    s_waitcnt vmcnt(2)
    ds_add_u32 v28, v29
    ds_read_b64_tr_b16 v[32:33], v8 offset:8192
    ds_read_b64_tr_b16 v[34:35], v8 offset:9216
    s_add_u32 m0, s99, 102400
    s_add_u32 s60, s53, 0
    buffer_load_dwordx4 v20, s[36:39], s60 offen lds
    v_mfma_f32_32x32x16_bf16 v[80:95], v[36:39], v[128:131], 0
    ds_read_b64_tr_b16 v[36:37], v9 offset:8192
    ds_read_b64_tr_b16 v[38:39], v9 offset:9216
    s_add_u32 m0, s99, 106496
    s_add_u32 s60, s53, 57344
    buffer_load_dwordx4 v20, s[36:39], s60 offen lds
    v_mfma_f32_32x32x16_bf16 v[96:111], v[40:43], v[128:131], 0
    ds_read_b64_tr_b16 v[40:41], v10 offset:8192
    ds_read_b64_tr_b16 v[42:43], v10 offset:9216
    s_add_u32 m0, s99, 110592
    s_add_u32 s60, s53, 114688
    buffer_load_dwordx4 v20, s[36:39], s60 offen lds
    v_mfma_f32_32x32x16_bf16 v[112:127], v[44:47], v[128:131], 0
    ds_read_b64_tr_b16 v[44:45], v11 offset:8192
    ds_read_b64_tr_b16 v[46:47], v11 offset:9216
    s_add_u32 m0, s99, 114688
    s_add_u32 s60, s53, 172032
    buffer_load_dwordx4 v20, s[36:39], s60 offen lds
    v_mfma_f32_32x32x16_bf16 v[64:79], v[48:51], v[132:135], v[64:79]
    ds_read_b64_tr_b16 v[48:49], v8 offset:12288
    ds_read_b64_tr_b16 v[50:51], v8 offset:13312
    s_add_u32 m0, s99, 118784
    s_add_u32 s60, s53, 229376
    buffer_load_dwordx4 v20, s[36:39], s60 offen lds
    v_mfma_f32_32x32x16_bf16 v[80:95], v[52:55], v[132:135], v[80:95]
    ds_read_b64_tr_b16 v[52:53], v9 offset:12288
    ds_read_b64_tr_b16 v[54:55], v9 offset:13312
    ds_read_b32 v13, v30
    s_add_u32 m0, s99, 122880
    s_add_u32 s60, s53, 286720
    buffer_load_dwordx4 v20, s[36:39], s60 offen lds
    v_mfma_f32_32x32x16_bf16 v[96:111], v[56:59], v[132:135], v[96:111]
    ds_read_b64_tr_b16 v[56:57], v10 offset:12288
    ds_read_b64_tr_b16 v[58:59], v10 offset:13312
    v_mfma_f32_32x32x16_bf16 v[112:127], v[60:63], v[132:135], v[112:127]
    ds_read_b64_tr_b16 v[60:61], v11 offset:12288
    ds_read_b64_tr_b16 v[62:63], v11 offset:13312
    s_waitcnt lgkmcnt(13)
    v_mfma_f32_32x32x16_bf16 v[64:79], v[32:35], v[136:139], v[64:79]
    s_setprio 2
    s_waitcnt lgkmcnt(4)
    v_cmp_le_u32 vcc, 12, v13
    s_cbranch_vccz L_gs_136
L_gs_136_r:
    s_lshl_b32 s60, s57, 2
    v_add_u32 v1, s60, v30
    s_mul_i32 s68, s57, 16384
    s_add_u32 s68, s68, 0
    s_lshl_b32 s69, s57, 14
L_pl_137:
    ds_read_b32 v13, v1 offset:16
    s_waitcnt lgkmcnt(0)
    v_cmp_le_u32 vcc, 1, v13
    s_cbranch_vccnz L_pld_138
    s_sub_u32 s70, s70, 1
    s_cbranch_scc1 L_pld_138_x
    s_sleep 1
    s_branch L_pl_137
L_pld_138_x:
    s_mov_b32 s70, 0
L_pld_138:
    s_setprio 0
    s_waitcnt vmcnt(6)
    ds_add_u32 v28, v29
    ds_read_b64_tr_b16 v[32:33], v8 offset:16384
    ds_read_b64_tr_b16 v[34:35], v8 offset:17408
    s_add_u32 m0, s68, 4096
    s_add_u32 s60, s69, 70656
    buffer_load_dwordx4 v12, s[32:35], s60 offen sc1 lds
    s_add_u32 m0, s68, 12288
    s_add_u32 s60, s69, 6144
    buffer_load_dwordx4 v12, s[32:35], s60 offen sc1 lds
    v_mfma_f32_32x32x16_bf16 v[80:95], v[36:39], v[136:139], v[80:95]
    ds_read_b64_tr_b16 v[36:37], v9 offset:16384
    ds_read_b64_tr_b16 v[38:39], v9 offset:17408
    s_add_u32 m0, s68, 5120
    s_add_u32 s60, s69, 71680
    buffer_load_dwordx4 v12, s[32:35], s60 offen sc1 lds
    s_add_u32 m0, s68, 13312
    s_add_u32 s60, s69, 7168
    buffer_load_dwordx4 v12, s[32:35], s60 offen sc1 lds
    v_mfma_f32_32x32x16_bf16 v[96:111], v[40:43], v[136:139], v[96:111]
    ds_read_b64_tr_b16 v[40:41], v10 offset:16384
    ds_read_b64_tr_b16 v[42:43], v10 offset:17408
    s_add_u32 m0, s99, 126976
    s_add_u32 s60, s53, 344064
    buffer_load_dwordx4 v20, s[36:39], s60 offen lds
    v_mfma_f32_32x32x16_bf16 v[112:127], v[44:47], v[136:139], v[112:127]
    ds_read_b64_tr_b16 v[44:45], v11 offset:16384
    ds_read_b64_tr_b16 v[46:47], v11 offset:17408
    s_add_u32 m0, s99, 131072
    s_add_u32 s60, s53, 401408
    buffer_load_dwordx4 v20, s[36:39], s60 offen lds
    v_mfma_f32_32x32x16_bf16 v[64:79], v[48:51], v[140:143], v[64:79]
    ds_read_b64_tr_b16 v[48:49], v8 offset:20480
    ds_read_b64_tr_b16 v[50:51], v8 offset:21504
    s_add_u32 m0, s99, 135168
    s_add_u32 s60, s54, 0
    buffer_load_dwordx4 v20, s[36:39], s60 offen lds
    v_mfma_f32_32x32x16_bf16 v[80:95], v[52:55], v[140:143], v[80:95]
    ds_read_b64_tr_b16 v[52:53], v9 offset:20480
    ds_read_b64_tr_b16 v[54:55], v9 offset:21504
    ds_read_b32 v13, v30
    s_add_u32 m0, s99, 139264
    s_add_u32 s60, s54, 57344
    buffer_load_dwordx4 v20, s[36:39], s60 offen lds
    v_mfma_f32_32x32x16_bf16 v[96:111], v[56:59], v[140:143], v[96:111]
    ds_read_b64_tr_b16 v[56:57], v10 offset:20480
    ds_read_b64_tr_b16 v[58:59], v10 offset:21504
    s_add_u32 m0, s99, 143360
    s_add_u32 s60, s54, 114688
    buffer_load_dwordx4 v20, s[36:39], s60 offen lds
    v_mfma_f32_32x32x16_bf16 v[112:127], v[60:63], v[140:143], v[112:127]
    ds_read_b64_tr_b16 v[60:61], v11 offset:20480
    ds_read_b64_tr_b16 v[62:63], v11 offset:21504
    s_add_u32 m0, s99, 147456
    s_add_u32 s60, s54, 172032
    buffer_load_dwordx4 v20, s[36:39], s60 offen lds
    s_waitcnt lgkmcnt(13)
    v_mfma_f32_32x32x16_bf16 v[64:79], v[32:35], v[144:147], v[64:79]
    s_setprio 2
    s_waitcnt lgkmcnt(4)
    v_cmp_le_u32 vcc, 16, v13
    s_cbranch_vccz L_gs_139
L_gs_139_r:
    s_setprio 0
    s_waitcnt vmcnt(14)
    ds_add_u32 v28, v29
    ds_read_b64_tr_b16 v[32:33], v8 offset:24576
    ds_read_b64_tr_b16 v[34:35], v8 offset:25600
    s_add_u32 m0, s68, 6144
    s_add_u32 s60, s69, 72704
    buffer_load_dwordx4 v12, s[32:35], s60 offen sc1 lds
    s_add_u32 m0, s68, 14336
    s_add_u32 s60, s69, 8192
    buffer_load_dwordx4 v12, s[32:35], s60 offen sc1 lds
    v_mfma_f32_32x32x16_bf16 v[80:95], v[36:39], v[144:147], v[80:95]
    ds_read_b64_tr_b16 v[36:37], v9 offset:24576
    ds_read_b64_tr_b16 v[38:39], v9 offset:25600
    s_add_u32 m0, s68, 7168
    s_add_u32 s60, s69, 73728
    buffer_load_dwordx4 v12, s[32:35], s60 offen sc1 lds
    s_add_u32 m0, s68, 15360
    s_add_u32 s60, s69, 9216
    buffer_load_dwordx4 v12, s[32:35], s60 offen sc1 lds
    v_mfma_f32_32x32x16_bf16 v[96:111], v[40:43], v[144:147], v[96:111]
    ds_read_b64_tr_b16 v[40:41], v10 offset:24576
    ds_read_b64_tr_b16 v[42:43], v10 offset:25600
    s_add_u32 m0, s99, 151552
    s_add_u32 s60, s54, 229376
    buffer_load_dwordx4 v20, s[36:39], s60 offen lds
    v_mfma_f32_32x32x16_bf16 v[112:127], v[44:47], v[144:147], v[112:127]
    ds_read_b64_tr_b16 v[44:45], v11 offset:24576
    ds_read_b64_tr_b16 v[46:47], v11 offset:25600
    s_add_u32 m0, s99, 155648
    s_add_u32 s60, s54, 286720
    buffer_load_dwordx4 v20, s[36:39], s60 offen lds
    v_mfma_f32_32x32x16_bf16 v[64:79], v[48:51], v[148:151], v[64:79]
    ds_read_b64_tr_b16 v[48:49], v8 offset:28672
    ds_read_b64_tr_b16 v[50:51], v8 offset:29696
    s_add_u32 m0, s99, 69632
    s_add_u32 s60, s54, 344064
    buffer_load_dwordx4 v20, s[36:39], s60 offen lds
    v_mfma_f32_32x32x16_bf16 v[80:95], v[52:55], v[148:151], v[80:95]
    ds_read_b64_tr_b16 v[52:53], v9 offset:28672
    ds_read_b64_tr_b16 v[54:55], v9 offset:29696
    ds_read_b32 v13, v30
    s_add_u32 m0, s99, 73728
    s_add_u32 s60, s54, 401408
    buffer_load_dwordx4 v20, s[36:39], s60 offen lds
    s_waitcnt lgkmcnt(14)
    v_mfma_f32_32x32x16_bf16 v[96:111], v[56:59], v[148:151], v[96:111]
    ds_read_b64_tr_b16 v[56:57], v10 offset:28672
    ds_read_b64_tr_b16 v[58:59], v10 offset:29696
    s_add_u32 m0, s99, 77824
    s_add_u32 s60, s55, 0
    buffer_load_dwordx4 v20, s[36:39], s60 offen lds
    v_mfma_f32_32x32x16_bf16 v[112:127], v[60:63], v[148:151], v[112:127]
    ds_read_b64_tr_b16 v[60:61], v11 offset:28672
    ds_read_b64_tr_b16 v[62:63], v11 offset:29696
    s_add_u32 m0, s99, 81920
    s_add_u32 s60, s55, 57344
    buffer_load_dwordx4 v20, s[36:39], s60 offen lds
    s_waitcnt lgkmcnt(13)
    v_mfma_f32_32x32x16_bf16 v[64:79], v[32:35], v[152:155], v[64:79]
    s_setprio 2
    s_waitcnt lgkmcnt(4)
    v_cmp_le_u32 vcc, 20, v13
    s_cbranch_vccz L_gs_140
L_gs_140_r:
    s_setprio 0
    s_waitcnt vmcnt(22)
    ds_add_u32 v28, v29
    ds_read_b64_tr_b16 v[32:33], v8 offset:32768
    ds_read_b64_tr_b16 v[34:35], v8 offset:33792
    s_add_u32 m0, s99, 86016
    s_add_u32 s60, s55, 114688
    buffer_load_dwordx4 v20, s[36:39], s60 offen lds
    v_mfma_f32_32x32x16_bf16 v[80:95], v[36:39], v[152:155], v[80:95]
    ds_read_b64_tr_b16 v[36:37], v9 offset:32768
    ds_read_b64_tr_b16 v[38:39], v9 offset:33792
    s_add_u32 m0, s99, 90112
    s_add_u32 s60, s55, 172032
    buffer_load_dwordx4 v20, s[36:39], s60 offen lds
    v_mfma_f32_32x32x16_bf16 v[96:111], v[40:43], v[152:155], v[96:111]
    ds_read_b64_tr_b16 v[40:41], v10 offset:32768
    ds_read_b64_tr_b16 v[42:43], v10 offset:33792
    v_mfma_f32_32x32x16_bf16 v[112:127], v[44:47], v[152:155], v[112:127]
    ds_read_b64_tr_b16 v[44:45], v11 offset:32768
    ds_read_b64_tr_b16 v[46:47], v11 offset:33792
    v_mfma_f32_32x32x16_bf16 v[64:79], v[48:51], v[156:159], v[64:79]
    ds_read_b64_tr_b16 v[48:49], v8 offset:36864
    ds_read_b64_tr_b16 v[50:51], v8 offset:37888
    v_mfma_f32_32x32x16_bf16 v[80:95], v[52:55], v[156:159], v[80:95]
    ds_read_b64_tr_b16 v[52:53], v9 offset:36864
    ds_read_b64_tr_b16 v[54:55], v9 offset:37888
    ds_read_b32 v13, v30
    s_waitcnt lgkmcnt(14)
    v_mfma_f32_32x32x16_bf16 v[96:111], v[56:59], v[156:159], v[96:111]
    ds_read_b64_tr_b16 v[56:57], v10 offset:36864
    ds_read_b64_tr_b16 v[58:59], v10 offset:37888
    v_mfma_f32_32x32x16_bf16 v[112:127], v[60:63], v[156:159], v[112:127]
    ds_read_b64_tr_b16 v[60:61], v11 offset:36864
    ds_read_b64_tr_b16 v[62:63], v11 offset:37888
    s_waitcnt lgkmcnt(13)
    v_mfma_f32_32x32x16_bf16 v[64:79], v[32:35], v[160:163], v[64:79]
    s_setprio 2
    s_waitcnt lgkmcnt(4)
    v_cmp_le_u32 vcc, 24, v13
    s_cbranch_vccz L_gs_141
L_gs_141_r:
    s_setprio 0
    s_waitcnt vmcnt(22)
    ds_add_u32 v28, v29
    ds_read_b64_tr_b16 v[32:33], v8 offset:40960
    ds_read_b64_tr_b16 v[34:35], v8 offset:41984
    s_add_u32 m0, s99, 94208
    s_add_u32 s60, s55, 229376
    buffer_load_dwordx4 v20, s[36:39], s60 offen lds
    v_mfma_f32_32x32x16_bf16 v[80:95], v[36:39], v[160:163], v[80:95]
    ds_read_b64_tr_b16 v[36:37], v9 offset:40960
    ds_read_b64_tr_b16 v[38:39], v9 offset:41984
    s_add_u32 m0, s99, 98304
    s_add_u32 s60, s55, 286720
    buffer_load_dwordx4 v20, s[36:39], s60 offen lds
    v_mfma_f32_32x32x16_bf16 v[96:111], v[40:43], v[160:163], v[96:111]
    ds_read_b64_tr_b16 v[40:41], v10 offset:40960
    ds_read_b64_tr_b16 v[42:43], v10 offset:41984
    v_mfma_f32_32x32x16_bf16 v[112:127], v[44:47], v[160:163], v[112:127]
    ds_read_b64_tr_b16 v[44:45], v11 offset:40960
    ds_read_b64_tr_b16 v[46:47], v11 offset:41984
    v_mfma_f32_32x32x16_bf16 v[64:79], v[48:51], v[164:167], v[64:79]
    ds_read_b64_tr_b16 v[48:49], v8 offset:45056
    ds_read_b64_tr_b16 v[50:51], v8 offset:46080
    v_mfma_f32_32x32x16_bf16 v[80:95], v[52:55], v[164:167], v[80:95]
    ds_read_b64_tr_b16 v[52:53], v9 offset:45056
    ds_read_b64_tr_b16 v[54:55], v9 offset:46080
    ds_read_b32 v13, v30
    s_waitcnt lgkmcnt(14)
    v_mfma_f32_32x32x16_bf16 v[96:111], v[56:59], v[164:167], v[96:111]
    ds_read_b64_tr_b16 v[56:57], v10 offset:45056
    ds_read_b64_tr_b16 v[58:59], v10 offset:46080
    v_mfma_f32_32x32x16_bf16 v[112:127], v[60:63], v[164:167], v[112:127]
    ds_read_b64_tr_b16 v[60:61], v11 offset:45056
    ds_read_b64_tr_b16 v[62:63], v11 offset:46080
    s_waitcnt lgkmcnt(13)
    v_mfma_f32_32x32x16_bf16 v[64:79], v[32:35], v[168:171], v[64:79]
    s_setprio 2
    s_waitcnt lgkmcnt(4)
    v_cmp_le_u32 vcc, 28, v13
    s_cbranch_vccz L_gs_142
L_gs_142_r:
    s_setprio 0
    s_waitcnt vmcnt(18)
    ds_add_u32 v28, v29
    s_waitcnt vmcnt(10)
    s_mov_b64 exec, 1
    ds_add_u32 v1, v29 offset:32
    s_mov_b64 exec, -1
    ds_read_b64_tr_b16 v[32:33], v8 offset:49152
    ds_read_b64_tr_b16 v[34:35], v8 offset:50176
    s_add_u32 m0, s99, 102400
    s_add_u32 s60, s55, 344064
    buffer_load_dwordx4 v20, s[36:39], s60 offen lds
    v_mfma_f32_32x32x16_bf16 v[80:95], v[36:39], v[168:171], v[80:95]
    ds_read_b64_tr_b16 v[36:37], v9 offset:49152
    ds_read_b64_tr_b16 v[38:39], v9 offset:50176
    s_add_u32 m0, s99, 106496
    s_add_u32 s60, s55, 401408
    buffer_load_dwordx4 v20, s[36:39], s60 offen lds
    v_mfma_f32_32x32x16_bf16 v[96:111], v[40:43], v[168:171], v[96:111]
    ds_read_b64_tr_b16 v[40:41], v10 offset:49152
    ds_read_b64_tr_b16 v[42:43], v10 offset:50176
    v_mfma_f32_32x32x16_bf16 v[112:127], v[44:47], v[168:171], v[112:127]
    ds_read_b64_tr_b16 v[44:45], v11 offset:49152
    ds_read_b64_tr_b16 v[46:47], v11 offset:50176
    v_mfma_f32_32x32x16_bf16 v[64:79], v[48:51], v[172:175], v[64:79]
    ds_read_b64_tr_b16 v[48:49], v8 offset:53248
    ds_read_b64_tr_b16 v[50:51], v8 offset:54272
    v_mfma_f32_32x32x16_bf16 v[80:95], v[52:55], v[172:175], v[80:95]
    ds_read_b64_tr_b16 v[52:53], v9 offset:53248
    ds_read_b64_tr_b16 v[54:55], v9 offset:54272
    ds_read_b32 v13, v30
    s_waitcnt lgkmcnt(15)
    v_mfma_f32_32x32x16_bf16 v[96:111], v[56:59], v[172:175], v[96:111]
    ds_read_b64_tr_b16 v[56:57], v10 offset:53248
    ds_read_b64_tr_b16 v[58:59], v10 offset:54272
    v_mfma_f32_32x32x16_bf16 v[112:127], v[60:63], v[172:175], v[112:127]
    ds_read_b64_tr_b16 v[60:61], v11 offset:53248
    ds_read_b64_tr_b16 v[62:63], v11 offset:54272
    s_waitcnt lgkmcnt(13)
    v_mfma_f32_32x32x16_bf16 v[64:79], v[32:35], v[176:179], v[64:79]
    s_setprio 2
    s_waitcnt lgkmcnt(4)
    v_cmp_le_u32 vcc, 32, v13
    s_cbranch_vccz L_gs_143
L_gs_143_r:
    s_setprio 0
    ds_add_u32 v28, v29
    ds_read_b64_tr_b16 v[32:33], v8 offset:57344
    ds_read_b64_tr_b16 v[34:35], v8 offset:58368
    s_add_u32 m0, s99, 110592
    s_add_u32 s60, s52, 0
    buffer_load_dwordx4 v21, s[36:39], s60 offen lds
    v_mfma_f32_32x32x16_bf16 v[80:95], v[36:39], v[176:179], v[80:95]
    ds_read_b64_tr_b16 v[36:37], v9 offset:57344
    ds_read_b64_tr_b16 v[38:39], v9 offset:58368
    s_add_u32 m0, s99, 114688
    s_add_u32 s60, s52, 57344
    buffer_load_dwordx4 v21, s[36:39], s60 offen lds
    v_mfma_f32_32x32x16_bf16 v[96:111], v[40:43], v[176:179], v[96:111]
    ds_read_b64_tr_b16 v[40:41], v10 offset:57344
    ds_read_b64_tr_b16 v[42:43], v10 offset:58368
    v_mfma_f32_32x32x16_bf16 v[112:127], v[44:47], v[176:179], v[112:127]
    ds_read_b64_tr_b16 v[44:45], v11 offset:57344
    ds_read_b64_tr_b16 v[46:47], v11 offset:58368
    v_mfma_f32_32x32x16_bf16 v[64:79], v[48:51], v[180:183], v[64:79]
    ds_read_b64_tr_b16 v[48:49], v8 offset:61440
    ds_read_b64_tr_b16 v[50:51], v8 offset:62464
    v_mfma_f32_32x32x16_bf16 v[80:95], v[52:55], v[180:183], v[80:95]
    ds_read_b64_tr_b16 v[52:53], v9 offset:61440
    ds_read_b64_tr_b16 v[54:55], v9 offset:62464
    ds_read_b32 v13, v30
    s_waitcnt lgkmcnt(14)
    v_mfma_f32_32x32x16_bf16 v[96:111], v[56:59], v[180:183], v[96:111]
    ds_read_b64_tr_b16 v[56:57], v10 offset:61440
    ds_read_b64_tr_b16 v[58:59], v10 offset:62464
    v_mfma_f32_32x32x16_bf16 v[112:127], v[60:63], v[180:183], v[112:127]
    ds_read_b64_tr_b16 v[60:61], v11 offset:61440
    ds_read_b64_tr_b16 v[62:63], v11 offset:62464
    s_waitcnt lgkmcnt(13)
    v_mfma_f32_32x32x16_bf16 v[64:79], v[32:35], v[184:187], v[64:79]
    s_setprio 2
    s_waitcnt lgkmcnt(4)
    v_cmp_le_u32 vcc, 36, v13
    s_cbranch_vccz L_gs_144
L_gs_144_r:
    s_setprio 0
    ds_add_u32 v28, v29
    ds_read_b64_tr_b16 v[32:33], v16 offset:0
    ds_read_b64_tr_b16 v[34:35], v16 offset:1024
    s_add_u32 m0, s99, 118784
    s_add_u32 s60, s52, 114688
    buffer_load_dwordx4 v21, s[36:39], s60 offen lds
    v_mfma_f32_32x32x16_bf16 v[80:95], v[36:39], v[184:187], v[80:95]
    ds_read_b64_tr_b16 v[36:37], v17 offset:0
    ds_read_b64_tr_b16 v[38:39], v17 offset:1024
    s_add_u32 m0, s99, 122880
    s_add_u32 s60, s52, 172032
    buffer_load_dwordx4 v21, s[36:39], s60 offen lds
    v_mfma_f32_32x32x16_bf16 v[96:111], v[40:43], v[184:187], v[96:111]
    ds_read_b64_tr_b16 v[40:41], v18 offset:0
    ds_read_b64_tr_b16 v[42:43], v18 offset:1024
    v_mfma_f32_32x32x16_bf16 v[112:127], v[44:47], v[184:187], v[112:127]
    ds_read_b64_tr_b16 v[44:45], v19 offset:0
    ds_read_b64_tr_b16 v[46:47], v19 offset:1024
    v_mfma_f32_32x32x16_bf16 v[64:79], v[48:51], v[188:191], v[64:79]
    ds_read_b64_tr_b16 v[48:49], v16 offset:4096
    ds_read_b64_tr_b16 v[50:51], v16 offset:5120
    v_mfma_f32_32x32x16_bf16 v[80:95], v[52:55], v[188:191], v[80:95]
    ds_read_b64_tr_b16 v[52:53], v17 offset:4096
    ds_read_b64_tr_b16 v[54:55], v17 offset:5120
    ds_read_b32 v13, v30
    s_waitcnt lgkmcnt(14)
    v_mfma_f32_32x32x16_bf16 v[96:111], v[56:59], v[188:191], v[96:111]
    ds_read_b64_tr_b16 v[56:57], v18 offset:4096
    ds_read_b64_tr_b16 v[58:59], v18 offset:5120
    v_mfma_f32_32x32x16_bf16 v[112:127], v[60:63], v[188:191], v[112:127]
    ds_read_b64_tr_b16 v[60:61], v19 offset:4096
    ds_read_b64_tr_b16 v[62:63], v19 offset:5120
    s_waitcnt lgkmcnt(13)
    v_mfma_f32_32x32x16_bf16 v[64:79], v[32:35], v[192:195], v[64:79]
    s_setprio 2
    s_waitcnt lgkmcnt(4)
    v_cmp_le_u32 vcc, 40, v13
    s_cbranch_vccz L_gs_145
L_gs_145_r:
    s_setprio 0
    s_waitcnt vmcnt(14)
    ds_add_u32 v28, v29
    ds_read_b64_tr_b16 v[32:33], v16 offset:8192
    ds_read_b64_tr_b16 v[34:35], v16 offset:9216
    s_add_u32 m0, s99, 126976
    s_add_u32 s60, s52, 229376
    buffer_load_dwordx4 v21, s[36:39], s60 offen lds
    v_mfma_f32_32x32x16_bf16 v[80:95], v[36:39], v[192:195], v[80:95]
    ds_read_b64_tr_b16 v[36:37], v17 offset:8192
    ds_read_b64_tr_b16 v[38:39], v17 offset:9216
    s_add_u32 m0, s99, 131072
    s_add_u32 s60, s52, 286720
    buffer_load_dwordx4 v21, s[36:39], s60 offen lds
    v_mfma_f32_32x32x16_bf16 v[96:111], v[40:43], v[192:195], v[96:111]
    ds_read_b64_tr_b16 v[40:41], v18 offset:8192
    ds_read_b64_tr_b16 v[42:43], v18 offset:9216
    v_mfma_f32_32x32x16_bf16 v[112:127], v[44:47], v[192:195], v[112:127]
    ds_read_b64_tr_b16 v[44:45], v19 offset:8192
    ds_read_b64_tr_b16 v[46:47], v19 offset:9216
    v_mfma_f32_32x32x16_bf16 v[64:79], v[48:51], v[196:199], v[64:79]
    ds_read_b64_tr_b16 v[48:49], v16 offset:12288
    ds_read_b64_tr_b16 v[50:51], v16 offset:13312
    v_mfma_f32_32x32x16_bf16 v[80:95], v[52:55], v[196:199], v[80:95]
    ds_read_b64_tr_b16 v[52:53], v17 offset:12288
    ds_read_b64_tr_b16 v[54:55], v17 offset:13312
    ds_read_b32 v13, v30
    s_waitcnt lgkmcnt(14)
    v_mfma_f32_32x32x16_bf16 v[96:111], v[56:59], v[196:199], v[96:111]
    ds_read_b64_tr_b16 v[56:57], v18 offset:12288
    ds_read_b64_tr_b16 v[58:59], v18 offset:13312
    v_mfma_f32_32x32x16_bf16 v[112:127], v[60:63], v[196:199], v[112:127]
    ds_read_b64_tr_b16 v[60:61], v19 offset:12288
    ds_read_b64_tr_b16 v[62:63], v19 offset:13312
    s_waitcnt lgkmcnt(13)
    v_mfma_f32_32x32x16_bf16 v[64:79], v[32:35], v[200:203], v[64:79]
    s_setprio 2
    s_waitcnt lgkmcnt(4)
    v_cmp_le_u32 vcc, 44, v13
    s_cbranch_vccz L_gs_146
L_gs_146_r:
    s_setprio 0
    s_waitcnt vmcnt(14)
    ds_add_u32 v28, v29
    ds_read_b64_tr_b16 v[32:33], v16 offset:16384
    ds_read_b64_tr_b16 v[34:35], v16 offset:17408
    s_add_u32 m0, s99, 135168
    s_add_u32 s60, s52, 344064
    buffer_load_dwordx4 v21, s[36:39], s60 offen lds
    v_mfma_f32_32x32x16_bf16 v[80:95], v[36:39], v[200:203], v[80:95]
    ds_read_b64_tr_b16 v[36:37], v17 offset:16384
    ds_read_b64_tr_b16 v[38:39], v17 offset:17408
    s_add_u32 m0, s99, 139264
    s_add_u32 s60, s52, 401408
    buffer_load_dwordx4 v21, s[36:39], s60 offen lds
    v_mfma_f32_32x32x16_bf16 v[96:111], v[40:43], v[200:203], v[96:111]
    ds_read_b64_tr_b16 v[40:41], v18 offset:16384
    ds_read_b64_tr_b16 v[42:43], v18 offset:17408
    v_mfma_f32_32x32x16_bf16 v[112:127], v[44:47], v[200:203], v[112:127]
    ds_read_b64_tr_b16 v[44:45], v19 offset:16384
    ds_read_b64_tr_b16 v[46:47], v19 offset:17408
    v_mfma_f32_32x32x16_bf16 v[64:79], v[48:51], v[204:207], v[64:79]
    ds_read_b64_tr_b16 v[48:49], v16 offset:20480
    ds_read_b64_tr_b16 v[50:51], v16 offset:21504
    v_mfma_f32_32x32x16_bf16 v[80:95], v[52:55], v[204:207], v[80:95]
    ds_read_b64_tr_b16 v[52:53], v17 offset:20480
    ds_read_b64_tr_b16 v[54:55], v17 offset:21504
    ds_read_b32 v13, v30
    s_waitcnt lgkmcnt(14)
    v_mfma_f32_32x32x16_bf16 v[96:111], v[56:59], v[204:207], v[96:111]
    ds_read_b64_tr_b16 v[56:57], v18 offset:20480
    ds_read_b64_tr_b16 v[58:59], v18 offset:21504
    v_mfma_f32_32x32x16_bf16 v[112:127], v[60:63], v[204:207], v[112:127]
    ds_read_b64_tr_b16 v[60:61], v19 offset:20480
    ds_read_b64_tr_b16 v[62:63], v19 offset:21504
    s_waitcnt lgkmcnt(13)
    v_mfma_f32_32x32x16_bf16 v[64:79], v[32:35], v[208:211], v[64:79]
    s_setprio 2
    s_waitcnt lgkmcnt(4)
    v_cmp_le_u32 vcc, 48, v13
    s_cbranch_vccz L_gs_147
L_gs_147_r:
    s_setprio 0
    s_waitcnt vmcnt(14)
    ds_add_u32 v28, v29
    ds_read_b64_tr_b16 v[32:33], v8 offset:0
    ds_read_b64_tr_b16 v[34:35], v8 offset:1024
    s_add_u32 m0, s99, 143360
    s_add_u32 s60, s53, 0
    buffer_load_dwordx4 v21, s[36:39], s60 offen lds
    v_mfma_f32_32x32x16_bf16 v[80:95], v[36:39], v[208:211], v[80:95]
    ds_read_b64_tr_b16 v[36:37], v9 offset:0
    ds_read_b64_tr_b16 v[38:39], v9 offset:1024
    s_add_u32 m0, s99, 147456
    s_add_u32 s60, s53, 57344
    buffer_load_dwordx4 v21, s[36:39], s60 offen lds
    v_mfma_f32_32x32x16_bf16 v[96:111], v[40:43], v[208:211], v[96:111]
    ds_read_b64_tr_b16 v[40:41], v10 offset:0
    ds_read_b64_tr_b16 v[42:43], v10 offset:1024
    v_mfma_f32_32x32x16_bf16 v[112:127], v[44:47], v[208:211], v[112:127]
    ds_read_b64_tr_b16 v[44:45], v11 offset:0
    ds_read_b64_tr_b16 v[46:47], v11 offset:1024
    v_mfma_f32_32x32x16_bf16 v[64:79], v[48:51], v[212:215], v[64:79]
    ds_read_b64_tr_b16 v[48:49], v8 offset:4096
    ds_read_b64_tr_b16 v[50:51], v8 offset:5120
    v_mfma_f32_32x32x16_bf16 v[80:95], v[52:55], v[212:215], v[80:95]
    ds_read_b64_tr_b16 v[52:53], v9 offset:4096
    ds_read_b64_tr_b16 v[54:55], v9 offset:5120
    ds_read_b32 v13, v30
    s_waitcnt lgkmcnt(14)
    v_mfma_f32_32x32x16_bf16 v[96:111], v[56:59], v[212:215], v[96:111]
    ds_read_b64_tr_b16 v[56:57], v10 offset:4096
    ds_read_b64_tr_b16 v[58:59], v10 offset:5120
    v_mfma_f32_32x32x16_bf16 v[112:127], v[60:63], v[212:215], v[112:127]
    ds_read_b64_tr_b16 v[60:61], v11 offset:4096
    ds_read_b64_tr_b16 v[62:63], v11 offset:5120
    s_waitcnt lgkmcnt(13)
    v_mfma_f32_32x32x16_bf16 v[64:79], v[32:35], v[216:219], v[64:79]
    s_setprio 2
    s_waitcnt lgkmcnt(4)
    v_cmp_le_u32 vcc, 52, v13
    s_cbranch_vccz L_gs_148
L_gs_148_r:
    s_setprio 0
    s_waitcnt vmcnt(14)
    ds_add_u32 v28, v29
    ds_read_b64_tr_b16 v[32:33], v8 offset:8192
    ds_read_b64_tr_b16 v[34:35], v8 offset:9216
    s_add_u32 m0, s99, 151552
    s_add_u32 s60, s53, 114688
    buffer_load_dwordx4 v21, s[36:39], s60 offen lds
    v_mfma_f32_32x32x16_bf16 v[80:95], v[36:39], v[216:219], v[80:95]
    ds_read_b64_tr_b16 v[36:37], v9 offset:8192
    ds_read_b64_tr_b16 v[38:39], v9 offset:9216
    s_add_u32 m0, s99, 155648
    s_add_u32 s60, s53, 172032
    buffer_load_dwordx4 v21, s[36:39], s60 offen lds
    v_mfma_f32_32x32x16_bf16 v[96:111], v[40:43], v[216:219], v[96:111]
    ds_read_b64_tr_b16 v[40:41], v10 offset:8192
    ds_read_b64_tr_b16 v[42:43], v10 offset:9216
    v_mfma_f32_32x32x16_bf16 v[112:127], v[44:47], v[216:219], v[112:127]
    ds_read_b64_tr_b16 v[44:45], v11 offset:8192
    ds_read_b64_tr_b16 v[46:47], v11 offset:9216
    v_mfma_f32_32x32x16_bf16 v[64:79], v[48:51], v[220:223], v[64:79]
    ds_read_b64_tr_b16 v[48:49], v8 offset:12288
    ds_read_b64_tr_b16 v[50:51], v8 offset:13312
    v_mfma_f32_32x32x16_bf16 v[80:95], v[52:55], v[220:223], v[80:95]
    ds_read_b64_tr_b16 v[52:53], v9 offset:12288
    ds_read_b64_tr_b16 v[54:55], v9 offset:13312
    ds_read_b32 v13, v30
    s_waitcnt lgkmcnt(14)
    v_mfma_f32_32x32x16_bf16 v[96:111], v[56:59], v[220:223], v[96:111]
    ds_read_b64_tr_b16 v[56:57], v10 offset:12288
    ds_read_b64_tr_b16 v[58:59], v10 offset:13312
    v_mfma_f32_32x32x16_bf16 v[112:127], v[60:63], v[220:223], v[112:127]
    ds_read_b64_tr_b16 v[60:61], v11 offset:12288
    ds_read_b64_tr_b16 v[62:63], v11 offset:13312
    s_waitcnt lgkmcnt(13)
    v_mfma_f32_32x32x16_bf16 v[64:79], v[32:35], v[224:227], v[64:79]
    s_setprio 2
    s_waitcnt lgkmcnt(4)
    v_cmp_le_u32 vcc, 56, v13
    s_cbranch_vccz L_gs_149
L_gs_149_r:
    s_setprio 0
    s_waitcnt vmcnt(14)
    ds_add_u32 v28, v29
    ds_read_b64_tr_b16 v[32:33], v8 offset:16384
    ds_read_b64_tr_b16 v[34:35], v8 offset:17408
    s_add_u32 m0, s99, 69632
    s_add_u32 s60, s53, 229376
    buffer_load_dwordx4 v21, s[36:39], s60 offen lds
    v_mfma_f32_32x32x16_bf16 v[80:95], v[36:39], v[224:227], v[80:95]
    ds_read_b64_tr_b16 v[36:37], v9 offset:16384
    ds_read_b64_tr_b16 v[38:39], v9 offset:17408
    s_add_u32 m0, s99, 73728
    s_add_u32 s60, s53, 286720
    buffer_load_dwordx4 v21, s[36:39], s60 offen lds
    v_mfma_f32_32x32x16_bf16 v[96:111], v[40:43], v[224:227], v[96:111]
    ds_read_b64_tr_b16 v[40:41], v10 offset:16384
    ds_read_b64_tr_b16 v[42:43], v10 offset:17408
    v_mfma_f32_32x32x16_bf16 v[112:127], v[44:47], v[224:227], v[112:127]
    ds_read_b64_tr_b16 v[44:45], v11 offset:16384
    ds_read_b64_tr_b16 v[46:47], v11 offset:17408
    v_mfma_f32_32x32x16_bf16 v[64:79], v[48:51], v[228:231], v[64:79]
    ds_read_b64_tr_b16 v[48:49], v8 offset:20480
    ds_read_b64_tr_b16 v[50:51], v8 offset:21504
    v_mfma_f32_32x32x16_bf16 v[80:95], v[52:55], v[228:231], v[80:95]
    ds_read_b64_tr_b16 v[52:53], v9 offset:20480
    ds_read_b64_tr_b16 v[54:55], v9 offset:21504
    ds_read_b32 v13, v30
    s_waitcnt lgkmcnt(14)
    v_mfma_f32_32x32x16_bf16 v[96:111], v[56:59], v[228:231], v[96:111]
    ds_read_b64_tr_b16 v[56:57], v10 offset:20480
    ds_read_b64_tr_b16 v[58:59], v10 offset:21504
    v_mfma_f32_32x32x16_bf16 v[112:127], v[60:63], v[228:231], v[112:127]
    ds_read_b64_tr_b16 v[60:61], v11 offset:20480
    ds_read_b64_tr_b16 v[62:63], v11 offset:21504
    s_waitcnt lgkmcnt(13)
    v_mfma_f32_32x32x16_bf16 v[64:79], v[32:35], v[232:235], v[64:79]
    s_setprio 2
    s_waitcnt lgkmcnt(4)
    v_cmp_le_u32 vcc, 60, v13
    s_cbranch_vccz L_gs_150
L_gs_150_r:
L_pl_151:
    ds_read_b32 v13, v1 offset:16
    s_waitcnt lgkmcnt(0)
    v_cmp_le_u32 vcc, 2, v13
    s_cbranch_vccnz L_pld_152
    s_sub_u32 s70, s70, 1
    s_cbranch_scc1 L_pld_152_x
    s_sleep 1
    s_branch L_pl_151
L_pld_152_x:
    s_mov_b32 s70, 0
L_pld_152:
    s_setprio 0
    s_waitcnt vmcnt(14)
    ds_add_u32 v28, v29
    ds_read_b64_tr_b16 v[32:33], v8 offset:24576
    ds_read_b64_tr_b16 v[34:35], v8 offset:25600
    s_add_u32 m0, s68, 0
    s_add_u32 s60, s69, 74752
    buffer_load_dwordx4 v12, s[32:35], s60 offen sc1 lds
    s_add_u32 m0, s68, 8192
    s_add_u32 s60, s69, 10240
    buffer_load_dwordx4 v12, s[32:35], s60 offen sc1 lds
    v_mfma_f32_32x32x16_bf16 v[80:95], v[36:39], v[232:235], v[80:95]
    ds_read_b64_tr_b16 v[36:37], v9 offset:24576
    ds_read_b64_tr_b16 v[38:39], v9 offset:25600
    s_add_u32 m0, s68, 1024
    s_add_u32 s60, s69, 75776
    buffer_load_dwordx4 v12, s[32:35], s60 offen sc1 lds
    s_add_u32 m0, s68, 9216
    s_add_u32 s60, s69, 11264
    buffer_load_dwordx4 v12, s[32:35], s60 offen sc1 lds
    v_mfma_f32_32x32x16_bf16 v[96:111], v[40:43], v[232:235], v[96:111]
    ds_read_b64_tr_b16 v[40:41], v10 offset:24576
    ds_read_b64_tr_b16 v[42:43], v10 offset:25600
    s_setprio 2
    s_and_b32 s61, s58, 3
    v_lshlrev_b32 v22, 10, v0
    s_add_u32 s62, s59, 0
    s_and_b32 s62, s62, 7
    s_lshl_b32 s62, s62, 7
    s_lshl_b32 s63, s61, 2
    s_add_u32 s63, s63, s57
    s_mul_i32 s14, s63, 64
    s_mul_i32 s15, s63, 32
    s_add_u32 s15, s15, 256
    s_cmp_ge_u32 s63, 8
    s_cselect_b32 s15, s15, s14
    s_add_u32 s15, s15, 1024
    s_min_u32 s15, s15, 1728
    s_lshl_b32 s15, s15, 10
    s_add_u32 s15, s15, s62
    s_lshl_b32 s14, s63, 16
    s_add_u32 s14, s14, s62
    s_lshl_b32 s3, s63, 15
    s_add_u32 s3, s3, s62
    s_lshl_b32 s98, s57, 10
    s_add_u32 s98, s98, 159744
    s_setprio 0
    v_mfma_f32_32x32x16_bf16 v[112:127], v[44:47], v[232:235], v[112:127]
    ds_read_b64_tr_b16 v[44:45], v11 offset:24576
    ds_read_b64_tr_b16 v[46:47], v11 offset:25600
    s_add_u32 m0, s98, 0
    s_add_u32 s60, s14, 0
    s_mov_b64 exec, 0xff
    buffer_load_dword v22, s[40:43], s60 offen lds
    s_mov_b64 exec, -1
    v_mfma_f32_32x32x16_bf16 v[64:79], v[48:51], v[236:239], v[64:79]
    ds_read_b64_tr_b16 v[48:49], v8 offset:28672
    ds_read_b64_tr_b16 v[50:51], v8 offset:29696
    s_add_u32 m0, s98, 32
    s_add_u32 s60, s14, 8192
    s_mov_b64 exec, 0xff
    buffer_load_dword v22, s[40:43], s60 offen lds
    s_mov_b64 exec, -1
    v_mfma_f32_32x32x16_bf16 v[80:95], v[52:55], v[236:239], v[80:95]
    ds_read_b64_tr_b16 v[52:53], v9 offset:28672
    ds_read_b64_tr_b16 v[54:55], v9 offset:29696
    ds_read_b32 v13, v30
    s_add_u32 m0, s99, 77824
    s_add_u32 s60, s53, 344064
    buffer_load_dwordx4 v21, s[36:39], s60 offen lds
    v_mfma_f32_32x32x16_bf16 v[96:111], v[56:59], v[236:239], v[96:111]
    ds_read_b64_tr_b16 v[56:57], v10 offset:28672
    ds_read_b64_tr_b16 v[58:59], v10 offset:29696
    s_add_u32 m0, s99, 81920
    s_add_u32 s60, s53, 401408
    buffer_load_dwordx4 v21, s[36:39], s60 offen lds
    v_mfma_f32_32x32x16_bf16 v[112:127], v[60:63], v[236:239], v[112:127]
    ds_read_b64_tr_b16 v[60:61], v11 offset:28672
    ds_read_b64_tr_b16 v[62:63], v11 offset:29696
    s_waitcnt lgkmcnt(13)
    v_mfma_f32_32x32x16_bf16 v[64:79], v[32:35], v[240:243], v[64:79]
    s_setprio 2
    s_waitcnt lgkmcnt(4)
    v_cmp_le_u32 vcc, 64, v13
    s_cbranch_vccz L_gs_153
L_gs_153_r:
    s_setprio 0
    s_waitcnt vmcnt(20)
    ds_add_u32 v28, v29
    ds_read_b64_tr_b16 v[32:33], v8 offset:32768
    ds_read_b64_tr_b16 v[34:35], v8 offset:33792
    s_add_u32 m0, s68, 2048
    s_add_u32 s60, s69, 76800
    buffer_load_dwordx4 v12, s[32:35], s60 offen sc1 lds
    s_add_u32 m0, s68, 10240
    s_add_u32 s60, s69, 12288
    buffer_load_dwordx4 v12, s[32:35], s60 offen sc1 lds
    v_mfma_f32_32x32x16_bf16 v[80:95], v[36:39], v[240:243], v[80:95]
    ds_read_b64_tr_b16 v[36:37], v9 offset:32768
    ds_read_b64_tr_b16 v[38:39], v9 offset:33792
    s_add_u32 m0, s68, 3072
    s_add_u32 s60, s69, 77824
    buffer_load_dwordx4 v12, s[32:35], s60 offen sc1 lds
    v_mfma_f32_32x32x16_bf16 v[96:111], v[40:43], v[240:243], v[96:111]
    ds_read_b64_tr_b16 v[40:41], v10 offset:32768
    ds_read_b64_tr_b16 v[42:43], v10 offset:33792
    s_add_u32 m0, s68, 11264
    s_add_u32 s60, s69, 13312
    buffer_load_dwordx4 v12, s[32:35], s60 offen sc1 lds
    v_mfma_f32_32x32x16_bf16 v[112:127], v[44:47], v[240:243], v[112:127]
    ds_read_b64_tr_b16 v[44:45], v11 offset:32768
    ds_read_b64_tr_b16 v[46:47], v11 offset:33792
    s_add_u32 m0, s98, 64
    s_add_u32 s60, s14, 16384
    s_mov_b64 exec, 0xff
    buffer_load_dword v22, s[40:43], s60 offen lds
    s_mov_b64 exec, -1
    v_mfma_f32_32x32x16_bf16 v[64:79], v[48:51], v[244:247], v[64:79]
    ds_read_b64_tr_b16 v[48:49], v8 offset:36864
    ds_read_b64_tr_b16 v[50:51], v8 offset:37888
    s_add_u32 m0, s98, 96
    s_add_u32 s60, s14, 24576
    s_mov_b64 exec, 0xff
    buffer_load_dword v22, s[40:43], s60 offen lds
    s_mov_b64 exec, -1
    v_mfma_f32_32x32x16_bf16 v[80:95], v[52:55], v[244:247], v[80:95]
    ds_read_b64_tr_b16 v[52:53], v9 offset:36864
    ds_read_b64_tr_b16 v[54:55], v9 offset:37888
    ds_read_b32 v13, v30
    s_add_u32 m0, s99, 86016
    s_add_u32 s60, s54, 0
    buffer_load_dwordx4 v21, s[36:39], s60 offen lds
    s_waitcnt lgkmcnt(14)
    v_mfma_f32_32x32x16_bf16 v[96:111], v[56:59], v[244:247], v[96:111]
    ds_read_b64_tr_b16 v[56:57], v10 offset:36864
    ds_read_b64_tr_b16 v[58:59], v10 offset:37888
    s_add_u32 m0, s99, 90112
    s_add_u32 s60, s54, 57344
    buffer_load_dwordx4 v21, s[36:39], s60 offen lds
    v_mfma_f32_32x32x16_bf16 v[112:127], v[60:63], v[244:247], v[112:127]
    ds_read_b64_tr_b16 v[60:61], v11 offset:36864
    ds_read_b64_tr_b16 v[62:63], v11 offset:37888
    s_waitcnt lgkmcnt(13)
    v_mfma_f32_32x32x16_bf16 v[64:79], v[32:35], v[248:251], v[64:79]
    s_setprio 2
    s_waitcnt lgkmcnt(4)
    v_cmp_le_u32 vcc, 68, v13
    s_cbranch_vccz L_gs_154
L_gs_154_r:
    s_setprio 0
    s_waitcnt vmcnt(26)
    ds_add_u32 v28, v29
    ds_read_b64_tr_b16 v[32:33], v8 offset:40960
    ds_read_b64_tr_b16 v[34:35], v8 offset:41984
    s_add_u32 m0, s98, 128
    s_add_u32 s60, s14, 32768
    s_mov_b64 exec, 0xff
    buffer_load_dword v22, s[40:43], s60 offen lds
    s_mov_b64 exec, -1
    v_mfma_f32_32x32x16_bf16 v[80:95], v[36:39], v[248:251], v[80:95]
    ds_read_b64_tr_b16 v[36:37], v9 offset:40960
    ds_read_b64_tr_b16 v[38:39], v9 offset:41984
    ds_read_b32 v13, v30
    s_add_u32 m0, s99, 94208
    s_add_u32 s60, s54, 114688
    buffer_load_dwordx4 v21, s[36:39], s60 offen lds
    v_mfma_f32_32x32x16_bf16 v[96:111], v[40:43], v[248:251], v[96:111]
    ds_read_b64_tr_b16 v[40:41], v8 offset:45056
    ds_read_b64_tr_b16 v[42:43], v8 offset:46080
    s_add_u32 m0, s99, 98304
    s_add_u32 s60, s54, 172032
    buffer_load_dwordx4 v21, s[36:39], s60 offen lds
    v_mfma_f32_32x32x16_bf16 v[112:127], v[44:47], v[248:251], v[112:127]
    ds_read_b64_tr_b16 v[44:45], v9 offset:45056
    ds_read_b64_tr_b16 v[46:47], v9 offset:46080
    v_mfma_f32_32x32x16_bf16 v[64:79], v[48:51], v[252:255], v[64:79]
    s_setprio 2
    s_waitcnt lgkmcnt(4)
    v_cmp_le_u32 vcc, 72, v13
    s_cbranch_vccz L_gs_155
L_gs_155_r:
    s_setprio 0
    s_waitcnt vmcnt(27)
    ds_add_u32 v28, v29
    ds_read_b64_tr_b16 v[48:49], v8 offset:49152
    ds_read_b64_tr_b16 v[50:51], v8 offset:50176
    s_add_u32 m0, s98, 160
    s_add_u32 s60, s14, 40960
    s_mov_b64 exec, 0xff
    buffer_load_dword v22, s[40:43], s60 offen lds
    s_mov_b64 exec, -1
    v_mfma_f32_32x32x16_bf16 v[80:95], v[52:55], v[252:255], v[80:95]
    ds_read_b64_tr_b16 v[52:53], v9 offset:49152
    ds_read_b64_tr_b16 v[54:55], v9 offset:50176
    ds_read_b32 v13, v30
    s_add_u32 m0, s99, 102400
    s_add_u32 s60, s54, 229376
    buffer_load_dwordx4 v21, s[36:39], s60 offen lds
    v_mfma_f32_32x32x16_bf16 v[96:111], v[56:59], v[252:255], v[96:111]
    ds_read_b64_tr_b16 v[56:57], v8 offset:53248
    ds_read_b64_tr_b16 v[58:59], v8 offset:54272
    s_add_u32 m0, s99, 106496
    s_add_u32 s60, s54, 286720
    buffer_load_dwordx4 v21, s[36:39], s60 offen lds
    v_mfma_f32_32x32x16_bf16 v[112:127], v[60:63], v[252:255], v[112:127]
    ds_read_b64_tr_b16 v[60:61], v9 offset:53248
    ds_read_b64_tr_b16 v[62:63], v9 offset:54272
    s_setprio 2
    s_nop 7
    v_pk_mul_f32 v[2:3], v[64:65], v[26:27] op_sel_hi:[1,0]
    v_pk_mul_f32 v[4:5], v[66:67], v[26:27] op_sel_hi:[1,0]
    v_pk_mul_f32 v[6:7], v[68:69], v[26:27] op_sel_hi:[1,0]
    v_pk_mul_f32 v[14:15], v[70:71], v[26:27] op_sel_hi:[1,0]
    v_exp_f32 v2, v2
    v_exp_f32 v3, v3
    v_exp_f32 v4, v4
    v_exp_f32 v5, v5
    v_exp_f32 v6, v6
    v_exp_f32 v7, v7
    v_exp_f32 v14, v14
    v_exp_f32 v15, v15
    v_pk_mul_f32 v[64:65], v[64:65], v[72:73]
    v_pk_mul_f32 v[66:67], v[66:67], v[74:75]
    v_pk_mul_f32 v[68:69], v[68:69], v[76:77]
    v_pk_mul_f32 v[70:71], v[70:71], v[78:79]
    v_pk_fma_f32 v[2:3], v[2:3], v[26:27], v[26:27] op_sel:[0,1,1] op_sel_hi:[1,1,1]
    v_pk_fma_f32 v[4:5], v[4:5], v[26:27], v[26:27] op_sel:[0,1,1] op_sel_hi:[1,1,1]
    v_pk_fma_f32 v[6:7], v[6:7], v[26:27], v[26:27] op_sel:[0,1,1] op_sel_hi:[1,1,1]
    v_pk_fma_f32 v[14:15], v[14:15], v[26:27], v[26:27] op_sel:[0,1,1] op_sel_hi:[1,1,1]
    v_rcp_f32 v2, v2
    v_rcp_f32 v3, v3
    v_rcp_f32 v4, v4
    v_rcp_f32 v5, v5
    v_rcp_f32 v6, v6
    v_rcp_f32 v7, v7
    v_rcp_f32 v14, v14
    v_rcp_f32 v15, v15
    s_nop 0
    v_pk_mul_f32 v[64:65], v[64:65], v[2:3]
    v_pk_mul_f32 v[66:67], v[66:67], v[4:5]
    v_pk_mul_f32 v[68:69], v[68:69], v[6:7]
    v_pk_mul_f32 v[70:71], v[70:71], v[14:15]
    v_cvt_pk_bf16_f32 v72, v64, v65
    v_cvt_pk_bf16_f32 v73, v66, v67
    v_cvt_pk_bf16_f32 v74, v68, v69
    v_cvt_pk_bf16_f32 v75, v70, v71
    buffer_store_dwordx4 v[72:75], v12, s[32:35], s76 offen offset:0 sc1
    v_pk_mul_f32 v[2:3], v[80:81], v[26:27] op_sel_hi:[1,0]
    v_pk_mul_f32 v[4:5], v[82:83], v[26:27] op_sel_hi:[1,0]
    v_pk_mul_f32 v[6:7], v[84:85], v[26:27] op_sel_hi:[1,0]
    v_pk_mul_f32 v[14:15], v[86:87], v[26:27] op_sel_hi:[1,0]
    v_exp_f32 v2, v2
    v_exp_f32 v3, v3
    v_exp_f32 v4, v4
    v_exp_f32 v5, v5
    v_exp_f32 v6, v6
    v_exp_f32 v7, v7
    v_exp_f32 v14, v14
    v_exp_f32 v15, v15
    v_pk_mul_f32 v[80:81], v[80:81], v[88:89]
    v_pk_mul_f32 v[82:83], v[82:83], v[90:91]
    v_pk_mul_f32 v[84:85], v[84:85], v[92:93]
    v_pk_mul_f32 v[86:87], v[86:87], v[94:95]
    v_pk_fma_f32 v[2:3], v[2:3], v[26:27], v[26:27] op_sel:[0,1,1] op_sel_hi:[1,1,1]
    v_pk_fma_f32 v[4:5], v[4:5], v[26:27], v[26:27] op_sel:[0,1,1] op_sel_hi:[1,1,1]
    v_pk_fma_f32 v[6:7], v[6:7], v[26:27], v[26:27] op_sel:[0,1,1] op_sel_hi:[1,1,1]
    v_pk_fma_f32 v[14:15], v[14:15], v[26:27], v[26:27] op_sel:[0,1,1] op_sel_hi:[1,1,1]
    v_rcp_f32 v2, v2
    v_rcp_f32 v3, v3
    v_rcp_f32 v4, v4
    v_rcp_f32 v5, v5
    v_rcp_f32 v6, v6
    v_rcp_f32 v7, v7
    v_rcp_f32 v14, v14
    v_rcp_f32 v15, v15
    s_nop 0
    v_pk_mul_f32 v[80:81], v[80:81], v[2:3]
    v_pk_mul_f32 v[82:83], v[82:83], v[4:5]
    v_pk_mul_f32 v[84:85], v[84:85], v[6:7]
    v_pk_mul_f32 v[86:87], v[86:87], v[14:15]
    v_cvt_pk_bf16_f32 v88, v80, v81
    v_cvt_pk_bf16_f32 v89, v82, v83
    v_cvt_pk_bf16_f32 v90, v84, v85
    v_cvt_pk_bf16_f32 v91, v86, v87
    buffer_store_dwordx4 v[88:91], v12, s[32:35], s76 offen offset:1024 sc1
    v_pk_mul_f32 v[2:3], v[96:97], v[26:27] op_sel_hi:[1,0]
    v_pk_mul_f32 v[4:5], v[98:99], v[26:27] op_sel_hi:[1,0]
    v_pk_mul_f32 v[6:7], v[100:101], v[26:27] op_sel_hi:[1,0]
    v_pk_mul_f32 v[14:15], v[102:103], v[26:27] op_sel_hi:[1,0]
    v_exp_f32 v2, v2
    v_exp_f32 v3, v3
    v_exp_f32 v4, v4
    v_exp_f32 v5, v5
    v_exp_f32 v6, v6
    v_exp_f32 v7, v7
    v_exp_f32 v14, v14
    v_exp_f32 v15, v15
    v_pk_mul_f32 v[96:97], v[96:97], v[104:105]
    v_pk_mul_f32 v[98:99], v[98:99], v[106:107]
    v_pk_mul_f32 v[100:101], v[100:101], v[108:109]
    v_pk_mul_f32 v[102:103], v[102:103], v[110:111]
    v_pk_fma_f32 v[2:3], v[2:3], v[26:27], v[26:27] op_sel:[0,1,1] op_sel_hi:[1,1,1]
    v_pk_fma_f32 v[4:5], v[4:5], v[26:27], v[26:27] op_sel:[0,1,1] op_sel_hi:[1,1,1]
    v_pk_fma_f32 v[6:7], v[6:7], v[26:27], v[26:27] op_sel:[0,1,1] op_sel_hi:[1,1,1]
    v_pk_fma_f32 v[14:15], v[14:15], v[26:27], v[26:27] op_sel:[0,1,1] op_sel_hi:[1,1,1]
    v_rcp_f32 v2, v2
    v_rcp_f32 v3, v3
    v_rcp_f32 v4, v4
    v_rcp_f32 v5, v5
    v_rcp_f32 v6, v6
    v_rcp_f32 v7, v7
    v_rcp_f32 v14, v14
    v_rcp_f32 v15, v15
    s_nop 0
    v_pk_mul_f32 v[96:97], v[96:97], v[2:3]
    v_pk_mul_f32 v[98:99], v[98:99], v[4:5]
    v_pk_mul_f32 v[100:101], v[100:101], v[6:7]
    v_pk_mul_f32 v[102:103], v[102:103], v[14:15]
    v_cvt_pk_bf16_f32 v104, v96, v97
    v_cvt_pk_bf16_f32 v105, v98, v99
    v_cvt_pk_bf16_f32 v106, v100, v101
    v_cvt_pk_bf16_f32 v107, v102, v103
    buffer_store_dwordx4 v[104:107], v12, s[32:35], s76 offen offset:2048 sc1
    v_pk_mul_f32 v[2:3], v[112:113], v[26:27] op_sel_hi:[1,0]
    v_pk_mul_f32 v[4:5], v[114:115], v[26:27] op_sel_hi:[1,0]
    v_pk_mul_f32 v[6:7], v[116:117], v[26:27] op_sel_hi:[1,0]
    v_pk_mul_f32 v[14:15], v[118:119], v[26:27] op_sel_hi:[1,0]
    v_exp_f32 v2, v2
    v_exp_f32 v3, v3
    v_exp_f32 v4, v4
    v_exp_f32 v5, v5
    v_exp_f32 v6, v6
    v_exp_f32 v7, v7
    v_exp_f32 v14, v14
    v_exp_f32 v15, v15
    v_pk_mul_f32 v[112:113], v[112:113], v[120:121]
    v_pk_mul_f32 v[114:115], v[114:115], v[122:123]
    v_pk_mul_f32 v[116:117], v[116:117], v[124:125]
    v_pk_mul_f32 v[118:119], v[118:119], v[126:127]
    v_pk_fma_f32 v[2:3], v[2:3], v[26:27], v[26:27] op_sel:[0,1,1] op_sel_hi:[1,1,1]
    v_pk_fma_f32 v[4:5], v[4:5], v[26:27], v[26:27] op_sel:[0,1,1] op_sel_hi:[1,1,1]
    v_pk_fma_f32 v[6:7], v[6:7], v[26:27], v[26:27] op_sel:[0,1,1] op_sel_hi:[1,1,1]
    v_pk_fma_f32 v[14:15], v[14:15], v[26:27], v[26:27] op_sel:[0,1,1] op_sel_hi:[1,1,1]
    v_rcp_f32 v2, v2
    v_rcp_f32 v3, v3
    v_rcp_f32 v4, v4
    v_rcp_f32 v5, v5
    v_rcp_f32 v6, v6
    v_rcp_f32 v7, v7
    v_rcp_f32 v14, v14
    v_rcp_f32 v15, v15
    s_nop 0
    v_pk_mul_f32 v[112:113], v[112:113], v[2:3]
    v_pk_mul_f32 v[114:115], v[114:115], v[4:5]
    v_pk_mul_f32 v[116:117], v[116:117], v[6:7]
    v_pk_mul_f32 v[118:119], v[118:119], v[14:15]
    v_cvt_pk_bf16_f32 v120, v112, v113
    v_cvt_pk_bf16_f32 v121, v114, v115
    v_cvt_pk_bf16_f32 v122, v116, v117
    v_cvt_pk_bf16_f32 v123, v118, v119
    buffer_store_dwordx4 v[120:123], v12, s[32:35], s76 offen offset:3072 sc1
    s_setprio 0
    v_mfma_f32_32x32x16_bf16 v[64:79], v[32:35], v[128:131], 0
    s_setprio 2
    s_waitcnt lgkmcnt(4)
    v_cmp_le_u32 vcc, 76, v13
    s_cbranch_vccz L_gs_156
L_gs_156_r:
    s_setprio 0
    s_waitcnt vmcnt(32)
    ds_add_u32 v28, v29
    s_waitcnt vmcnt(14)
    s_mov_b64 exec, 1
    ds_add_u32 v1, v29 offset:32
    s_mov_b64 exec, -1
    ds_read_b64_tr_b16 v[32:33], v8 offset:57344
    ds_read_b64_tr_b16 v[34:35], v8 offset:58368
    s_add_u32 m0, s98, 192
    s_add_u32 s60, s14, 49152
    s_mov_b64 exec, 0xff
    buffer_load_dword v22, s[40:43], s60 offen lds
    s_mov_b64 exec, -1
    v_mfma_f32_32x32x16_bf16 v[80:95], v[36:39], v[128:131], 0
    ds_read_b64_tr_b16 v[36:37], v9 offset:57344
    ds_read_b64_tr_b16 v[38:39], v9 offset:58368
    ds_read_b32 v13, v30
    s_add_u32 m0, s99, 110592
    s_add_u32 s60, s54, 344064
    buffer_load_dwordx4 v21, s[36:39], s60 offen lds
    v_mfma_f32_32x32x16_bf16 v[64:79], v[40:43], v[132:135], v[64:79]
    ds_read_b64_tr_b16 v[40:41], v8 offset:61440
    ds_read_b64_tr_b16 v[42:43], v8 offset:62464
    s_add_u32 m0, s99, 114688
    s_add_u32 s60, s54, 401408
    buffer_load_dwordx4 v21, s[36:39], s60 offen lds
    v_mfma_f32_32x32x16_bf16 v[80:95], v[44:47], v[132:135], v[80:95]
    ds_read_b64_tr_b16 v[44:45], v9 offset:61440
    ds_read_b64_tr_b16 v[46:47], v9 offset:62464
    v_mfma_f32_32x32x16_bf16 v[64:79], v[48:51], v[136:139], v[64:79]
    s_setprio 2
    s_waitcnt lgkmcnt(4)
    v_cmp_le_u32 vcc, 80, v13
    s_cbranch_vccz L_gs_157
L_gs_157_r:
    s_setprio 0
    ds_add_u32 v28, v29
    s_waitcnt vmcnt(3)
    s_setprio 2
    s_lshl_b32 s60, s80, 2
    s_add_u32 s60, s60, s57
    s_lshl_b32 s60, s60, 3
    v_mov_b32 v2, s60
    v_mov_b32 v4, s72
    v_mov_b32 v5, s73
    s_mov_b32 s87, 159744
    s_mov_b64 exec, 1
    buffer_store_dwordx2 v[4:5], v2, s[32:35], s87 offen sc1
    s_mov_b64 exec, -1
    s_setprio 0
    ds_read_b64_tr_b16 v[48:49], v16 offset:0
    ds_read_b64_tr_b16 v[50:51], v16 offset:1024
    s_add_u32 m0, s98, 224
    s_add_u32 s60, s14, 57344
    s_mov_b64 exec, 0xff
    buffer_load_dword v22, s[40:43], s60 offen lds
    s_mov_b64 exec, -1
    v_mfma_f32_32x32x16_bf16 v[80:95], v[52:55], v[136:139], v[80:95]
    ds_read_b64_tr_b16 v[52:53], v17 offset:0
    ds_read_b64_tr_b16 v[54:55], v17 offset:1024
    ds_read_b32 v13, v30
    s_add_u32 m0, s99, 118784
    s_add_u32 s60, s55, 0
    buffer_load_dwordx4 v21, s[36:39], s60 offen lds
    v_mfma_f32_32x32x16_bf16 v[64:79], v[56:59], v[140:143], v[64:79]
    ds_read_b64_tr_b16 v[56:57], v16 offset:4096
    ds_read_b64_tr_b16 v[58:59], v16 offset:5120
    s_add_u32 m0, s99, 122880
    s_add_u32 s60, s55, 57344
    buffer_load_dwordx4 v21, s[36:39], s60 offen lds
    v_mfma_f32_32x32x16_bf16 v[80:95], v[60:63], v[140:143], v[80:95]
    ds_read_b64_tr_b16 v[60:61], v17 offset:4096
    ds_read_b64_tr_b16 v[62:63], v17 offset:5120
    v_mfma_f32_32x32x16_bf16 v[64:79], v[32:35], v[144:147], v[64:79]
    s_setprio 2
    s_waitcnt lgkmcnt(4)
    v_cmp_le_u32 vcc, 84, v13
    s_cbranch_vccz L_gs_158
L_gs_158_r:
    s_setprio 0
    ds_add_u32 v28, v29
    ds_read_b64_tr_b16 v[32:33], v16 offset:8192
    ds_read_b64_tr_b16 v[34:35], v16 offset:9216
    s_add_u32 m0, s98, 256
    s_add_u32 s60, s15, 0
    s_mov_b64 exec, 0xff
    buffer_load_dword v22, s[40:43], s60 offen lds
    s_mov_b64 exec, -1
    v_mfma_f32_32x32x16_bf16 v[80:95], v[36:39], v[144:147], v[80:95]
    ds_read_b64_tr_b16 v[36:37], v17 offset:8192
    ds_read_b64_tr_b16 v[38:39], v17 offset:9216
    ds_read_b32 v13, v30
    s_add_u32 m0, s99, 126976
    s_add_u32 s60, s55, 114688
    buffer_load_dwordx4 v21, s[36:39], s60 offen lds
    v_mfma_f32_32x32x16_bf16 v[64:79], v[40:43], v[148:151], v[64:79]
    ds_read_b64_tr_b16 v[40:41], v16 offset:12288
    ds_read_b64_tr_b16 v[42:43], v16 offset:13312
    s_add_u32 m0, s99, 131072
    s_add_u32 s60, s55, 172032
    buffer_load_dwordx4 v21, s[36:39], s60 offen lds
    v_mfma_f32_32x32x16_bf16 v[80:95], v[44:47], v[148:151], v[80:95]
    ds_read_b64_tr_b16 v[44:45], v17 offset:12288
    ds_read_b64_tr_b16 v[46:47], v17 offset:13312
    v_mfma_f32_32x32x16_bf16 v[64:79], v[48:51], v[152:155], v[64:79]
    s_setprio 2
    s_waitcnt lgkmcnt(4)
    v_cmp_le_u32 vcc, 88, v13
    s_cbranch_vccz L_gs_159
L_gs_159_r:
    s_setprio 0
    ds_add_u32 v28, v29
    ds_read_b64_tr_b16 v[48:49], v16 offset:16384
    ds_read_b64_tr_b16 v[50:51], v16 offset:17408
    s_add_u32 m0, s98, 288
    s_add_u32 s60, s15, 8192
    s_mov_b64 exec, 0xff
    buffer_load_dword v22, s[40:43], s60 offen lds
    s_mov_b64 exec, -1
    v_mfma_f32_32x32x16_bf16 v[80:95], v[52:55], v[152:155], v[80:95]
    ds_read_b64_tr_b16 v[52:53], v17 offset:16384
    ds_read_b64_tr_b16 v[54:55], v17 offset:17408
    ds_read_b32 v13, v30
    s_add_u32 m0, s99, 135168
    s_add_u32 s60, s55, 229376
    buffer_load_dwordx4 v21, s[36:39], s60 offen lds
    v_mfma_f32_32x32x16_bf16 v[64:79], v[56:59], v[156:159], v[64:79]
    ds_read_b64_tr_b16 v[56:57], v16 offset:20480
    ds_read_b64_tr_b16 v[58:59], v16 offset:21504
    s_add_u32 m0, s99, 139264
    s_add_u32 s60, s55, 286720
    buffer_load_dwordx4 v21, s[36:39], s60 offen lds
    v_mfma_f32_32x32x16_bf16 v[80:95], v[60:63], v[156:159], v[80:95]
    ds_read_b64_tr_b16 v[60:61], v17 offset:20480
    ds_read_b64_tr_b16 v[62:63], v17 offset:21504
    v_mfma_f32_32x32x16_bf16 v[64:79], v[32:35], v[160:163], v[64:79]
    s_setprio 2
    s_waitcnt lgkmcnt(4)
    v_cmp_le_u32 vcc, 92, v13
    s_cbranch_vccz L_gs_160
L_gs_160_r:
    s_setprio 0
    ds_add_u32 v28, v29
    ds_read_b64_tr_b16 v[32:33], v8 offset:0
    ds_read_b64_tr_b16 v[34:35], v8 offset:1024
    s_add_u32 m0, s98, 320
    s_add_u32 s60, s15, 16384
    s_mov_b64 exec, 0xff
    buffer_load_dword v22, s[40:43], s60 offen lds
    s_mov_b64 exec, -1
    v_mfma_f32_32x32x16_bf16 v[80:95], v[36:39], v[160:163], v[80:95]
    ds_read_b64_tr_b16 v[36:37], v9 offset:0
    ds_read_b64_tr_b16 v[38:39], v9 offset:1024
    ds_read_b32 v13, v30
    s_add_u32 m0, s99, 143360
    s_add_u32 s60, s55, 344064
    buffer_load_dwordx4 v21, s[36:39], s60 offen lds
    v_mfma_f32_32x32x16_bf16 v[64:79], v[40:43], v[164:167], v[64:79]
    ds_read_b64_tr_b16 v[40:41], v8 offset:4096
    ds_read_b64_tr_b16 v[42:43], v8 offset:5120
    s_add_u32 m0, s99, 147456
    s_add_u32 s60, s55, 401408
    buffer_load_dwordx4 v21, s[36:39], s60 offen lds
    v_mfma_f32_32x32x16_bf16 v[80:95], v[44:47], v[164:167], v[80:95]
    ds_read_b64_tr_b16 v[44:45], v9 offset:4096
    ds_read_b64_tr_b16 v[46:47], v9 offset:5120
    v_mfma_f32_32x32x16_bf16 v[64:79], v[48:51], v[168:171], v[64:79]
    s_setprio 2
    s_waitcnt lgkmcnt(4)
    v_cmp_le_u32 vcc, 96, v13
    s_cbranch_vccz L_gs_161
L_gs_161_r:
    s_setprio 0
    ds_add_u32 v28, v29
    ds_read_b64_tr_b16 v[48:49], v8 offset:8192
    ds_read_b64_tr_b16 v[50:51], v8 offset:9216
    s_add_u32 m0, s98, 352
    s_add_u32 s60, s15, 24576
    s_mov_b64 exec, 0xff
    buffer_load_dword v22, s[40:43], s60 offen lds
    s_mov_b64 exec, -1
    v_mfma_f32_32x32x16_bf16 v[80:95], v[52:55], v[168:171], v[80:95]
    ds_read_b64_tr_b16 v[52:53], v9 offset:8192
    ds_read_b64_tr_b16 v[54:55], v9 offset:9216
    ds_read_b32 v13, v30
    v_mfma_f32_32x32x16_bf16 v[64:79], v[56:59], v[172:175], v[64:79]
    ds_read_b64_tr_b16 v[56:57], v8 offset:12288
    ds_read_b64_tr_b16 v[58:59], v8 offset:13312
    v_mfma_f32_32x32x16_bf16 v[80:95], v[60:63], v[172:175], v[80:95]
    ds_read_b64_tr_b16 v[60:61], v9 offset:12288
    ds_read_b64_tr_b16 v[62:63], v9 offset:13312
    v_mfma_f32_32x32x16_bf16 v[64:79], v[32:35], v[176:179], v[64:79]
    s_setprio 2
    s_waitcnt lgkmcnt(4)
    v_cmp_le_u32 vcc, 100, v13
    s_cbranch_vccz L_gs_162
L_gs_162_r:
    s_setprio 0
    ds_add_u32 v28, v29
    ds_read_b64_tr_b16 v[32:33], v8 offset:16384
    ds_read_b64_tr_b16 v[34:35], v8 offset:17408
    s_add_u32 m0, s98, 384
    s_add_u32 s60, s15, 32768
    s_mov_b64 exec, 0xff
    buffer_load_dword v22, s[40:43], s60 offen lds
    s_mov_b64 exec, -1
    v_mfma_f32_32x32x16_bf16 v[80:95], v[36:39], v[176:179], v[80:95]
    ds_read_b64_tr_b16 v[36:37], v9 offset:16384
    ds_read_b64_tr_b16 v[38:39], v9 offset:17408
    ds_read_b32 v13, v30
    v_mfma_f32_32x32x16_bf16 v[64:79], v[40:43], v[180:183], v[64:79]
    ds_read_b64_tr_b16 v[40:41], v8 offset:20480
    ds_read_b64_tr_b16 v[42:43], v8 offset:21504
    v_mfma_f32_32x32x16_bf16 v[80:95], v[44:47], v[180:183], v[80:95]
    ds_read_b64_tr_b16 v[44:45], v9 offset:20480
    ds_read_b64_tr_b16 v[46:47], v9 offset:21504
    v_mfma_f32_32x32x16_bf16 v[64:79], v[48:51], v[184:187], v[64:79]
    s_setprio 2
    s_waitcnt lgkmcnt(4)
    v_cmp_le_u32 vcc, 104, v13
    s_cbranch_vccz L_gs_163
L_gs_163_r:
    s_setprio 0
    ds_add_u32 v28, v29
    ds_read_b64_tr_b16 v[48:49], v8 offset:24576
    ds_read_b64_tr_b16 v[50:51], v8 offset:25600
    s_add_u32 m0, s98, 416
    s_add_u32 s60, s15, 40960
    s_mov_b64 exec, 0xff
    buffer_load_dword v22, s[40:43], s60 offen lds
    s_mov_b64 exec, -1
    v_mfma_f32_32x32x16_bf16 v[80:95], v[52:55], v[184:187], v[80:95]
    ds_read_b64_tr_b16 v[52:53], v9 offset:24576
    ds_read_b64_tr_b16 v[54:55], v9 offset:25600
    ds_read_b32 v13, v30
    v_mfma_f32_32x32x16_bf16 v[64:79], v[56:59], v[188:191], v[64:79]
    ds_read_b64_tr_b16 v[56:57], v8 offset:28672
    ds_read_b64_tr_b16 v[58:59], v8 offset:29696
    v_mfma_f32_32x32x16_bf16 v[80:95], v[60:63], v[188:191], v[80:95]
    ds_read_b64_tr_b16 v[60:61], v9 offset:28672
    ds_read_b64_tr_b16 v[62:63], v9 offset:29696
    v_mfma_f32_32x32x16_bf16 v[64:79], v[32:35], v[192:195], v[64:79]
    s_setprio 2
    s_waitcnt lgkmcnt(4)
    v_cmp_le_u32 vcc, 108, v13
    s_cbranch_vccz L_gs_164
L_gs_164_r:
    s_setprio 0
    s_waitcnt vmcnt(16)
    ds_add_u32 v28, v29
    ds_read_b64_tr_b16 v[32:33], v8 offset:32768
    ds_read_b64_tr_b16 v[34:35], v8 offset:33792
    s_add_u32 m0, s98, 448
    s_add_u32 s60, s15, 49152
    s_mov_b64 exec, 0xff
    buffer_load_dword v22, s[40:43], s60 offen lds
    s_mov_b64 exec, -1
    v_mfma_f32_32x32x16_bf16 v[80:95], v[36:39], v[192:195], v[80:95]
    ds_read_b64_tr_b16 v[36:37], v9 offset:32768
    ds_read_b64_tr_b16 v[38:39], v9 offset:33792
    ds_read_b32 v13, v30
    v_mfma_f32_32x32x16_bf16 v[64:79], v[40:43], v[196:199], v[64:79]
    ds_read_b64_tr_b16 v[40:41], v8 offset:36864
    ds_read_b64_tr_b16 v[42:43], v8 offset:37888
    v_mfma_f32_32x32x16_bf16 v[80:95], v[44:47], v[196:199], v[80:95]
    ds_read_b64_tr_b16 v[44:45], v9 offset:36864
    ds_read_b64_tr_b16 v[46:47], v9 offset:37888
    v_mfma_f32_32x32x16_bf16 v[64:79], v[48:51], v[200:203], v[64:79]
    s_setprio 2
    s_waitcnt lgkmcnt(4)
    v_cmp_le_u32 vcc, 112, v13
    s_cbranch_vccz L_gs_165
L_gs_165_r:
    s_setprio 0
    s_waitcnt vmcnt(13)
    ds_add_u32 v28, v29
    ds_read_b64_tr_b16 v[48:49], v8 offset:40960
    ds_read_b64_tr_b16 v[50:51], v8 offset:41984
    s_add_u32 m0, s98, 480
    s_add_u32 s60, s15, 57344
    s_mov_b64 exec, 0xff
    buffer_load_dword v22, s[40:43], s60 offen lds
    s_mov_b64 exec, -1
    v_mfma_f32_32x32x16_bf16 v[80:95], v[52:55], v[200:203], v[80:95]
    ds_read_b64_tr_b16 v[52:53], v9 offset:40960
    ds_read_b64_tr_b16 v[54:55], v9 offset:41984
    ds_read_b32 v13, v30
    v_mfma_f32_32x32x16_bf16 v[64:79], v[56:59], v[204:207], v[64:79]
    ds_read_b64_tr_b16 v[56:57], v8 offset:45056
    ds_read_b64_tr_b16 v[58:59], v8 offset:46080
    v_mfma_f32_32x32x16_bf16 v[80:95], v[60:63], v[204:207], v[80:95]
    ds_read_b64_tr_b16 v[60:61], v9 offset:45056
    ds_read_b64_tr_b16 v[62:63], v9 offset:46080
    v_mfma_f32_32x32x16_bf16 v[64:79], v[32:35], v[208:211], v[64:79]
    s_setprio 2
    s_waitcnt lgkmcnt(4)
    v_cmp_le_u32 vcc, 116, v13
    s_cbranch_vccz L_gs_166
L_gs_166_r:
    s_setprio 0
    s_waitcnt vmcnt(11)
    ds_add_u32 v28, v29
    s_setprio 2
    v_bfe_u32 v2, v0, 1, 2
    v_lshlrev_b32 v2, 4, v2
    v_and_b32 v3, 1, v0
    v_add_u32 v2, v2, v3
    s_lshl_b32 s60, s58, 6
    s_lshl_b32 s61, s57, 2
    s_add_u32 s60, s60, s61
    s_lshr_b32 s61, s59, 3
    s_lshl_b32 s61, s61, 1
    s_add_u32 s60, s60, s61
    v_add_u32 v2, s60, v2
    v_lshlrev_b32 v24, 3, v2
    s_mov_b32 s87, 159744
    s_setprio 0
    buffer_load_dwordx2 v[14:15], v24, s[32:35], s87 offen sc1
    ds_read_b64_tr_b16 v[32:33], v8 offset:49152
    ds_read_b64_tr_b16 v[34:35], v8 offset:50176
    s_add_u32 m0, s98, 512
    s_add_u32 s60, s3, 0
    s_mov_b64 exec, 0xff
    buffer_load_dword v22, s[44:47], s60 offen lds
    s_mov_b64 exec, -1
    v_mfma_f32_32x32x16_bf16 v[80:95], v[36:39], v[208:211], v[80:95]
    ds_read_b64_tr_b16 v[36:37], v9 offset:49152
    ds_read_b64_tr_b16 v[38:39], v9 offset:50176
    ds_read_b32 v13, v30
    v_mfma_f32_32x32x16_bf16 v[64:79], v[40:43], v[212:215], v[64:79]
    ds_read_b64_tr_b16 v[40:41], v8 offset:53248
    ds_read_b64_tr_b16 v[42:43], v8 offset:54272
    v_mfma_f32_32x32x16_bf16 v[80:95], v[44:47], v[212:215], v[80:95]
    ds_read_b64_tr_b16 v[44:45], v9 offset:53248
    ds_read_b64_tr_b16 v[46:47], v9 offset:54272
    v_mfma_f32_32x32x16_bf16 v[64:79], v[48:51], v[216:219], v[64:79]
    s_setprio 2
    s_waitcnt lgkmcnt(4)
    v_cmp_le_u32 vcc, 120, v13
    s_cbranch_vccz L_gs_167
L_gs_167_r:
    s_setprio 0
    s_waitcnt vmcnt(10)
    ds_add_u32 v28, v29
    ds_read_b64_tr_b16 v[48:49], v8 offset:57344
    ds_read_b64_tr_b16 v[50:51], v8 offset:58368
    s_add_u32 m0, s98, 544
    s_add_u32 s60, s3, 8192
    s_mov_b64 exec, 0xff
    buffer_load_dword v22, s[44:47], s60 offen lds
    s_mov_b64 exec, -1
    v_mfma_f32_32x32x16_bf16 v[80:95], v[52:55], v[216:219], v[80:95]
    ds_read_b64_tr_b16 v[52:53], v9 offset:57344
    ds_read_b64_tr_b16 v[54:55], v9 offset:58368
    ds_read_b32 v13, v30
    v_mfma_f32_32x32x16_bf16 v[64:79], v[56:59], v[220:223], v[64:79]
    ds_read_b64_tr_b16 v[56:57], v8 offset:61440
    ds_read_b64_tr_b16 v[58:59], v8 offset:62464
    v_mfma_f32_32x32x16_bf16 v[80:95], v[60:63], v[220:223], v[80:95]
    ds_read_b64_tr_b16 v[60:61], v9 offset:61440
    ds_read_b64_tr_b16 v[62:63], v9 offset:62464
    v_mfma_f32_32x32x16_bf16 v[64:79], v[32:35], v[224:227], v[64:79]
    s_setprio 2
    s_waitcnt lgkmcnt(4)
    v_cmp_le_u32 vcc, 124, v13
    s_cbranch_vccz L_gs_168
L_gs_168_r:
    s_setprio 0
    s_waitcnt vmcnt(8)
    ds_add_u32 v28, v29
    ds_read_b64_tr_b16 v[32:33], v16 offset:0
    ds_read_b64_tr_b16 v[34:35], v16 offset:1024
    s_add_u32 m0, s98, 576
    s_add_u32 s60, s3, 16384
    s_mov_b64 exec, 0xff
    buffer_load_dword v22, s[44:47], s60 offen lds
    s_mov_b64 exec, -1
    v_mfma_f32_32x32x16_bf16 v[80:95], v[36:39], v[224:227], v[80:95]
    ds_read_b64_tr_b16 v[36:37], v17 offset:0
    ds_read_b64_tr_b16 v[38:39], v17 offset:1024
    ds_read_b32 v13, v30
    v_mfma_f32_32x32x16_bf16 v[64:79], v[40:43], v[228:231], v[64:79]
    ds_read_b64_tr_b16 v[40:41], v16 offset:4096
    ds_read_b64_tr_b16 v[42:43], v16 offset:5120
    v_mfma_f32_32x32x16_bf16 v[80:95], v[44:47], v[228:231], v[80:95]
    ds_read_b64_tr_b16 v[44:45], v17 offset:4096
    ds_read_b64_tr_b16 v[46:47], v17 offset:5120
    v_mfma_f32_32x32x16_bf16 v[64:79], v[48:51], v[232:235], v[64:79]
    s_setprio 2
    s_waitcnt lgkmcnt(4)
    v_cmp_le_u32 vcc, 128, v13
    s_cbranch_vccz L_gs_169
L_gs_169_r:
L_pl_170:
    ds_read_b32 v13, v1 offset:16
    s_waitcnt lgkmcnt(0)
    v_cmp_le_u32 vcc, 3, v13
    s_cbranch_vccnz L_pld_171
    s_sub_u32 s70, s70, 1
    s_cbranch_scc1 L_pld_171_x
    s_sleep 1
    s_branch L_pl_170
L_pld_171_x:
    s_mov_b32 s70, 0
L_pld_171:
    s_setprio 0
    ds_read_b64_tr_b16 v[48:49], v16 offset:8192
    ds_read_b64_tr_b16 v[50:51], v16 offset:9216
    s_add_u32 m0, s68, 4096
    s_add_u32 s60, s69, 78848
    buffer_load_dwordx4 v12, s[32:35], s60 offen sc1 lds
    v_mfma_f32_32x32x16_bf16 v[80:95], v[52:55], v[232:235], v[80:95]
    ds_read_b64_tr_b16 v[52:53], v17 offset:8192
    ds_read_b64_tr_b16 v[54:55], v17 offset:9216
    s_add_u32 m0, s68, 12288
    s_add_u32 s60, s69, 14336
    buffer_load_dwordx4 v12, s[32:35], s60 offen sc1 lds
    v_mfma_f32_32x32x16_bf16 v[64:79], v[56:59], v[236:239], v[64:79]
    ds_read_b64_tr_b16 v[56:57], v16 offset:12288
    ds_read_b64_tr_b16 v[58:59], v16 offset:13312
    s_add_u32 m0, s68, 5120
    s_add_u32 s60, s69, 79872
    buffer_load_dwordx4 v12, s[32:35], s60 offen sc1 lds
    v_mfma_f32_32x32x16_bf16 v[80:95], v[60:63], v[236:239], v[80:95]
    ds_read_b64_tr_b16 v[60:61], v17 offset:12288
    ds_read_b64_tr_b16 v[62:63], v17 offset:13312
    s_add_u32 m0, s68, 13312
    s_add_u32 s60, s69, 15360
    buffer_load_dwordx4 v12, s[32:35], s60 offen sc1 lds
    v_mfma_f32_32x32x16_bf16 v[64:79], v[32:35], v[240:243], v[64:79]
    s_add_u32 m0, s98, 608
    s_add_u32 s60, s3, 24576
    s_mov_b64 exec, 0xff
    buffer_load_dword v22, s[44:47], s60 offen lds
    s_mov_b64 exec, -1
    v_mfma_f32_32x32x16_bf16 v[80:95], v[36:39], v[240:243], v[80:95]
    v_mfma_f32_32x32x16_bf16 v[64:79], v[40:43], v[244:247], v[64:79]
    v_mfma_f32_32x32x16_bf16 v[80:95], v[44:47], v[244:247], v[80:95]
    s_waitcnt lgkmcnt(4)
    v_mfma_f32_32x32x16_bf16 v[64:79], v[48:51], v[248:251], v[64:79]
    v_mfma_f32_32x32x16_bf16 v[80:95], v[52:55], v[248:251], v[80:95]
    s_waitcnt lgkmcnt(0)
    v_mfma_f32_32x32x16_bf16 v[64:79], v[56:59], v[252:255], v[64:79]
    v_mfma_f32_32x32x16_bf16 v[80:95], v[60:63], v[252:255], v[80:95]
    s_add_u32 m0, s68, 6144
    s_add_u32 s60, s69, 80896
    buffer_load_dwordx4 v12, s[32:35], s60 offen sc1 lds
    ds_add_u32 v28, v29
    s_setprio 2
    v_lshrrev_b32 v2, 3, v0
    v_bfe_u32 v3, v0, 4, 1
    v_lshlrev_b32 v3, 2, v3
    v_and_b32 v4, 7, v0
    v_xor_b32 v3, v3, v4
    v_lshlrev_b32 v2, 10, v2
    v_lshl_add_u32 v2, v3, 4, v2
    s_add_u32 s60, s59, 0
    s_and_b32 s60, s60, 7
    s_lshl_b32 s60, s60, 7
    v_add_u32 v20, s60, v2
    v_add_u32 v21, 7168, v20
    s_mul_i32 s74, s57, 65536
    s_mul_i32 s75, s57, 32768
    s_mul_i32 s68, s57, 65536
    s_mul_i32 s99, s57, 32768
    s_mul_i32 s71, s57, 16384
    s_add_u32 s71, s71, 69632
    s_lshl_b32 s64, s58, 2
    s_lshr_b32 s60, s59, 3
    s_lshl_b32 s60, s60, 1
    s_add_u32 s64, s64, s60
    v_and_b32 v16, 31, v0
    v_lshlrev_b32 v16, 10, v16
    v_lshrrev_b32 v3, 5, v0
    v_lshl_add_u32 v16, v3, 4, v16
    s_lshr_b32 s60, s57, 1
    s_add_u32 s60, s60, s64
    s_lshl_b32 s60, s60, 15
    s_add_u32 s61, s59, 0
    s_and_b32 s61, s61, 7
    s_lshl_b32 s61, s61, 7
    s_add_u32 s65, s60, s61
    s_and_b32 s61, s57, 1
    s_lshl_b32 s61, s61, 6
    s_add_u32 s65, s65, s61
    v_bfe_u32 v2, v0, 2, 2
    v_lshrrev_b32 v3, 5, v0
    v_lshl_add_u32 v3, v3, 2, v2
    v_lshlrev_b32 v3, 7, v3
    v_lshrrev_b32 v2, 1, v2
    v_lshl_add_u32 v3, v2, 6, v3
    v_bfe_u32 v2, v0, 4, 1
    v_lshl_add_u32 v3, v2, 5, v3
    v_and_b32 v2, 3, v0
    v_lshl_add_u32 v3, v2, 3, v3
    v_xor_b32 v3, s61, v3
    v_add_u32 v8, s71, v3
    v_xor_b32 v9, 64, v8
    s_lshr_b32 s60, s57, 1
    s_mul_i32 s61, s60, 114688
    v_add_u32 v22, s61, v12
    s_sub_u32 s61, 114688, s61
    v_add_u32 v17, s61, v12
    s_lshl_b32 s61, s60, 15
    v_add_u32 v23, s61, v12
    s_sub_u32 s61, 32768, s61
    v_add_u32 v18, s61, v12
    s_mul_i32 s98, s64, 114688
    s_add_u32 s98, s98, 1048576
    s_mul_i32 s60, s57, 6144
    s_add_u32 s3, s98, s60
    s_mul_i32 s60, s57, 8192
    s_add_u32 s98, s98, s60
    s_lshl_b32 s77, s64, 15
    s_mul_i32 s60, s57, 2048
    s_add_u32 s77, s77, s60
    s_add_u32 s77, s77, 9437184
L_pl_172:
    ds_read_b32 v13, v30 offset:0
    s_waitcnt lgkmcnt(0)
    v_cmp_le_u32 vcc, 132, v13
    s_cbranch_vccnz L_pld_173
    s_sub_u32 s70, s70, 1
    s_cbranch_scc1 L_pld_173_x
    s_sleep 1
    s_branch L_pl_172
L_pld_173_x:
    s_mov_b32 s70, 0
L_pld_173:
    s_waitcnt vmcnt(9)
    v_cmp_eq_u32 vcc, s72, v14
    v_cmp_eq_u32 s[78:79], s73, v15
    s_and_b64 vcc, vcc, s[78:79]
    s_cmp_eq_u64 vcc, -1
    s_cbranch_scc1 L_fh_174
    s_mov_b32 s87, 159744
L_pf_175:
    buffer_load_dwordx2 v[14:15], v24, s[32:35], s87 offen sc1
    s_waitcnt vmcnt(0)
    v_cmp_eq_u32 vcc, s72, v14
    v_cmp_eq_u32 s[78:79], s73, v15
    s_and_b64 vcc, vcc, s[78:79]
    s_cmp_eq_u64 vcc, -1
    s_cbranch_scc1 L_pfd_176
    s_sub_u32 s70, s70, 1
    s_cbranch_scc1 L_pfd_176_x
    s_sleep 2
    s_branch L_pf_175
L_pfd_176_x:
    s_mov_b32 s70, 0
L_pfd_176:
L_fh_174:
    s_add_u32 m0, s71, 0
    s_add_u32 s60, s74, 0
    buffer_load_dwordx4 v20, s[40:43], s60 offen lds
    buffer_load_dwordx4 v21, s[40:43], s60 offen offset:1024 lds
    s_add_u32 s62, s98, 0
    buffer_load_dwordx4 v[128:131], v22, s[32:35], s62 offen offset:0 sc1
    buffer_load_dwordx4 v[132:135], v17, s[32:35], s62 offen offset:0 sc1
    s_add_u32 m0, s71, 2048
    s_add_u32 s60, s74, 16384
    buffer_load_dwordx4 v20, s[40:43], s60 offen lds
    buffer_load_dwordx4 v21, s[40:43], s60 offen offset:1024 lds
    buffer_load_dwordx4 v[136:139], v22, s[32:35], s62 offen offset:1024 sc1
    buffer_load_dwordx4 v[140:143], v17, s[32:35], s62 offen offset:1024 sc1
    buffer_load_dwordx4 v[144:147], v22, s[32:35], s62 offen offset:2048 sc1
    buffer_load_dwordx4 v[148:151], v17, s[32:35], s62 offen offset:2048 sc1
    buffer_load_dwordx4 v[152:155], v22, s[32:35], s62 offen offset:3072 sc1
    buffer_load_dwordx4 v[156:159], v17, s[32:35], s62 offen offset:3072 sc1
    buffer_load_dwordx4 v[48:51], v16, s[28:31], s65 offen offset:0
    buffer_load_dwordx4 v[52:55], v16, s[28:31], s65 offen offset:32
    v_pk_mul_f32 v[2:3], v[64:65], v[26:27] op_sel_hi:[1,0]
    v_pk_mul_f32 v[4:5], v[66:67], v[26:27] op_sel_hi:[1,0]
    v_pk_mul_f32 v[6:7], v[68:69], v[26:27] op_sel_hi:[1,0]
    v_pk_mul_f32 v[14:15], v[70:71], v[26:27] op_sel_hi:[1,0]
    v_exp_f32 v2, v2
    v_exp_f32 v3, v3
    v_exp_f32 v4, v4
    v_exp_f32 v5, v5
    v_exp_f32 v6, v6
    v_exp_f32 v7, v7
    v_exp_f32 v14, v14
    v_exp_f32 v15, v15
    v_pk_mul_f32 v[64:65], v[64:65], v[72:73]
    v_pk_mul_f32 v[66:67], v[66:67], v[74:75]
    v_pk_mul_f32 v[68:69], v[68:69], v[76:77]
    v_pk_mul_f32 v[70:71], v[70:71], v[78:79]
    v_pk_fma_f32 v[2:3], v[2:3], v[26:27], v[26:27] op_sel:[0,1,1] op_sel_hi:[1,1,1]
    v_pk_fma_f32 v[4:5], v[4:5], v[26:27], v[26:27] op_sel:[0,1,1] op_sel_hi:[1,1,1]
    v_pk_fma_f32 v[6:7], v[6:7], v[26:27], v[26:27] op_sel:[0,1,1] op_sel_hi:[1,1,1]
    v_pk_fma_f32 v[14:15], v[14:15], v[26:27], v[26:27] op_sel:[0,1,1] op_sel_hi:[1,1,1]
    v_rcp_f32 v2, v2
    v_rcp_f32 v3, v3
    v_rcp_f32 v4, v4
    v_rcp_f32 v5, v5
    v_rcp_f32 v6, v6
    v_rcp_f32 v7, v7
    v_rcp_f32 v14, v14
    v_rcp_f32 v15, v15
    s_nop 0
    v_pk_mul_f32 v[64:65], v[64:65], v[2:3]
    v_pk_mul_f32 v[66:67], v[66:67], v[4:5]
    v_pk_mul_f32 v[68:69], v[68:69], v[6:7]
    v_pk_mul_f32 v[70:71], v[70:71], v[14:15]
    v_cvt_pk_bf16_f32 v72, v64, v65
    v_cvt_pk_bf16_f32 v73, v66, v67
    v_cvt_pk_bf16_f32 v74, v68, v69
    v_cvt_pk_bf16_f32 v75, v70, v71
    s_add_u32 s76, s76, 4096
    buffer_store_dwordx4 v[72:75], v12, s[32:35], s76 offen offset:0 sc1
    v_pk_mul_f32 v[2:3], v[80:81], v[26:27] op_sel_hi:[1,0]
    v_pk_mul_f32 v[4:5], v[82:83], v[26:27] op_sel_hi:[1,0]
    v_pk_mul_f32 v[6:7], v[84:85], v[26:27] op_sel_hi:[1,0]
    v_pk_mul_f32 v[14:15], v[86:87], v[26:27] op_sel_hi:[1,0]
    v_exp_f32 v2, v2
    v_exp_f32 v3, v3
    v_exp_f32 v4, v4
    v_exp_f32 v5, v5
    v_exp_f32 v6, v6
    v_exp_f32 v7, v7
    v_exp_f32 v14, v14
    v_exp_f32 v15, v15
    v_pk_mul_f32 v[80:81], v[80:81], v[88:89]
    v_pk_mul_f32 v[82:83], v[82:83], v[90:91]
    v_pk_mul_f32 v[84:85], v[84:85], v[92:93]
    v_pk_mul_f32 v[86:87], v[86:87], v[94:95]
    v_pk_fma_f32 v[2:3], v[2:3], v[26:27], v[26:27] op_sel:[0,1,1] op_sel_hi:[1,1,1]
    v_pk_fma_f32 v[4:5], v[4:5], v[26:27], v[26:27] op_sel:[0,1,1] op_sel_hi:[1,1,1]
    v_pk_fma_f32 v[6:7], v[6:7], v[26:27], v[26:27] op_sel:[0,1,1] op_sel_hi:[1,1,1]
    v_pk_fma_f32 v[14:15], v[14:15], v[26:27], v[26:27] op_sel:[0,1,1] op_sel_hi:[1,1,1]
    v_rcp_f32 v2, v2
    v_rcp_f32 v3, v3
    v_rcp_f32 v4, v4
    v_rcp_f32 v5, v5
    v_rcp_f32 v6, v6
    v_rcp_f32 v7, v7
    v_rcp_f32 v14, v14
    v_rcp_f32 v15, v15
    s_nop 0
    v_pk_mul_f32 v[80:81], v[80:81], v[2:3]
    v_pk_mul_f32 v[82:83], v[82:83], v[4:5]
    v_pk_mul_f32 v[84:85], v[84:85], v[6:7]
    v_pk_mul_f32 v[86:87], v[86:87], v[14:15]
    v_cvt_pk_bf16_f32 v88, v80, v81
    v_cvt_pk_bf16_f32 v89, v82, v83
    v_cvt_pk_bf16_f32 v90, v84, v85
    v_cvt_pk_bf16_f32 v91, v86, v87
    buffer_store_dwordx4 v[88:91], v12, s[32:35], s76 offen offset:1024 sc1
    s_waitcnt vmcnt(16)
    s_mov_b64 exec, 1
    ds_add_u32 v1, v29 offset:32
    s_mov_b64 exec, -1
    s_add_u32 m0, s71, 4096
    s_add_u32 s60, s74, 32768
    buffer_load_dwordx4 v20, s[40:43], s60 offen lds
    buffer_load_dwordx4 v21, s[40:43], s60 offen offset:1024 lds
    s_add_u32 m0, s71, 6144
    s_add_u32 s60, s74, 49152
    buffer_load_dwordx4 v20, s[40:43], s60 offen lds
    buffer_load_dwordx4 v21, s[40:43], s60 offen offset:1024 lds
    s_add_u32 m0, s71, 8192
    s_add_u32 s60, s74, 262144
    buffer_load_dwordx4 v20, s[40:43], s60 offen lds
    buffer_load_dwordx4 v21, s[40:43], s60 offen offset:1024 lds
    s_add_u32 m0, s71, 10240
    s_add_u32 s60, s74, 278528
    buffer_load_dwordx4 v20, s[40:43], s60 offen lds
    buffer_load_dwordx4 v21, s[40:43], s60 offen offset:1024 lds
    s_add_u32 m0, s71, 12288
    s_add_u32 s60, s74, 294912
    buffer_load_dwordx4 v20, s[40:43], s60 offen lds
    buffer_load_dwordx4 v21, s[40:43], s60 offen offset:1024 lds
    s_add_u32 m0, s71, 14336
    s_add_u32 s60, s74, 311296
    buffer_load_dwordx4 v20, s[40:43], s60 offen lds
    buffer_load_dwordx4 v21, s[40:43], s60 offen offset:1024 lds
    v_and_b32 v2, 31, v0
    v_lshrrev_b32 v3, 5, v0
    v_lshlrev_b32 v3, 3, v3
    v_sub_u32 v2, v2, v3
    v_and_b32 v3, 1, v2
    v_lshlrev_b32 v3, 4, v3
    v_lshrrev_b32 v2, 1, v2
    v_mov_b32 v56, 0x3f80
    v_lshlrev_b32 v3, v3, v56
    v_cmp_eq_u32 vcc, 0, v2
    s_nop 1
    v_cndmask_b32 v56, 0, v3, vcc
    v_cmp_eq_u32 vcc, 1, v2
    s_nop 1
    v_cndmask_b32 v57, 0, v3, vcc
    v_cmp_eq_u32 vcc, 2, v2
    s_nop 1
    v_cndmask_b32 v58, 0, v3, vcc
    v_cmp_eq_u32 vcc, 3, v2
    s_nop 1
    v_cndmask_b32 v59, 0, v3, vcc
    v_cmp_eq_u32 vcc, 8, v2
    s_nop 1
    v_cndmask_b32 v60, 0, v3, vcc
    v_cmp_eq_u32 vcc, 9, v2
    s_nop 1
    v_cndmask_b32 v61, 0, v3, vcc
    v_cmp_eq_u32 vcc, 10, v2
    s_nop 1
    v_cndmask_b32 v62, 0, v3, vcc
    v_cmp_eq_u32 vcc, 11, v2
    s_nop 1
    v_cndmask_b32 v63, 0, v3, vcc
    s_waitcnt vmcnt(14)
    v_mfma_f32_32x32x16_bf16 v[64:79], v[56:59], v[48:51], 0
    v_mfma_f32_32x32x16_bf16 v[64:79], v[60:63], v[52:55], v[64:79]
    s_setprio 0
    ds_read_b64_tr_b16 v[32:33], v8 offset:0
    ds_read_b64_tr_b16 v[34:35], v8 offset:1024
    ds_read_b64_tr_b16 v[36:37], v9 offset:0
    ds_read_b64_tr_b16 v[38:39], v9 offset:1024
    ds_read_b64_tr_b16 v[40:41], v8 offset:2048
    ds_read_b64_tr_b16 v[42:43], v8 offset:3072
    ds_read_b64_tr_b16 v[44:45], v9 offset:2048
    ds_read_b64_tr_b16 v[46:47], v9 offset:3072
    s_waitcnt lgkmcnt(4)
    v_mfma_f32_32x32x16_bf16 v[64:79], v[32:35], v[128:131], v[64:79]
    s_waitcnt vmcnt(10)
    ds_read_b64_tr_b16 v[48:49], v8 offset:4096
    ds_read_b64_tr_b16 v[50:51], v8 offset:5120
    ds_read_b64_tr_b16 v[52:53], v9 offset:4096
    ds_read_b64_tr_b16 v[54:55], v9 offset:5120
    v_mfma_f32_32x32x16_bf16 v[80:95], v[36:39], v[128:131], 0
    s_add_u32 m0, s71, 0
    s_add_u32 s60, s74, 524288
    buffer_load_dwordx4 v20, s[40:43], s60 offen lds
    buffer_load_dwordx4 v21, s[40:43], s60 offen offset:1024 lds
    v_mfma_f32_32x32x16_bf16 v[96:111], v[32:35], v[132:135], 0
    v_mfma_f32_32x32x16_bf16 v[112:127], v[36:39], v[132:135], 0
    s_add_u32 s62, s98, 32768
    buffer_load_dwordx4 v[128:131], v22, s[32:35], s62 offen offset:0 sc1
    buffer_load_dwordx4 v[132:135], v17, s[32:35], s62 offen offset:0 sc1
    s_waitcnt lgkmcnt(4)
    v_mfma_f32_32x32x16_bf16 v[64:79], v[40:43], v[136:139], v[64:79]
    s_waitcnt vmcnt(12)
    ds_read_b64_tr_b16 v[56:57], v8 offset:6144
    ds_read_b64_tr_b16 v[58:59], v8 offset:7168
    ds_read_b64_tr_b16 v[60:61], v9 offset:6144
    ds_read_b64_tr_b16 v[62:63], v9 offset:7168
    v_mfma_f32_32x32x16_bf16 v[80:95], v[44:47], v[136:139], v[80:95]
    s_add_u32 m0, s71, 2048
    s_add_u32 s60, s74, 540672
    buffer_load_dwordx4 v20, s[40:43], s60 offen lds
    buffer_load_dwordx4 v21, s[40:43], s60 offen offset:1024 lds
    v_mfma_f32_32x32x16_bf16 v[96:111], v[40:43], v[140:143], v[96:111]
    v_mfma_f32_32x32x16_bf16 v[112:127], v[44:47], v[140:143], v[112:127]
    buffer_load_dwordx4 v[136:139], v22, s[32:35], s62 offen offset:1024 sc1
    buffer_load_dwordx4 v[140:143], v17, s[32:35], s62 offen offset:1024 sc1
    s_waitcnt lgkmcnt(4)
    v_mfma_f32_32x32x16_bf16 v[64:79], v[48:51], v[144:147], v[64:79]
    s_waitcnt vmcnt(14)
    ds_read_b64_tr_b16 v[32:33], v8 offset:8192
    ds_read_b64_tr_b16 v[34:35], v8 offset:9216
    ds_read_b64_tr_b16 v[36:37], v9 offset:8192
    ds_read_b64_tr_b16 v[38:39], v9 offset:9216
    v_mfma_f32_32x32x16_bf16 v[80:95], v[52:55], v[144:147], v[80:95]
    s_add_u32 m0, s71, 4096
    s_add_u32 s60, s74, 557056
    buffer_load_dwordx4 v20, s[40:43], s60 offen lds
    buffer_load_dwordx4 v21, s[40:43], s60 offen offset:1024 lds
    v_mfma_f32_32x32x16_bf16 v[96:111], v[48:51], v[148:151], v[96:111]
    s_setprio 2
    s_lshl_b32 s60, s80, 2
    s_add_u32 s60, s60, s57
    s_lshl_b32 s60, s60, 3
    v_mov_b32 v6, s60
    v_mov_b32 v4, s72
    v_mov_b32 v5, s73
    s_mov_b32 s87, 151552
    s_mov_b64 exec, 1
    buffer_store_dwordx2 v[4:5], v6, s[32:35], s87 offen sc1
    s_mov_b64 exec, -1
    s_setprio 0
    v_mfma_f32_32x32x16_bf16 v[112:127], v[52:55], v[148:151], v[112:127]
    buffer_load_dwordx4 v[144:147], v22, s[32:35], s62 offen offset:2048 sc1
    buffer_load_dwordx4 v[148:151], v17, s[32:35], s62 offen offset:2048 sc1
    s_waitcnt lgkmcnt(4)
    v_mfma_f32_32x32x16_bf16 v[64:79], v[56:59], v[152:155], v[64:79]
    s_waitcnt vmcnt(17)
    ds_read_b64_tr_b16 v[40:41], v8 offset:10240
    ds_read_b64_tr_b16 v[42:43], v8 offset:11264
    ds_read_b64_tr_b16 v[44:45], v9 offset:10240
    ds_read_b64_tr_b16 v[46:47], v9 offset:11264
    v_mfma_f32_32x32x16_bf16 v[80:95], v[60:63], v[152:155], v[80:95]
    s_add_u32 m0, s71, 6144
    s_add_u32 s60, s74, 573440
    buffer_load_dwordx4 v20, s[40:43], s60 offen lds
    buffer_load_dwordx4 v21, s[40:43], s60 offen offset:1024 lds
    v_mfma_f32_32x32x16_bf16 v[96:111], v[56:59], v[156:159], v[96:111]
    v_mfma_f32_32x32x16_bf16 v[112:127], v[60:63], v[156:159], v[112:127]
    buffer_load_dwordx4 v[152:155], v22, s[32:35], s62 offen offset:3072 sc1
    buffer_load_dwordx4 v[156:159], v17, s[32:35], s62 offen offset:3072 sc1
    s_waitcnt vmcnt(13) lgkmcnt(4)
    v_mfma_f32_32x32x16_bf16 v[64:79], v[32:35], v[128:131], v[64:79]
    ds_read_b64_tr_b16 v[48:49], v8 offset:12288
    ds_read_b64_tr_b16 v[50:51], v8 offset:13312
    ds_read_b64_tr_b16 v[52:53], v9 offset:12288
    ds_read_b64_tr_b16 v[54:55], v9 offset:13312
    v_mfma_f32_32x32x16_bf16 v[80:95], v[36:39], v[128:131], v[80:95]
    s_add_u32 m0, s71, 8192
    s_add_u32 s60, s74, 786432
    buffer_load_dwordx4 v20, s[40:43], s60 offen lds
    buffer_load_dwordx4 v21, s[40:43], s60 offen offset:1024 lds
    v_mfma_f32_32x32x16_bf16 v[96:111], v[32:35], v[132:135], v[96:111]
    v_mfma_f32_32x32x16_bf16 v[112:127], v[36:39], v[132:135], v[112:127]
    s_add_u32 s62, s3, 65536
    buffer_load_dwordx4 v[128:131], v22, s[32:35], s62 offen offset:0 sc1
    buffer_load_dwordx4 v[132:135], v17, s[32:35], s62 offen offset:0 sc1
    s_waitcnt vmcnt(13) lgkmcnt(4)
    v_mfma_f32_32x32x16_bf16 v[64:79], v[40:43], v[136:139], v[64:79]
    ds_read_b64_tr_b16 v[56:57], v8 offset:14336
    ds_read_b64_tr_b16 v[58:59], v8 offset:15360
    ds_read_b64_tr_b16 v[60:61], v9 offset:14336
    ds_read_b64_tr_b16 v[62:63], v9 offset:15360
    v_mfma_f32_32x32x16_bf16 v[80:95], v[44:47], v[136:139], v[80:95]
    s_add_u32 m0, s71, 10240
    s_add_u32 s60, s74, 802816
    buffer_load_dwordx4 v20, s[40:43], s60 offen lds
    buffer_load_dwordx4 v21, s[40:43], s60 offen offset:1024 lds
    v_mfma_f32_32x32x16_bf16 v[96:111], v[40:43], v[140:143], v[96:111]
    v_mfma_f32_32x32x16_bf16 v[112:127], v[44:47], v[140:143], v[112:127]
    buffer_load_dwordx4 v[136:139], v22, s[32:35], s62 offen offset:1024 sc1
    buffer_load_dwordx4 v[140:143], v17, s[32:35], s62 offen offset:1024 sc1
    s_waitcnt vmcnt(12) lgkmcnt(4)
    v_mfma_f32_32x32x16_bf16 v[64:79], v[48:51], v[144:147], v[64:79]
    ds_read_b64_tr_b16 v[32:33], v8 offset:0
    ds_read_b64_tr_b16 v[34:35], v8 offset:1024
    ds_read_b64_tr_b16 v[36:37], v9 offset:0
    ds_read_b64_tr_b16 v[38:39], v9 offset:1024
    v_mfma_f32_32x32x16_bf16 v[80:95], v[52:55], v[144:147], v[80:95]
    s_add_u32 m0, s71, 12288
    s_add_u32 s60, s74, 819200
    buffer_load_dwordx4 v20, s[40:43], s60 offen lds
    buffer_load_dwordx4 v21, s[40:43], s60 offen offset:1024 lds
    v_mfma_f32_32x32x16_bf16 v[96:111], v[48:51], v[148:151], v[96:111]
    v_mfma_f32_32x32x16_bf16 v[112:127], v[52:55], v[148:151], v[112:127]
    buffer_load_dwordx4 v[144:147], v22, s[32:35], s62 offen offset:2048 sc1
    buffer_load_dwordx4 v[148:151], v17, s[32:35], s62 offen offset:2048 sc1
    s_waitcnt vmcnt(12) lgkmcnt(4)
    v_mfma_f32_32x32x16_bf16 v[64:79], v[56:59], v[152:155], v[64:79]
    ds_read_b64_tr_b16 v[40:41], v8 offset:2048
    ds_read_b64_tr_b16 v[42:43], v8 offset:3072
    ds_read_b64_tr_b16 v[44:45], v9 offset:2048
    ds_read_b64_tr_b16 v[46:47], v9 offset:3072
    v_mfma_f32_32x32x16_bf16 v[80:95], v[60:63], v[152:155], v[80:95]
    s_add_u32 m0, s71, 14336
    s_add_u32 s60, s74, 835584
    buffer_load_dwordx4 v20, s[40:43], s60 offen lds
    buffer_load_dwordx4 v21, s[40:43], s60 offen offset:1024 lds
    v_mfma_f32_32x32x16_bf16 v[96:111], v[56:59], v[156:159], v[96:111]
    v_mfma_f32_32x32x16_bf16 v[112:127], v[60:63], v[156:159], v[112:127]
    buffer_load_dwordx4 v[152:155], v22, s[32:35], s62 offen offset:3072 sc1
    buffer_load_dwordx4 v[156:159], v17, s[32:35], s62 offen offset:3072 sc1
    s_waitcnt vmcnt(12) lgkmcnt(4)
    v_mfma_f32_32x32x16_bf16 v[64:79], v[32:35], v[128:131], v[64:79]
    ds_read_b64_tr_b16 v[48:49], v8 offset:4096
    ds_read_b64_tr_b16 v[50:51], v8 offset:5120
    ds_read_b64_tr_b16 v[52:53], v9 offset:4096
    ds_read_b64_tr_b16 v[54:55], v9 offset:5120
    v_mfma_f32_32x32x16_bf16 v[80:95], v[36:39], v[128:131], v[80:95]
    s_add_u32 m0, s71, 0
    s_add_u32 s60, s99, 1572864
    buffer_load_dwordx4 v20, s[40:43], s60 offen lds
    buffer_load_dwordx4 v21, s[40:43], s60 offen offset:1024 lds
    v_mfma_f32_32x32x16_bf16 v[96:111], v[32:35], v[132:135], v[96:111]
    v_mfma_f32_32x32x16_bf16 v[112:127], v[36:39], v[132:135], v[112:127]
    s_add_u32 s62, s3, 90112
    buffer_load_dwordx4 v[128:131], v22, s[32:35], s62 offen offset:0 sc1
    buffer_load_dwordx4 v[132:135], v17, s[32:35], s62 offen offset:0 sc1
    s_waitcnt vmcnt(12) lgkmcnt(4)
    v_mfma_f32_32x32x16_bf16 v[64:79], v[40:43], v[136:139], v[64:79]
    ds_read_b64_tr_b16 v[56:57], v8 offset:6144
    ds_read_b64_tr_b16 v[58:59], v8 offset:7168
    ds_read_b64_tr_b16 v[60:61], v9 offset:6144
    ds_read_b64_tr_b16 v[62:63], v9 offset:7168
    v_mfma_f32_32x32x16_bf16 v[80:95], v[44:47], v[136:139], v[80:95]
    s_add_u32 m0, s71, 2048
    s_add_u32 s60, s99, 1589248
    buffer_load_dwordx4 v20, s[40:43], s60 offen lds
    buffer_load_dwordx4 v21, s[40:43], s60 offen offset:1024 lds
    v_mfma_f32_32x32x16_bf16 v[96:111], v[40:43], v[140:143], v[96:111]
    v_mfma_f32_32x32x16_bf16 v[112:127], v[44:47], v[140:143], v[112:127]
    buffer_load_dwordx4 v[136:139], v22, s[32:35], s62 offen offset:1024 sc1
    buffer_load_dwordx4 v[140:143], v17, s[32:35], s62 offen offset:1024 sc1
    s_waitcnt vmcnt(12) lgkmcnt(4)
    v_mfma_f32_32x32x16_bf16 v[64:79], v[48:51], v[144:147], v[64:79]
    ds_read_b64_tr_b16 v[32:33], v8 offset:8192
    ds_read_b64_tr_b16 v[34:35], v8 offset:9216
    ds_read_b64_tr_b16 v[36:37], v9 offset:8192
    ds_read_b64_tr_b16 v[38:39], v9 offset:9216
    v_mfma_f32_32x32x16_bf16 v[80:95], v[52:55], v[144:147], v[80:95]
    s_add_u32 m0, s71, 4096
    s_add_u32 s60, s99, 1703936
    buffer_load_dwordx4 v20, s[40:43], s60 offen lds
    buffer_load_dwordx4 v21, s[40:43], s60 offen offset:1024 lds
    v_mfma_f32_32x32x16_bf16 v[96:111], v[48:51], v[148:151], v[96:111]
    v_mfma_f32_32x32x16_bf16 v[112:127], v[52:55], v[148:151], v[112:127]
    s_mov_b32 s87, 151552
    buffer_load_dwordx2 v[2:3], v24, s[32:35], s87 offen sc1
    buffer_load_dwordx4 v[144:147], v22, s[32:35], s62 offen offset:2048 sc1
    buffer_load_dwordx4 v[148:151], v17, s[32:35], s62 offen offset:2048 sc1
    s_waitcnt vmcnt(13) lgkmcnt(4)
    v_mfma_f32_32x32x16_bf16 v[64:79], v[56:59], v[152:155], v[64:79]
    ds_read_b64_tr_b16 v[40:41], v8 offset:10240
    ds_read_b64_tr_b16 v[42:43], v8 offset:11264
    ds_read_b64_tr_b16 v[44:45], v9 offset:10240
    ds_read_b64_tr_b16 v[46:47], v9 offset:11264
    v_mfma_f32_32x32x16_bf16 v[80:95], v[60:63], v[152:155], v[80:95]
    s_add_u32 m0, s71, 6144
    s_add_u32 s60, s99, 1720320
    buffer_load_dwordx4 v20, s[40:43], s60 offen lds
    buffer_load_dwordx4 v21, s[40:43], s60 offen offset:1024 lds
    v_mfma_f32_32x32x16_bf16 v[96:111], v[56:59], v[156:159], v[96:111]
    v_mfma_f32_32x32x16_bf16 v[112:127], v[60:63], v[156:159], v[112:127]
    buffer_load_dwordx4 v[152:155], v22, s[32:35], s62 offen offset:3072 sc1
    buffer_load_dwordx4 v[156:159], v17, s[32:35], s62 offen offset:3072 sc1
    s_waitcnt vmcnt(13) lgkmcnt(4)
    v_mfma_f32_32x32x16_bf16 v[64:79], v[32:35], v[128:131], v[64:79]
    ds_read_b64_tr_b16 v[48:49], v8 offset:12288
    ds_read_b64_tr_b16 v[50:51], v8 offset:13312
    ds_read_b64_tr_b16 v[52:53], v9 offset:12288
    ds_read_b64_tr_b16 v[54:55], v9 offset:13312
    v_mfma_f32_32x32x16_bf16 v[80:95], v[36:39], v[128:131], v[80:95]
    s_add_u32 m0, s71, 8192
    s_add_u32 s60, s68, 1048576
    buffer_load_dwordx4 v20, s[40:43], s60 offen lds
    buffer_load_dwordx4 v21, s[40:43], s60 offen offset:1024 lds
    v_mfma_f32_32x32x16_bf16 v[96:111], v[32:35], v[132:135], v[96:111]
    v_mfma_f32_32x32x16_bf16 v[112:127], v[36:39], v[132:135], v[112:127]
    s_setprio 2
    s_waitcnt vmcnt(8)
    v_cmp_eq_u32 vcc, s72, v2
    v_cmp_eq_u32 s[78:79], s73, v3
    s_and_b64 vcc, vcc, s[78:79]
    s_or_b32 vcc_lo, vcc_lo, 0xf0f0f0f
    s_or_b32 vcc_hi, vcc_hi, 0xf0f0f0f
    s_cmp_eq_u64 vcc, -1
    s_cbranch_scc1 L_fh_177
    s_mov_b32 s87, 151552
L_pf_178:
    buffer_load_dwordx2 v[2:3], v24, s[32:35], s87 offen sc1
    s_waitcnt vmcnt(0)
    v_cmp_eq_u32 vcc, s72, v2
    v_cmp_eq_u32 s[78:79], s73, v3
    s_and_b64 vcc, vcc, s[78:79]
    s_or_b32 vcc_lo, vcc_lo, 0xf0f0f0f
    s_or_b32 vcc_hi, vcc_hi, 0xf0f0f0f
    s_cmp_eq_u64 vcc, -1
    s_cbranch_scc1 L_pfd_179
    s_sub_u32 s70, s70, 1
    s_cbranch_scc1 L_pfd_179_x
    s_sleep 2
    s_branch L_pf_178
L_pfd_179_x:
    s_mov_b32 s70, 0
L_pfd_179:
L_fh_177:
    s_setprio 0
    s_add_u32 s62, s3, 69632
    buffer_load_dwordx4 v[128:131], v22, s[32:35], s62 offen offset:0 sc1
    buffer_load_dwordx4 v[132:135], v17, s[32:35], s62 offen offset:0 sc1
    s_waitcnt lgkmcnt(4)
    v_mfma_f32_32x32x16_bf16 v[64:79], v[40:43], v[136:139], v[64:79]
    ds_read_b64_tr_b16 v[56:57], v8 offset:14336
    ds_read_b64_tr_b16 v[58:59], v8 offset:15360
    ds_read_b64_tr_b16 v[60:61], v9 offset:14336
    ds_read_b64_tr_b16 v[62:63], v9 offset:15360
    v_mfma_f32_32x32x16_bf16 v[80:95], v[44:47], v[136:139], v[80:95]
    s_add_u32 m0, s71, 10240
    s_add_u32 s60, s68, 1064960
    buffer_load_dwordx4 v20, s[40:43], s60 offen lds
    buffer_load_dwordx4 v21, s[40:43], s60 offen offset:1024 lds
    v_mfma_f32_32x32x16_bf16 v[96:111], v[40:43], v[140:143], v[96:111]
    v_mfma_f32_32x32x16_bf16 v[112:127], v[44:47], v[140:143], v[112:127]
    buffer_load_dwordx4 v[136:139], v22, s[32:35], s62 offen offset:1024 sc1
    buffer_load_dwordx4 v[140:143], v17, s[32:35], s62 offen offset:1024 sc1
    s_waitcnt vmcnt(12) lgkmcnt(4)
    v_mfma_f32_32x32x16_bf16 v[64:79], v[48:51], v[144:147], v[64:79]
    ds_read_b64_tr_b16 v[32:33], v8 offset:0
    ds_read_b64_tr_b16 v[34:35], v8 offset:1024
    ds_read_b64_tr_b16 v[36:37], v9 offset:0
    ds_read_b64_tr_b16 v[38:39], v9 offset:1024
    v_mfma_f32_32x32x16_bf16 v[80:95], v[52:55], v[144:147], v[80:95]
    s_add_u32 m0, s71, 12288
    s_add_u32 s60, s68, 1081344
    buffer_load_dwordx4 v20, s[40:43], s60 offen lds
    buffer_load_dwordx4 v21, s[40:43], s60 offen offset:1024 lds
    v_mfma_f32_32x32x16_bf16 v[96:111], v[48:51], v[148:151], v[96:111]
    v_mfma_f32_32x32x16_bf16 v[112:127], v[52:55], v[148:151], v[112:127]
    s_mov_b32 s87, 151552
    buffer_load_dwordx2 v[4:5], v24, s[32:35], s87 offen sc1
    s_add_u32 s62, s3, 94208
    buffer_load_dwordx4 v[144:147], v22, s[32:35], s62 offen offset:0 sc1
    buffer_load_dwordx4 v[148:151], v17, s[32:35], s62 offen offset:0 sc1
    s_waitcnt vmcnt(13) lgkmcnt(4)
    v_mfma_f32_32x32x16_bf16 v[64:79], v[56:59], v[152:155], v[64:79]
    ds_read_b64_tr_b16 v[40:41], v8 offset:2048
    ds_read_b64_tr_b16 v[42:43], v8 offset:3072
    ds_read_b64_tr_b16 v[44:45], v9 offset:2048
    ds_read_b64_tr_b16 v[46:47], v9 offset:3072
    v_mfma_f32_32x32x16_bf16 v[80:95], v[60:63], v[152:155], v[80:95]
    s_add_u32 m0, s71, 14336
    s_add_u32 s60, s68, 1097728
    buffer_load_dwordx4 v20, s[40:43], s60 offen lds
    buffer_load_dwordx4 v21, s[40:43], s60 offen offset:1024 lds
    v_mfma_f32_32x32x16_bf16 v[96:111], v[56:59], v[156:159], v[96:111]
    v_mfma_f32_32x32x16_bf16 v[112:127], v[60:63], v[156:159], v[112:127]
    buffer_load_dwordx4 v[152:155], v22, s[32:35], s62 offen offset:1024 sc1
    buffer_load_dwordx4 v[156:159], v17, s[32:35], s62 offen offset:1024 sc1
    s_waitcnt vmcnt(13) lgkmcnt(4)
    v_mfma_f32_32x32x16_bf16 v[64:79], v[32:35], v[128:131], v[64:79]
    ds_read_b64_tr_b16 v[48:49], v8 offset:4096
    ds_read_b64_tr_b16 v[50:51], v8 offset:5120
    ds_read_b64_tr_b16 v[52:53], v9 offset:4096
    ds_read_b64_tr_b16 v[54:55], v9 offset:5120
    v_mfma_f32_32x32x16_bf16 v[80:95], v[36:39], v[128:131], v[80:95]
    s_add_u32 m0, s71, 0
    s_add_u32 s60, s68, 1310720
    buffer_load_dwordx4 v20, s[40:43], s60 offen lds
    buffer_load_dwordx4 v21, s[40:43], s60 offen offset:1024 lds
    v_mfma_f32_32x32x16_bf16 v[96:111], v[32:35], v[132:135], v[96:111]
    v_mfma_f32_32x32x16_bf16 v[112:127], v[36:39], v[132:135], v[112:127]
    s_setprio 2
    s_waitcnt vmcnt(8)
    v_cmp_eq_u32 vcc, s72, v4
    v_cmp_eq_u32 s[78:79], s73, v5
    s_and_b64 vcc, vcc, s[78:79]
    s_cmp_eq_u64 vcc, -1
    s_cbranch_scc1 L_fh_180
    s_mov_b32 s87, 151552
L_pf_181:
    buffer_load_dwordx2 v[4:5], v24, s[32:35], s87 offen sc1
    s_waitcnt vmcnt(0)
    v_cmp_eq_u32 vcc, s72, v4
    v_cmp_eq_u32 s[78:79], s73, v5
    s_and_b64 vcc, vcc, s[78:79]
    s_cmp_eq_u64 vcc, -1
    s_cbranch_scc1 L_pfd_182
    s_sub_u32 s70, s70, 1
    s_cbranch_scc1 L_pfd_182_x
    s_sleep 2
    s_branch L_pf_181
L_pfd_182_x:
    s_mov_b32 s70, 0
L_pfd_182:
L_fh_180:
    s_setprio 0
    s_add_u32 s62, s98, 4096
    buffer_load_dwordx4 v[128:131], v22, s[32:35], s62 offen offset:0 sc1
    buffer_load_dwordx4 v[132:135], v17, s[32:35], s62 offen offset:0 sc1
    s_waitcnt lgkmcnt(4)
    v_mfma_f32_32x32x16_bf16 v[64:79], v[40:43], v[136:139], v[64:79]
    ds_read_b64_tr_b16 v[56:57], v8 offset:6144
    ds_read_b64_tr_b16 v[58:59], v8 offset:7168
    ds_read_b64_tr_b16 v[60:61], v9 offset:6144
    ds_read_b64_tr_b16 v[62:63], v9 offset:7168
    v_mfma_f32_32x32x16_bf16 v[80:95], v[44:47], v[136:139], v[80:95]
    s_add_u32 m0, s71, 2048
    s_add_u32 s60, s68, 1327104
    buffer_load_dwordx4 v20, s[40:43], s60 offen lds
    buffer_load_dwordx4 v21, s[40:43], s60 offen offset:1024 lds
    v_mfma_f32_32x32x16_bf16 v[96:111], v[40:43], v[140:143], v[96:111]
    v_mfma_f32_32x32x16_bf16 v[112:127], v[44:47], v[140:143], v[112:127]
    buffer_load_dwordx4 v[136:139], v22, s[32:35], s62 offen offset:1024 sc1
    buffer_load_dwordx4 v[140:143], v17, s[32:35], s62 offen offset:1024 sc1
    s_waitcnt vmcnt(12) lgkmcnt(4)
    v_mfma_f32_32x32x16_bf16 v[64:79], v[48:51], v[144:147], v[64:79]
    ds_read_b64_tr_b16 v[32:33], v8 offset:8192
    ds_read_b64_tr_b16 v[34:35], v8 offset:9216
    ds_read_b64_tr_b16 v[36:37], v9 offset:8192
    ds_read_b64_tr_b16 v[38:39], v9 offset:9216
    v_mfma_f32_32x32x16_bf16 v[80:95], v[52:55], v[144:147], v[80:95]
    s_add_u32 m0, s71, 4096
    s_add_u32 s60, s68, 1343488
    buffer_load_dwordx4 v20, s[40:43], s60 offen lds
    buffer_load_dwordx4 v21, s[40:43], s60 offen offset:1024 lds
    v_mfma_f32_32x32x16_bf16 v[96:111], v[48:51], v[148:151], v[96:111]
    v_mfma_f32_32x32x16_bf16 v[112:127], v[52:55], v[148:151], v[112:127]
    buffer_load_dwordx4 v[144:147], v22, s[32:35], s62 offen offset:2048 sc1
    buffer_load_dwordx4 v[148:151], v17, s[32:35], s62 offen offset:2048 sc1
    s_waitcnt vmcnt(12) lgkmcnt(4)
    v_mfma_f32_32x32x16_bf16 v[64:79], v[56:59], v[152:155], v[64:79]
    ds_read_b64_tr_b16 v[40:41], v8 offset:10240
    ds_read_b64_tr_b16 v[42:43], v8 offset:11264
    ds_read_b64_tr_b16 v[44:45], v9 offset:10240
    ds_read_b64_tr_b16 v[46:47], v9 offset:11264
    v_mfma_f32_32x32x16_bf16 v[80:95], v[60:63], v[152:155], v[80:95]
    s_add_u32 m0, s71, 6144
    s_add_u32 s60, s68, 1359872
    buffer_load_dwordx4 v20, s[40:43], s60 offen lds
    buffer_load_dwordx4 v21, s[40:43], s60 offen offset:1024 lds
    v_mfma_f32_32x32x16_bf16 v[96:111], v[56:59], v[156:159], v[96:111]
    v_mfma_f32_32x32x16_bf16 v[112:127], v[60:63], v[156:159], v[112:127]
    buffer_load_dwordx4 v[152:155], v22, s[32:35], s62 offen offset:3072 sc1
    buffer_load_dwordx4 v[156:159], v17, s[32:35], s62 offen offset:3072 sc1
    s_waitcnt vmcnt(12) lgkmcnt(4)
    v_mfma_f32_32x32x16_bf16 v[64:79], v[32:35], v[128:131], v[64:79]
    ds_read_b64_tr_b16 v[48:49], v8 offset:12288
    ds_read_b64_tr_b16 v[50:51], v8 offset:13312
    ds_read_b64_tr_b16 v[52:53], v9 offset:12288
    ds_read_b64_tr_b16 v[54:55], v9 offset:13312
    v_mfma_f32_32x32x16_bf16 v[80:95], v[36:39], v[128:131], v[80:95]
    s_add_u32 m0, s71, 8192
    s_add_u32 s60, s75, 0
    buffer_load_dwordx4 v20, s[44:47], s60 offen lds
    buffer_load_dwordx4 v21, s[44:47], s60 offen offset:1024 lds
    v_mfma_f32_32x32x16_bf16 v[96:111], v[32:35], v[132:135], v[96:111]
    v_mfma_f32_32x32x16_bf16 v[112:127], v[36:39], v[132:135], v[112:127]
    s_add_u32 s62, s98, 36864
    buffer_load_dwordx4 v[128:131], v22, s[32:35], s62 offen offset:0 sc1
    buffer_load_dwordx4 v[132:135], v17, s[32:35], s62 offen offset:0 sc1
    s_waitcnt vmcnt(12) lgkmcnt(4)
    v_mfma_f32_32x32x16_bf16 v[64:79], v[40:43], v[136:139], v[64:79]
    ds_read_b64_tr_b16 v[56:57], v8 offset:14336
    ds_read_b64_tr_b16 v[58:59], v8 offset:15360
    ds_read_b64_tr_b16 v[60:61], v9 offset:14336
    ds_read_b64_tr_b16 v[62:63], v9 offset:15360
    v_mfma_f32_32x32x16_bf16 v[80:95], v[44:47], v[136:139], v[80:95]
    s_add_u32 m0, s71, 10240
    s_add_u32 s60, s75, 16384
    buffer_load_dwordx4 v20, s[44:47], s60 offen lds
    buffer_load_dwordx4 v21, s[44:47], s60 offen offset:1024 lds
    v_mfma_f32_32x32x16_bf16 v[96:111], v[40:43], v[140:143], v[96:111]
    v_mfma_f32_32x32x16_bf16 v[112:127], v[44:47], v[140:143], v[112:127]
    buffer_load_dwordx4 v[136:139], v22, s[32:35], s62 offen offset:1024 sc1
    buffer_load_dwordx4 v[140:143], v17, s[32:35], s62 offen offset:1024 sc1
    s_waitcnt vmcnt(12) lgkmcnt(4)
    v_mfma_f32_32x32x16_bf16 v[64:79], v[48:51], v[144:147], v[64:79]
    ds_read_b64_tr_b16 v[32:33], v8 offset:0
    ds_read_b64_tr_b16 v[34:35], v8 offset:1024
    ds_read_b64_tr_b16 v[36:37], v9 offset:0
    ds_read_b64_tr_b16 v[38:39], v9 offset:1024
    v_mfma_f32_32x32x16_bf16 v[80:95], v[52:55], v[144:147], v[80:95]
    s_add_u32 m0, s71, 12288
    s_add_u32 s60, s75, 131072
    buffer_load_dwordx4 v20, s[44:47], s60 offen lds
    buffer_load_dwordx4 v21, s[44:47], s60 offen offset:1024 lds
    v_mfma_f32_32x32x16_bf16 v[96:111], v[48:51], v[148:151], v[96:111]
    v_mfma_f32_32x32x16_bf16 v[112:127], v[52:55], v[148:151], v[112:127]
    buffer_load_dwordx4 v[144:147], v22, s[32:35], s62 offen offset:2048 sc1
    buffer_load_dwordx4 v[148:151], v17, s[32:35], s62 offen offset:2048 sc1
    s_waitcnt vmcnt(12) lgkmcnt(4)
    v_mfma_f32_32x32x16_bf16 v[64:79], v[56:59], v[152:155], v[64:79]
    ds_read_b64_tr_b16 v[40:41], v8 offset:2048
    ds_read_b64_tr_b16 v[42:43], v8 offset:3072
    ds_read_b64_tr_b16 v[44:45], v9 offset:2048
    ds_read_b64_tr_b16 v[46:47], v9 offset:3072
    v_mfma_f32_32x32x16_bf16 v[80:95], v[60:63], v[152:155], v[80:95]
    s_add_u32 m0, s71, 14336
    s_add_u32 s60, s75, 147456
    buffer_load_dwordx4 v20, s[44:47], s60 offen lds
    buffer_load_dwordx4 v21, s[44:47], s60 offen offset:1024 lds
    v_mfma_f32_32x32x16_bf16 v[96:111], v[56:59], v[156:159], v[96:111]
    v_mfma_f32_32x32x16_bf16 v[112:127], v[60:63], v[156:159], v[112:127]
    buffer_load_dwordx4 v[152:155], v22, s[32:35], s62 offen offset:3072 sc1
    buffer_load_dwordx4 v[156:159], v17, s[32:35], s62 offen offset:3072 sc1
    s_waitcnt vmcnt(12) lgkmcnt(4)
    v_mfma_f32_32x32x16_bf16 v[64:79], v[32:35], v[128:131], v[64:79]
    ds_read_b64_tr_b16 v[48:49], v8 offset:4096
    ds_read_b64_tr_b16 v[50:51], v8 offset:5120
    ds_read_b64_tr_b16 v[52:53], v9 offset:4096
    ds_read_b64_tr_b16 v[54:55], v9 offset:5120
    v_mfma_f32_32x32x16_bf16 v[80:95], v[36:39], v[128:131], v[80:95]
    s_add_u32 m0, s71, 0
    s_add_u32 s60, s75, 262144
    buffer_load_dwordx4 v20, s[44:47], s60 offen lds
    buffer_load_dwordx4 v21, s[44:47], s60 offen offset:1024 lds
    v_mfma_f32_32x32x16_bf16 v[96:111], v[32:35], v[132:135], v[96:111]
    v_mfma_f32_32x32x16_bf16 v[112:127], v[36:39], v[132:135], v[112:127]
    s_waitcnt vmcnt(10) lgkmcnt(4)
    v_mfma_f32_32x32x16_bf16 v[64:79], v[40:43], v[136:139], v[64:79]
    ds_read_b64_tr_b16 v[56:57], v8 offset:6144
    ds_read_b64_tr_b16 v[58:59], v8 offset:7168
    ds_read_b64_tr_b16 v[60:61], v9 offset:6144
    ds_read_b64_tr_b16 v[62:63], v9 offset:7168
    v_mfma_f32_32x32x16_bf16 v[80:95], v[44:47], v[136:139], v[80:95]
    s_add_u32 m0, s71, 2048
    s_add_u32 s60, s75, 278528
    buffer_load_dwordx4 v20, s[44:47], s60 offen lds
    buffer_load_dwordx4 v21, s[44:47], s60 offen offset:1024 lds
    v_mfma_f32_32x32x16_bf16 v[96:111], v[40:43], v[140:143], v[96:111]
    v_mfma_f32_32x32x16_bf16 v[112:127], v[44:47], v[140:143], v[112:127]
    s_waitcnt vmcnt(8) lgkmcnt(4)
    v_mfma_f32_32x32x16_bf16 v[64:79], v[48:51], v[144:147], v[64:79]
    v_mfma_f32_32x32x16_bf16 v[80:95], v[52:55], v[144:147], v[80:95]
    s_add_u32 m0, s71, 4096
    s_add_u32 s60, s75, 393216
    buffer_load_dwordx4 v20, s[44:47], s60 offen lds
    buffer_load_dwordx4 v21, s[44:47], s60 offen offset:1024 lds
    v_mfma_f32_32x32x16_bf16 v[96:111], v[48:51], v[148:151], v[96:111]
    v_mfma_f32_32x32x16_bf16 v[112:127], v[52:55], v[148:151], v[112:127]
    s_waitcnt vmcnt(6) lgkmcnt(0)
    ds_read_b32 v13, v30 offset:48
    v_mfma_f32_32x32x16_bf16 v[64:79], v[56:59], v[152:155], v[64:79]
    v_mfma_f32_32x32x16_bf16 v[80:95], v[60:63], v[152:155], v[80:95]
    s_add_u32 m0, s71, 6144
    s_add_u32 s60, s75, 409600
    buffer_load_dwordx4 v20, s[44:47], s60 offen lds
    buffer_load_dwordx4 v21, s[44:47], s60 offen offset:1024 lds
    v_mfma_f32_32x32x16_bf16 v[96:111], v[56:59], v[156:159], v[96:111]
    v_mfma_f32_32x32x16_bf16 v[112:127], v[60:63], v[156:159], v[112:127]
    s_add_u32 s76, s77, 8192
    s_add_u32 s74, s77, 16384
    s_add_u32 s75, s77, 24576
    s_setprio 2
    s_waitcnt vmcnt(0) lgkmcnt(0)
    v_cmp_le_u32 vcc, 4, v13
    s_cbranch_vccz L_G_olate_o
    buffer_load_dwordx4 v[192:195], v23, s[32:35], s77 offen offset:0 sc1
    buffer_load_dwordx4 v[196:199], v18, s[32:35], s77 offen offset:0 sc1
    buffer_load_dwordx4 v[200:203], v23, s[32:35], s77 offen offset:1024 sc1
    buffer_load_dwordx4 v[204:207], v18, s[32:35], s77 offen offset:1024 sc1
    buffer_load_dwordx4 v[208:211], v23, s[32:35], s76 offen offset:0 sc1
    buffer_load_dwordx4 v[212:215], v18, s[32:35], s76 offen offset:0 sc1
    buffer_load_dwordx4 v[216:219], v23, s[32:35], s76 offen offset:1024 sc1
    buffer_load_dwordx4 v[220:223], v18, s[32:35], s76 offen offset:1024 sc1
    buffer_load_dwordx4 v[224:227], v23, s[32:35], s74 offen offset:0 sc1
    buffer_load_dwordx4 v[228:231], v18, s[32:35], s74 offen offset:0 sc1
    buffer_load_dwordx4 v[232:235], v23, s[32:35], s74 offen offset:1024 sc1
    buffer_load_dwordx4 v[236:239], v18, s[32:35], s74 offen offset:1024 sc1
    buffer_load_dwordx4 v[240:243], v23, s[32:35], s75 offen offset:0 sc1
    buffer_load_dwordx4 v[244:247], v18, s[32:35], s75 offen offset:0 sc1
    buffer_load_dwordx4 v[248:251], v23, s[32:35], s75 offen offset:1024 sc1
    buffer_load_dwordx4 v[252:255], v18, s[32:35], s75 offen offset:1024 sc1
L_G_olate_o:
    s_mov_b32 s61, vcc_lo
    ds_read_b64_tr_b16 v[128:129], v8 offset:8192
    ds_read_b64_tr_b16 v[130:131], v8 offset:9216
    ds_read_b64_tr_b16 v[132:133], v9 offset:8192
    ds_read_b64_tr_b16 v[134:135], v9 offset:9216
    ds_read_b64_tr_b16 v[136:137], v8 offset:10240
    ds_read_b64_tr_b16 v[138:139], v8 offset:11264
    ds_read_b64_tr_b16 v[140:141], v9 offset:10240
    ds_read_b64_tr_b16 v[142:143], v9 offset:11264
    ds_read_b64_tr_b16 v[144:145], v8 offset:12288
    ds_read_b64_tr_b16 v[146:147], v8 offset:13312
    ds_read_b64_tr_b16 v[148:149], v9 offset:12288
    ds_read_b64_tr_b16 v[150:151], v9 offset:13312
    ds_read_b64_tr_b16 v[152:153], v8 offset:14336
    ds_read_b64_tr_b16 v[154:155], v8 offset:15360
    ds_read_b64_tr_b16 v[156:157], v9 offset:14336
    ds_read_b64_tr_b16 v[158:159], v9 offset:15360
    ds_read_b64_tr_b16 v[160:161], v8 offset:0
    ds_read_b64_tr_b16 v[162:163], v8 offset:1024
    ds_read_b64_tr_b16 v[164:165], v9 offset:0
    ds_read_b64_tr_b16 v[166:167], v9 offset:1024
    ds_read_b64_tr_b16 v[168:169], v8 offset:2048
    ds_read_b64_tr_b16 v[170:171], v8 offset:3072
    ds_read_b64_tr_b16 v[172:173], v9 offset:2048
    ds_read_b64_tr_b16 v[174:175], v9 offset:3072
    ds_read_b64_tr_b16 v[176:177], v8 offset:4096
    ds_read_b64_tr_b16 v[178:179], v8 offset:5120
    ds_read_b64_tr_b16 v[180:181], v9 offset:4096
    ds_read_b64_tr_b16 v[182:183], v9 offset:5120
    ds_read_b64_tr_b16 v[184:185], v8 offset:6144
    ds_read_b64_tr_b16 v[186:187], v8 offset:7168
    ds_read_b64_tr_b16 v[188:189], v9 offset:6144
    ds_read_b64_tr_b16 v[190:191], v9 offset:7168
    ds_add_u32 v28, v29
    s_cmp_lg_u32 s61, 0
    s_cbranch_scc1 L_G_oreq_o
L_pl_183:
    ds_read_b32 v13, v30 offset:48
    s_waitcnt lgkmcnt(0)
    v_cmp_le_u32 vcc, 4, v13
    s_cbranch_vccnz L_pld_184
    s_sub_u32 s70, s70, 1
    s_cbranch_scc1 L_pld_184_x
    s_sleep 1
    s_branch L_pl_183
L_pld_184_x:
    s_mov_b32 s70, 0
L_pld_184:
    buffer_load_dwordx4 v[192:195], v23, s[32:35], s77 offen offset:0 sc1
    buffer_load_dwordx4 v[196:199], v18, s[32:35], s77 offen offset:0 sc1
    buffer_load_dwordx4 v[200:203], v23, s[32:35], s77 offen offset:1024 sc1
    buffer_load_dwordx4 v[204:207], v18, s[32:35], s77 offen offset:1024 sc1
    buffer_load_dwordx4 v[208:211], v23, s[32:35], s76 offen offset:0 sc1
    buffer_load_dwordx4 v[212:215], v18, s[32:35], s76 offen offset:0 sc1
    buffer_load_dwordx4 v[216:219], v23, s[32:35], s76 offen offset:1024 sc1
    buffer_load_dwordx4 v[220:223], v18, s[32:35], s76 offen offset:1024 sc1
    buffer_load_dwordx4 v[224:227], v23, s[32:35], s74 offen offset:0 sc1
    buffer_load_dwordx4 v[228:231], v18, s[32:35], s74 offen offset:0 sc1
    buffer_load_dwordx4 v[232:235], v23, s[32:35], s74 offen offset:1024 sc1
    buffer_load_dwordx4 v[236:239], v18, s[32:35], s74 offen offset:1024 sc1
    buffer_load_dwordx4 v[240:243], v23, s[32:35], s75 offen offset:0 sc1
    buffer_load_dwordx4 v[244:247], v18, s[32:35], s75 offen offset:0 sc1
    buffer_load_dwordx4 v[248:251], v23, s[32:35], s75 offen offset:1024 sc1
    buffer_load_dwordx4 v[252:255], v18, s[32:35], s75 offen offset:1024 sc1
L_G_oreq_o:
    s_xor_b32 s60, s57, 1
    s_mul_i32 s60, s60, 12288
    s_add_u32 s60, s60, 69632
    v_add_u32 v2, s60, v12
    s_xor_b32 s60, s57, 2
    s_mul_i32 s60, s60, 12288
    s_add_u32 s60, s60, 73728
    v_add_u32 v3, s60, v12
    s_xor_b32 s60, s57, 3
    s_mul_i32 s60, s60, 12288
    s_add_u32 s60, s60, 77824
    v_add_u32 v4, s60, v12
    s_mul_i32 s60, s57, 12288
    s_add_u32 s60, s60, 69632
    v_add_u32 v5, s60, v12
    s_waitcnt lgkmcnt(0)
    s_waitcnt vmcnt(12)
    v_max3_u32 v6, v192, v193, v194
    v_max3_u32 v7, v195, v196, v197
    v_max3_u32 v6, v198, v199, v6
    v_max3_u32 v7, v200, v201, v7
    v_max3_u32 v6, v202, v203, v6
    v_max3_u32 v7, v204, v205, v7
    v_max3_u32 v6, v206, v207, v6
    v_max_u32 v6, v6, v7
    v_cmp_eq_u32 vcc, -1, v6
    s_cbranch_vccz L_op_185_x
    s_waitcnt vmcnt(0)
L_op_185_l:
    s_sub_u32 s70, s70, 1
    s_cbranch_scc0 L_op_185_g
    s_mov_b32 s70, 0
    s_branch L_op_185_d
L_op_185_g:
    s_sleep 1
    buffer_load_dwordx4 v[192:195], v23, s[32:35], s77 offen offset:0 sc1
    buffer_load_dwordx4 v[196:199], v18, s[32:35], s77 offen offset:0 sc1
    buffer_load_dwordx4 v[200:203], v23, s[32:35], s77 offen offset:1024 sc1
    buffer_load_dwordx4 v[204:207], v18, s[32:35], s77 offen offset:1024 sc1
    buffer_load_dwordx4 v[208:211], v23, s[32:35], s76 offen offset:0 sc1
    buffer_load_dwordx4 v[212:215], v18, s[32:35], s76 offen offset:0 sc1
    buffer_load_dwordx4 v[216:219], v23, s[32:35], s76 offen offset:1024 sc1
    buffer_load_dwordx4 v[220:223], v18, s[32:35], s76 offen offset:1024 sc1
    s_waitcnt vmcnt(4)
    v_max3_u32 v6, v192, v193, v194
    v_max3_u32 v7, v195, v196, v197
    v_max3_u32 v6, v198, v199, v6
    v_max3_u32 v7, v200, v201, v7
    v_max3_u32 v6, v202, v203, v6
    v_max3_u32 v7, v204, v205, v7
    v_max3_u32 v6, v206, v207, v6
    v_max_u32 v6, v6, v7
    v_cmp_eq_u32 vcc, -1, v6
    s_cbranch_vccz L_op_185_e
    s_waitcnt vmcnt(0)
    s_branch L_op_185_l
L_op_185_d:
    s_waitcnt vmcnt(0)
    buffer_load_dwordx4 v[208:211], v23, s[32:35], s76 offen offset:0 sc1
    buffer_load_dwordx4 v[212:215], v18, s[32:35], s76 offen offset:0 sc1
    buffer_load_dwordx4 v[216:219], v23, s[32:35], s76 offen offset:1024 sc1
    buffer_load_dwordx4 v[220:223], v18, s[32:35], s76 offen offset:1024 sc1
L_op_185_e:
    buffer_load_dwordx4 v[224:227], v23, s[32:35], s74 offen offset:0 sc1
    buffer_load_dwordx4 v[228:231], v18, s[32:35], s74 offen offset:0 sc1
    buffer_load_dwordx4 v[232:235], v23, s[32:35], s74 offen offset:1024 sc1
    buffer_load_dwordx4 v[236:239], v18, s[32:35], s74 offen offset:1024 sc1
    buffer_load_dwordx4 v[240:243], v23, s[32:35], s75 offen offset:0 sc1
    buffer_load_dwordx4 v[244:247], v18, s[32:35], s75 offen offset:0 sc1
    buffer_load_dwordx4 v[248:251], v23, s[32:35], s75 offen offset:1024 sc1
    buffer_load_dwordx4 v[252:255], v18, s[32:35], s75 offen offset:1024 sc1
L_op_185_x:
    v_mfma_f32_32x32x16_bf16 v[64:79], v[128:131], v[192:195], v[64:79]
    v_mfma_f32_32x32x16_bf16 v[80:95], v[132:135], v[192:195], v[80:95]
    v_mfma_f32_32x32x16_bf16 v[96:111], v[128:131], v[196:199], v[96:111]
    v_mfma_f32_32x32x16_bf16 v[112:127], v[132:135], v[196:199], v[112:127]
    v_mfma_f32_32x32x16_bf16 v[64:79], v[136:139], v[200:203], v[64:79]
    v_mfma_f32_32x32x16_bf16 v[80:95], v[140:143], v[200:203], v[80:95]
    v_mfma_f32_32x32x16_bf16 v[96:111], v[136:139], v[204:207], v[96:111]
    v_mfma_f32_32x32x16_bf16 v[112:127], v[140:143], v[204:207], v[112:127]
    s_waitcnt vmcnt(8)
    v_max3_u32 v6, v208, v209, v210
    v_max3_u32 v7, v211, v212, v213
    v_max3_u32 v6, v214, v215, v6
    v_max3_u32 v7, v216, v217, v7
    v_max3_u32 v6, v218, v219, v6
    v_max3_u32 v7, v220, v221, v7
    v_max3_u32 v6, v222, v223, v6
    v_max_u32 v6, v6, v7
    v_cmp_eq_u32 vcc, -1, v6
    s_cbranch_vccz L_op_186_x
    s_waitcnt vmcnt(0)
L_op_186_l:
    s_sub_u32 s70, s70, 1
    s_cbranch_scc0 L_op_186_g
    s_mov_b32 s70, 0
    s_branch L_op_186_d
L_op_186_g:
    s_sleep 1
    buffer_load_dwordx4 v[208:211], v23, s[32:35], s76 offen offset:0 sc1
    buffer_load_dwordx4 v[212:215], v18, s[32:35], s76 offen offset:0 sc1
    buffer_load_dwordx4 v[216:219], v23, s[32:35], s76 offen offset:1024 sc1
    buffer_load_dwordx4 v[220:223], v18, s[32:35], s76 offen offset:1024 sc1
    buffer_load_dwordx4 v[224:227], v23, s[32:35], s74 offen offset:0 sc1
    buffer_load_dwordx4 v[228:231], v18, s[32:35], s74 offen offset:0 sc1
    buffer_load_dwordx4 v[232:235], v23, s[32:35], s74 offen offset:1024 sc1
    buffer_load_dwordx4 v[236:239], v18, s[32:35], s74 offen offset:1024 sc1
    s_waitcnt vmcnt(4)
    v_max3_u32 v6, v208, v209, v210
    v_max3_u32 v7, v211, v212, v213
    v_max3_u32 v6, v214, v215, v6
    v_max3_u32 v7, v216, v217, v7
    v_max3_u32 v6, v218, v219, v6
    v_max3_u32 v7, v220, v221, v7
    v_max3_u32 v6, v222, v223, v6
    v_max_u32 v6, v6, v7
    v_cmp_eq_u32 vcc, -1, v6
    s_cbranch_vccz L_op_186_e
    s_waitcnt vmcnt(0)
    s_branch L_op_186_l
L_op_186_d:
    s_waitcnt vmcnt(0)
    buffer_load_dwordx4 v[224:227], v23, s[32:35], s74 offen offset:0 sc1
    buffer_load_dwordx4 v[228:231], v18, s[32:35], s74 offen offset:0 sc1
    buffer_load_dwordx4 v[232:235], v23, s[32:35], s74 offen offset:1024 sc1
    buffer_load_dwordx4 v[236:239], v18, s[32:35], s74 offen offset:1024 sc1
L_op_186_e:
    buffer_load_dwordx4 v[240:243], v23, s[32:35], s75 offen offset:0 sc1
    buffer_load_dwordx4 v[244:247], v18, s[32:35], s75 offen offset:0 sc1
    buffer_load_dwordx4 v[248:251], v23, s[32:35], s75 offen offset:1024 sc1
    buffer_load_dwordx4 v[252:255], v18, s[32:35], s75 offen offset:1024 sc1
L_op_186_x:
    v_mfma_f32_32x32x16_bf16 v[64:79], v[144:147], v[208:211], v[64:79]
    v_mfma_f32_32x32x16_bf16 v[80:95], v[148:151], v[208:211], v[80:95]
    v_mfma_f32_32x32x16_bf16 v[96:111], v[144:147], v[212:215], v[96:111]
    v_mfma_f32_32x32x16_bf16 v[112:127], v[148:151], v[212:215], v[112:127]
    v_mfma_f32_32x32x16_bf16 v[64:79], v[152:155], v[216:219], v[64:79]
    v_mfma_f32_32x32x16_bf16 v[80:95], v[156:159], v[216:219], v[80:95]
    v_mfma_f32_32x32x16_bf16 v[96:111], v[152:155], v[220:223], v[96:111]
    v_mfma_f32_32x32x16_bf16 v[112:127], v[156:159], v[220:223], v[112:127]
    s_waitcnt vmcnt(4)
    v_max3_u32 v6, v224, v225, v226
    v_max3_u32 v7, v227, v228, v229
    v_max3_u32 v6, v230, v231, v6
    v_max3_u32 v7, v232, v233, v7
    v_max3_u32 v6, v234, v235, v6
    v_max3_u32 v7, v236, v237, v7
    v_max3_u32 v6, v238, v239, v6
    v_max_u32 v6, v6, v7
    v_cmp_eq_u32 vcc, -1, v6
    s_cbranch_vccz L_op_187_x
    s_waitcnt vmcnt(0)
L_op_187_l:
    s_sub_u32 s70, s70, 1
    s_cbranch_scc0 L_op_187_g
    s_mov_b32 s70, 0
    s_branch L_op_187_d
L_op_187_g:
    s_sleep 1
    buffer_load_dwordx4 v[224:227], v23, s[32:35], s74 offen offset:0 sc1
    buffer_load_dwordx4 v[228:231], v18, s[32:35], s74 offen offset:0 sc1
    buffer_load_dwordx4 v[232:235], v23, s[32:35], s74 offen offset:1024 sc1
    buffer_load_dwordx4 v[236:239], v18, s[32:35], s74 offen offset:1024 sc1
    buffer_load_dwordx4 v[240:243], v23, s[32:35], s75 offen offset:0 sc1
    buffer_load_dwordx4 v[244:247], v18, s[32:35], s75 offen offset:0 sc1
    buffer_load_dwordx4 v[248:251], v23, s[32:35], s75 offen offset:1024 sc1
    buffer_load_dwordx4 v[252:255], v18, s[32:35], s75 offen offset:1024 sc1
    s_waitcnt vmcnt(4)
    v_max3_u32 v6, v224, v225, v226
    v_max3_u32 v7, v227, v228, v229
    v_max3_u32 v6, v230, v231, v6
    v_max3_u32 v7, v232, v233, v7
    v_max3_u32 v6, v234, v235, v6
    v_max3_u32 v7, v236, v237, v7
    v_max3_u32 v6, v238, v239, v6
    v_max_u32 v6, v6, v7
    v_cmp_eq_u32 vcc, -1, v6
    s_cbranch_vccz L_op_187_e
    s_waitcnt vmcnt(0)
    s_branch L_op_187_l
L_op_187_d:
    s_waitcnt vmcnt(0)
    buffer_load_dwordx4 v[240:243], v23, s[32:35], s75 offen offset:0 sc1
    buffer_load_dwordx4 v[244:247], v18, s[32:35], s75 offen offset:0 sc1
    buffer_load_dwordx4 v[248:251], v23, s[32:35], s75 offen offset:1024 sc1
    buffer_load_dwordx4 v[252:255], v18, s[32:35], s75 offen offset:1024 sc1
L_op_187_e:
L_op_187_x:
    v_mfma_f32_32x32x16_bf16 v[64:79], v[160:163], v[224:227], v[64:79]
    v_mfma_f32_32x32x16_bf16 v[80:95], v[164:167], v[224:227], v[80:95]
    v_mfma_f32_32x32x16_bf16 v[96:111], v[160:163], v[228:231], v[96:111]
    v_mfma_f32_32x32x16_bf16 v[112:127], v[164:167], v[228:231], v[112:127]
    v_mfma_f32_32x32x16_bf16 v[64:79], v[168:171], v[232:235], v[64:79]
    v_mfma_f32_32x32x16_bf16 v[80:95], v[172:175], v[232:235], v[80:95]
    v_mfma_f32_32x32x16_bf16 v[96:111], v[168:171], v[236:239], v[96:111]
    v_mfma_f32_32x32x16_bf16 v[112:127], v[172:175], v[236:239], v[112:127]
    s_waitcnt vmcnt(0)
    v_max3_u32 v6, v240, v241, v242
    v_max3_u32 v7, v243, v244, v245
    v_max3_u32 v6, v246, v247, v6
    v_max3_u32 v7, v248, v249, v7
    v_max3_u32 v6, v250, v251, v6
    v_max3_u32 v7, v252, v253, v7
    v_max3_u32 v6, v254, v255, v6
    v_max_u32 v6, v6, v7
    v_cmp_eq_u32 vcc, -1, v6
    s_cbranch_vccz L_op_188_x
    s_waitcnt vmcnt(0)
L_op_188_l:
    s_sub_u32 s70, s70, 1
    s_cbranch_scc0 L_op_188_g
    s_mov_b32 s70, 0
    s_branch L_op_188_d
L_op_188_g:
    s_sleep 1
    buffer_load_dwordx4 v[240:243], v23, s[32:35], s75 offen offset:0 sc1
    buffer_load_dwordx4 v[244:247], v18, s[32:35], s75 offen offset:0 sc1
    buffer_load_dwordx4 v[248:251], v23, s[32:35], s75 offen offset:1024 sc1
    buffer_load_dwordx4 v[252:255], v18, s[32:35], s75 offen offset:1024 sc1
    s_waitcnt vmcnt(0)
    v_max3_u32 v6, v240, v241, v242
    v_max3_u32 v7, v243, v244, v245
    v_max3_u32 v6, v246, v247, v6
    v_max3_u32 v7, v248, v249, v7
    v_max3_u32 v6, v250, v251, v6
    v_max3_u32 v7, v252, v253, v7
    v_max3_u32 v6, v254, v255, v6
    v_max_u32 v6, v6, v7
    v_cmp_eq_u32 vcc, -1, v6
    s_cbranch_vccz L_op_188_e
    s_waitcnt vmcnt(0)
    s_branch L_op_188_l
L_op_188_d:
    s_waitcnt vmcnt(0)
L_op_188_e:
L_op_188_x:
    v_mfma_f32_32x32x16_bf16 v[64:79], v[176:179], v[240:243], v[64:79]
    v_mfma_f32_32x32x16_bf16 v[80:95], v[180:183], v[240:243], v[80:95]
    v_mfma_f32_32x32x16_bf16 v[96:111], v[176:179], v[244:247], v[96:111]
    v_mfma_f32_32x32x16_bf16 v[112:127], v[180:183], v[244:247], v[112:127]
    v_mfma_f32_32x32x16_bf16 v[64:79], v[184:187], v[248:251], v[64:79]
    v_mfma_f32_32x32x16_bf16 v[80:95], v[188:191], v[248:251], v[80:95]
    v_mfma_f32_32x32x16_bf16 v[96:111], v[184:187], v[252:255], v[96:111]
    v_mfma_f32_32x32x16_bf16 v[112:127], v[188:191], v[252:255], v[112:127]
L_pl_189:
    ds_read_b32 v13, v30 offset:0
    s_waitcnt lgkmcnt(0)
    v_cmp_le_u32 vcc, 136, v13
    s_cbranch_vccnz L_pld_190
    s_sub_u32 s70, s70, 1
    s_cbranch_scc1 L_pld_190_x
    s_sleep 1
    s_branch L_pl_189
L_pld_190_x:
    s_mov_b32 s70, 0
L_pld_190:
    s_nop 5
    ds_write_b128 v2, v[80:83] offset:0
    ds_write_b128 v2, v[84:87] offset:1024
    ds_write_b128 v2, v[88:91] offset:2048
    ds_write_b128 v2, v[92:95] offset:3072
    ds_write_b128 v3, v[96:99] offset:0
    ds_write_b128 v3, v[100:103] offset:1024
    ds_write_b128 v3, v[104:107] offset:2048
    ds_write_b128 v3, v[108:111] offset:3072
    ds_write_b128 v4, v[112:115] offset:0
    ds_write_b128 v4, v[116:119] offset:1024
    ds_write_b128 v4, v[120:123] offset:2048
    ds_write_b128 v4, v[124:127] offset:3072
    s_waitcnt lgkmcnt(0)
    s_barrier
    ds_read_b128 v[128:131], v5 offset:0
    ds_read_b128 v[132:135], v5 offset:1024
    ds_read_b128 v[136:139], v5 offset:2048
    ds_read_b128 v[140:143], v5 offset:3072
    ds_read_b128 v[144:147], v5 offset:4096
    ds_read_b128 v[148:151], v5 offset:5120
    ds_read_b128 v[152:155], v5 offset:6144
    ds_read_b128 v[156:159], v5 offset:7168
    ds_read_b128 v[160:163], v5 offset:8192
    ds_read_b128 v[164:167], v5 offset:9216
    ds_read_b128 v[168:171], v5 offset:10240
    ds_read_b128 v[172:175], v5 offset:11264
    s_waitcnt lgkmcnt(8)
    v_pk_add_f32 v[64:65], v[64:65], v[128:129]
    v_pk_add_f32 v[66:67], v[66:67], v[130:131]
    v_pk_add_f32 v[68:69], v[68:69], v[132:133]
    v_pk_add_f32 v[70:71], v[70:71], v[134:135]
    v_pk_add_f32 v[72:73], v[72:73], v[136:137]
    v_pk_add_f32 v[74:75], v[74:75], v[138:139]
    v_pk_add_f32 v[76:77], v[76:77], v[140:141]
    v_pk_add_f32 v[78:79], v[78:79], v[142:143]
    s_waitcnt lgkmcnt(0)
    v_pk_add_f32 v[144:145], v[144:145], v[160:161]
    v_pk_add_f32 v[146:147], v[146:147], v[162:163]
    v_pk_add_f32 v[148:149], v[148:149], v[164:165]
    v_pk_add_f32 v[150:151], v[150:151], v[166:167]
    v_pk_add_f32 v[152:153], v[152:153], v[168:169]
    v_pk_add_f32 v[154:155], v[154:155], v[170:171]
    v_pk_add_f32 v[156:157], v[156:157], v[172:173]
    v_pk_add_f32 v[158:159], v[158:159], v[174:175]
    v_pk_add_f32 v[128:129], v[64:65], v[144:145]
    v_pk_add_f32 v[130:131], v[66:67], v[146:147]
    v_pk_add_f32 v[132:133], v[68:69], v[148:149]
    v_pk_add_f32 v[134:135], v[70:71], v[150:151]
    v_pk_add_f32 v[136:137], v[72:73], v[152:153]
    v_pk_add_f32 v[138:139], v[74:75], v[154:155]
    v_pk_add_f32 v[140:141], v[76:77], v[156:157]
    v_pk_add_f32 v[142:143], v[78:79], v[158:159]
    v_cvt_pk_bf16_f32 v64, v128, v129
    v_cvt_pk_bf16_f32 v65, v130, v131
    v_cvt_pk_bf16_f32 v66, v132, v133
    v_cvt_pk_bf16_f32 v67, v134, v135
    v_cvt_pk_bf16_f32 v68, v136, v137
    v_cvt_pk_bf16_f32 v69, v138, v139
    v_cvt_pk_bf16_f32 v70, v140, v141
    v_cvt_pk_bf16_f32 v71, v142, v143
    s_nop 1
    v_permlane32_swap_b32 v64, v66
    v_permlane32_swap_b32 v65, v67
    v_permlane32_swap_b32 v68, v70
    v_permlane32_swap_b32 v69, v71
    buffer_store_dwordx4 v[64:67], v16, s[48:51], s65 offen
    buffer_store_dwordx4 v[68:71], v16, s[48:51], s65 offen offset:32
    s_endpgm
L_gs_133:
L_pl_191:
    ds_read_b32 v13, v30 offset:0
    s_waitcnt lgkmcnt(0)
    v_cmp_le_u32 vcc, 8, v13
    s_cbranch_vccnz L_pld_192
    s_sub_u32 s70, s70, 1
    s_cbranch_scc1 L_pld_192_x
    s_sleep 1
    s_branch L_pl_191
L_pld_192_x:
    s_mov_b32 s70, 0
L_pld_192:
    s_branch L_gs_133_r
L_gs_136:
L_pl_193:
    ds_read_b32 v13, v30 offset:0
    s_waitcnt lgkmcnt(0)
    v_cmp_le_u32 vcc, 12, v13
    s_cbranch_vccnz L_pld_194
    s_sub_u32 s70, s70, 1
    s_cbranch_scc1 L_pld_194_x
    s_sleep 1
    s_branch L_pl_193
L_pld_194_x:
    s_mov_b32 s70, 0
L_pld_194:
    s_branch L_gs_136_r
L_gs_139:
L_pl_195:
    ds_read_b32 v13, v30 offset:0
    s_waitcnt lgkmcnt(0)
    v_cmp_le_u32 vcc, 16, v13
    s_cbranch_vccnz L_pld_196
    s_sub_u32 s70, s70, 1
    s_cbranch_scc1 L_pld_196_x
    s_sleep 1
    s_branch L_pl_195
L_pld_196_x:
    s_mov_b32 s70, 0
L_pld_196:
    s_branch L_gs_139_r
L_gs_140:
L_pl_197:
    ds_read_b32 v13, v30 offset:0
    s_waitcnt lgkmcnt(0)
    v_cmp_le_u32 vcc, 20, v13
    s_cbranch_vccnz L_pld_198
    s_sub_u32 s70, s70, 1
    s_cbranch_scc1 L_pld_198_x
    s_sleep 1
    s_branch L_pl_197
L_pld_198_x:
    s_mov_b32 s70, 0
L_pld_198:
    s_branch L_gs_140_r
L_gs_141:
L_pl_199:
    ds_read_b32 v13, v30 offset:0
    s_waitcnt lgkmcnt(0)
    v_cmp_le_u32 vcc, 24, v13
    s_cbranch_vccnz L_pld_200
    s_sub_u32 s70, s70, 1
    s_cbranch_scc1 L_pld_200_x
    s_sleep 1
    s_branch L_pl_199
L_pld_200_x:
    s_mov_b32 s70, 0
L_pld_200:
    s_branch L_gs_141_r
L_gs_142:
L_pl_201:
    ds_read_b32 v13, v30 offset:0
    s_waitcnt lgkmcnt(0)
    v_cmp_le_u32 vcc, 28, v13
    s_cbranch_vccnz L_pld_202
    s_sub_u32 s70, s70, 1
    s_cbranch_scc1 L_pld_202_x
    s_sleep 1
    s_branch L_pl_201
L_pld_202_x:
    s_mov_b32 s70, 0
L_pld_202:
    s_branch L_gs_142_r
L_gs_143:
L_pl_203:
    ds_read_b32 v13, v30 offset:0
    s_waitcnt lgkmcnt(0)
    v_cmp_le_u32 vcc, 32, v13
    s_cbranch_vccnz L_pld_204
    s_sub_u32 s70, s70, 1
    s_cbranch_scc1 L_pld_204_x
    s_sleep 1
    s_branch L_pl_203
L_pld_204_x:
    s_mov_b32 s70, 0
L_pld_204:
    s_branch L_gs_143_r
L_gs_144:
L_pl_205:
    ds_read_b32 v13, v30 offset:0
    s_waitcnt lgkmcnt(0)
    v_cmp_le_u32 vcc, 36, v13
    s_cbranch_vccnz L_pld_206
    s_sub_u32 s70, s70, 1
    s_cbranch_scc1 L_pld_206_x
    s_sleep 1
    s_branch L_pl_205
L_pld_206_x:
    s_mov_b32 s70, 0
L_pld_206:
    s_branch L_gs_144_r
L_gs_145:
L_pl_207:
    ds_read_b32 v13, v30 offset:0
    s_waitcnt lgkmcnt(0)
    v_cmp_le_u32 vcc, 40, v13
    s_cbranch_vccnz L_pld_208
    s_sub_u32 s70, s70, 1
    s_cbranch_scc1 L_pld_208_x
    s_sleep 1
    s_branch L_pl_207
L_pld_208_x:
    s_mov_b32 s70, 0
L_pld_208:
    s_branch L_gs_145_r
L_gs_146:
L_pl_209:
    ds_read_b32 v13, v30 offset:0
    s_waitcnt lgkmcnt(0)
    v_cmp_le_u32 vcc, 44, v13
    s_cbranch_vccnz L_pld_210
    s_sub_u32 s70, s70, 1
    s_cbranch_scc1 L_pld_210_x
    s_sleep 1
    s_branch L_pl_209
L_pld_210_x:
    s_mov_b32 s70, 0
L_pld_210:
    s_branch L_gs_146_r
L_gs_147:
L_pl_211:
    ds_read_b32 v13, v30 offset:0
    s_waitcnt lgkmcnt(0)
    v_cmp_le_u32 vcc, 48, v13
    s_cbranch_vccnz L_pld_212
    s_sub_u32 s70, s70, 1
    s_cbranch_scc1 L_pld_212_x
    s_sleep 1
    s_branch L_pl_211
L_pld_212_x:
    s_mov_b32 s70, 0
L_pld_212:
    s_branch L_gs_147_r
L_gs_148:
L_pl_213:
    ds_read_b32 v13, v30 offset:0
    s_waitcnt lgkmcnt(0)
    v_cmp_le_u32 vcc, 52, v13
    s_cbranch_vccnz L_pld_214
    s_sub_u32 s70, s70, 1
    s_cbranch_scc1 L_pld_214_x
    s_sleep 1
    s_branch L_pl_213
L_pld_214_x:
    s_mov_b32 s70, 0
L_pld_214:
    s_branch L_gs_148_r
L_gs_149:
L_pl_215:
    ds_read_b32 v13, v30 offset:0
    s_waitcnt lgkmcnt(0)
    v_cmp_le_u32 vcc, 56, v13
    s_cbranch_vccnz L_pld_216
    s_sub_u32 s70, s70, 1
    s_cbranch_scc1 L_pld_216_x
    s_sleep 1
    s_branch L_pl_215
L_pld_216_x:
    s_mov_b32 s70, 0
L_pld_216:
    s_branch L_gs_149_r
L_gs_150:
L_pl_217:
    ds_read_b32 v13, v30 offset:0
    s_waitcnt lgkmcnt(0)
    v_cmp_le_u32 vcc, 60, v13
    s_cbranch_vccnz L_pld_218
    s_sub_u32 s70, s70, 1
    s_cbranch_scc1 L_pld_218_x
    s_sleep 1
    s_branch L_pl_217
L_pld_218_x:
    s_mov_b32 s70, 0
L_pld_218:
    s_branch L_gs_150_r
L_gs_153:
L_pl_219:
    ds_read_b32 v13, v30 offset:0
    s_waitcnt lgkmcnt(0)
    v_cmp_le_u32 vcc, 64, v13
    s_cbranch_vccnz L_pld_220
    s_sub_u32 s70, s70, 1
    s_cbranch_scc1 L_pld_220_x
    s_sleep 1
    s_branch L_pl_219
L_pld_220_x:
    s_mov_b32 s70, 0
L_pld_220:
    s_branch L_gs_153_r
L_gs_154:
L_pl_221:
    ds_read_b32 v13, v30 offset:0
    s_waitcnt lgkmcnt(0)
    v_cmp_le_u32 vcc, 68, v13
    s_cbranch_vccnz L_pld_222
    s_sub_u32 s70, s70, 1
    s_cbranch_scc1 L_pld_222_x
    s_sleep 1
    s_branch L_pl_221
L_pld_222_x:
    s_mov_b32 s70, 0
L_pld_222:
    s_branch L_gs_154_r
L_gs_155:
L_pl_223:
    ds_read_b32 v13, v30 offset:0
    s_waitcnt lgkmcnt(0)
    v_cmp_le_u32 vcc, 72, v13
    s_cbranch_vccnz L_pld_224
    s_sub_u32 s70, s70, 1
    s_cbranch_scc1 L_pld_224_x
    s_sleep 1
    s_branch L_pl_223
L_pld_224_x:
    s_mov_b32 s70, 0
L_pld_224:
    s_branch L_gs_155_r
L_gs_156:
L_pl_225:
    ds_read_b32 v13, v30 offset:0
    s_waitcnt lgkmcnt(0)
    v_cmp_le_u32 vcc, 76, v13
    s_cbranch_vccnz L_pld_226
    s_sub_u32 s70, s70, 1
    s_cbranch_scc1 L_pld_226_x
    s_sleep 1
    s_branch L_pl_225
L_pld_226_x:
    s_mov_b32 s70, 0
L_pld_226:
    s_branch L_gs_156_r
L_gs_157:
L_pl_227:
    ds_read_b32 v13, v30 offset:0
    s_waitcnt lgkmcnt(0)
    v_cmp_le_u32 vcc, 80, v13
    s_cbranch_vccnz L_pld_228
    s_sub_u32 s70, s70, 1
    s_cbranch_scc1 L_pld_228_x
    s_sleep 1
    s_branch L_pl_227
L_pld_228_x:
    s_mov_b32 s70, 0
L_pld_228:
    s_branch L_gs_157_r
L_gs_158:
L_pl_229:
    ds_read_b32 v13, v30 offset:0
    s_waitcnt lgkmcnt(0)
    v_cmp_le_u32 vcc, 84, v13
    s_cbranch_vccnz L_pld_230
    s_sub_u32 s70, s70, 1
    s_cbranch_scc1 L_pld_230_x
    s_sleep 1
    s_branch L_pl_229
L_pld_230_x:
    s_mov_b32 s70, 0
L_pld_230:
    s_branch L_gs_158_r
L_gs_159:
L_pl_231:
    ds_read_b32 v13, v30 offset:0
    s_waitcnt lgkmcnt(0)
    v_cmp_le_u32 vcc, 88, v13
    s_cbranch_vccnz L_pld_232
    s_sub_u32 s70, s70, 1
    s_cbranch_scc1 L_pld_232_x
    s_sleep 1
    s_branch L_pl_231
L_pld_232_x:
    s_mov_b32 s70, 0
L_pld_232:
    s_branch L_gs_159_r
L_gs_160:
L_pl_233:
    ds_read_b32 v13, v30 offset:0
    s_waitcnt lgkmcnt(0)
    v_cmp_le_u32 vcc, 92, v13
    s_cbranch_vccnz L_pld_234
    s_sub_u32 s70, s70, 1
    s_cbranch_scc1 L_pld_234_x
    s_sleep 1
    s_branch L_pl_233
L_pld_234_x:
    s_mov_b32 s70, 0
L_pld_234:
    s_branch L_gs_160_r
L_gs_161:
L_pl_235:
    ds_read_b32 v13, v30 offset:0
    s_waitcnt lgkmcnt(0)
    v_cmp_le_u32 vcc, 96, v13
    s_cbranch_vccnz L_pld_236
    s_sub_u32 s70, s70, 1
    s_cbranch_scc1 L_pld_236_x
    s_sleep 1
    s_branch L_pl_235
L_pld_236_x:
    s_mov_b32 s70, 0
L_pld_236:
    s_branch L_gs_161_r
L_gs_162:
L_pl_237:
    ds_read_b32 v13, v30 offset:0
    s_waitcnt lgkmcnt(0)
    v_cmp_le_u32 vcc, 100, v13
    s_cbranch_vccnz L_pld_238
    s_sub_u32 s70, s70, 1
    s_cbranch_scc1 L_pld_238_x
    s_sleep 1
    s_branch L_pl_237
L_pld_238_x:
    s_mov_b32 s70, 0
L_pld_238:
    s_branch L_gs_162_r
L_gs_163:
L_pl_239:
    ds_read_b32 v13, v30 offset:0
    s_waitcnt lgkmcnt(0)
    v_cmp_le_u32 vcc, 104, v13
    s_cbranch_vccnz L_pld_240
    s_sub_u32 s70, s70, 1
    s_cbranch_scc1 L_pld_240_x
    s_sleep 1
    s_branch L_pl_239
L_pld_240_x:
    s_mov_b32 s70, 0
L_pld_240:
    s_branch L_gs_163_r
L_gs_164:
L_pl_241:
    ds_read_b32 v13, v30 offset:0
    s_waitcnt lgkmcnt(0)
    v_cmp_le_u32 vcc, 108, v13
    s_cbranch_vccnz L_pld_242
    s_sub_u32 s70, s70, 1
    s_cbranch_scc1 L_pld_242_x
    s_sleep 1
    s_branch L_pl_241
L_pld_242_x:
    s_mov_b32 s70, 0
L_pld_242:
    s_branch L_gs_164_r
L_gs_165:
L_pl_243:
    ds_read_b32 v13, v30 offset:0
    s_waitcnt lgkmcnt(0)
    v_cmp_le_u32 vcc, 112, v13
    s_cbranch_vccnz L_pld_244
    s_sub_u32 s70, s70, 1
    s_cbranch_scc1 L_pld_244_x
    s_sleep 1
    s_branch L_pl_243
L_pld_244_x:
    s_mov_b32 s70, 0
L_pld_244:
    s_branch L_gs_165_r
L_gs_166:
L_pl_245:
    ds_read_b32 v13, v30 offset:0
    s_waitcnt lgkmcnt(0)
    v_cmp_le_u32 vcc, 116, v13
    s_cbranch_vccnz L_pld_246
    s_sub_u32 s70, s70, 1
    s_cbranch_scc1 L_pld_246_x
    s_sleep 1
    s_branch L_pl_245
L_pld_246_x:
    s_mov_b32 s70, 0
L_pld_246:
    s_branch L_gs_166_r
L_gs_167:
L_pl_247:
    ds_read_b32 v13, v30 offset:0
    s_waitcnt lgkmcnt(0)
    v_cmp_le_u32 vcc, 120, v13
    s_cbranch_vccnz L_pld_248
    s_sub_u32 s70, s70, 1
    s_cbranch_scc1 L_pld_248_x
    s_sleep 1
    s_branch L_pl_247
L_pld_248_x:
    s_mov_b32 s70, 0
L_pld_248:
    s_branch L_gs_167_r
L_gs_168:
L_pl_249:
    ds_read_b32 v13, v30 offset:0
    s_waitcnt lgkmcnt(0)
    v_cmp_le_u32 vcc, 124, v13
    s_cbranch_vccnz L_pld_250
    s_sub_u32 s70, s70, 1
    s_cbranch_scc1 L_pld_250_x
    s_sleep 1
    s_branch L_pl_249
L_pld_250_x:
    s_mov_b32 s70, 0
L_pld_250:
    s_branch L_gs_168_r
L_gs_169:
L_pl_251:
    ds_read_b32 v13, v30 offset:0
    s_waitcnt lgkmcnt(0)
    v_cmp_le_u32 vcc, 128, v13
    s_cbranch_vccnz L_pld_252
    s_sub_u32 s70, s70, 1
    s_cbranch_scc1 L_pld_252_x
    s_sleep 1
    s_branch L_pl_251
L_pld_252_x:
    s_mov_b32 s70, 0
L_pld_252:
    s_branch L_gs_169_r
L_end:
    s_endpgm
    .section .rodata,"a"
    .p2align 6
    .amdhsa_kernel parallel_sum__grouped_kv_mqa__glu_gated_swiglu__prompt_kernel
    .amdhsa_next_free_vgpr 256
    .amdhsa_next_free_sgpr 100
    .amdhsa_accum_offset 256
    .amdhsa_group_segment_fixed_size 0
    .amdhsa_kernarg_size 96
    .amdhsa_user_sgpr_count 2
    .amdhsa_user_sgpr_kernarg_segment_ptr 1
    .amdhsa_system_sgpr_workgroup_id_x 1
    .amdhsa_float_denorm_mode_32 3
    .end_amdhsa_kernel
```
